```python
import torch

def _softmax(x, axis=-1):
    return torch.softmax(x, dim=axis)
def _gelu(x):
    return torch.nn.functional.gelu(x, approximate="tanh")
def _silu(x):
    return torch.nn.functional.silu(x)
def _sigmoid(x):
    return torch.sigmoid(x)
def _layernorm(x, axis=-1, eps=1e-5):
    m = x.mean(dim=axis, keepdim=True)
    v = x.var(dim=axis, keepdim=True, unbiased=False)
    return (x - m) / torch.sqrt(v + eps)
def _scatter_add(tgt, idx, src, axis=0):
    return tgt.clone().index_add_(axis, idx, src)
def _segment_sum(src, seg, n):
    out = torch.zeros((n,) + src.shape[1:], dtype=src.dtype)
    return out.index_add_(0, seg, src)
def _pad(x, pw):
    flat = tuple(v for pair in reversed(pw) for v in pair)
    return torch.nn.functional.pad(x, flat)

kernel_name = 'gated_mix__sliding_local_dilated__dense_activation_gelu__prompt'

def setup_inputs():

    _w = (lambda a: (lambda t: t.to(torch.bfloat16) if t.is_floating_point() else t)(torch.as_tensor(a)))
    def _A_setup():
        B, S, D = 1, 2048, 640
        return {
            "x": _w((lambda *s: torch.randn(*s, dtype=torch.bfloat16) * 0.2)(B, S, D)),
            "wqkv": _w((lambda *s: torch.randn(*s, dtype=torch.bfloat16) * 0.2)(D, 3 * D)),
            "wo": _w((lambda *s: torch.randn(*s, dtype=torch.bfloat16) * 0.2)(D, D)),
        }
    _A_in = _A_setup()

    def _B_setup():
        B, S, D, F = 1, 2048, 640, 1728
        return {
            "x": _w((lambda *s: torch.randn(*s, dtype=torch.bfloat16) * 0.2)(B, S, D)),
            "w1": _w((lambda *s: torch.randn(*s, dtype=torch.bfloat16) * 3.2)(D, F) * (D ** -0.5)),
            "b1": _w((lambda *s: torch.randn(*s, dtype=torch.bfloat16) * 3.2)(F) * 0.01),
            "w2": _w((lambda *s: torch.randn(*s, dtype=torch.bfloat16) * 3.2)(F, D) * (F ** -0.5)),
            "b2": _w((lambda *s: torch.randn(*s, dtype=torch.bfloat16) * 3.2)(D) * 0.01),
        }
    _B_in = _B_setup()

    return {
        "A_x": _A_in["x"],
        "A_wqkv": _A_in["wqkv"],
        "A_wo": _A_in["wo"],
        "B_x": _B_in["x"],
        "B_w1": _B_in["w1"],
        "B_b1": _B_in["b1"],
        "B_w2": _B_in["w2"],
        "B_b2": _B_in["b2"],
        "gate_w": _w((lambda *s: torch.randn(*s, dtype=torch.bfloat16) * 0.2)(640) * 16.0),
    }

def reference(A_x, A_wqkv, A_wo, B_x, B_w1, B_b1, B_w2, B_b2, gate_w):
    def _A_ref(x, wqkv, wo):
        B, S, D = x.shape
        H = 32; Dh = D // H
        W, dil = 8, 2
        qkv = (lambda x, *d: x.permute(*d))((x @ wqkv).reshape(B, S, 3, H, Dh), 2, 0, 3, 1, 4)
        q, k, v = qkv[0], qkv[1], qkv[2]
        scale = Dh ** -0.5
        pos = torch.arange(S)
        off = torch.arange(W) * dil
        idx = pos[:, None] - off[None, :]
        mask = idx >= 0
        idx_c = torch.where(mask, idx, 0).reshape(-1)
        kg = k[:, :, idx_c, :].reshape(B, H, S, W, Dh)
        vg = v[:, :, idx_c, :].reshape(B, H, S, W, Dh)
        logits = torch.einsum("bhsd,bhswd->bhsw", q, kg) * scale
        logits = torch.where(mask[None, None, :, :], logits, -1e9)
        attn = _softmax(logits, axis=-1)
        o = torch.einsum("bhsw,bhswd->bhsd", attn, vg)
        return (lambda x, *d: x.permute(*d))(o, 0, 2, 1, 3).reshape(B, S, D) @ wo

    def _B_ref(x, w1, b1, w2, b2):
        h = torch.einsum("bsd,df->bsf", x, w1) + b1
        h = _gelu(h)
        return torch.einsum("bsf,fd->bsd", h, w2) + b2

    x = A_x
    g = _sigmoid((x * gate_w).sum(-1, keepdims=True))
    a = _A_ref(x, A_wqkv, A_wo)
    b = _B_ref(x, B_w1, B_b1, B_w2, B_b2)
    return g * a + (1 - g) * b
```

```asm
; @launch kernel=gm_k1_kernel grid=(256,1,1) block=(512,1,1) lds=163840
; @launch kernel=gm_k2_kernel grid=(256,1,1) block=(256,1,1) lds=81984
.amdgcn_target "amdgcn-amd-amdhsa--gfx950"
.text
.globl gm_k1_kernel
.p2align 8
.type gm_k1_kernel,@function
gm_k1_kernel:
    s_cmp_ge_u32 s2, 256
    s_cbranch_scc1 L_k1_end
    s_load_dwordx4 s[4:7], s[0:1], 0
    s_load_dwordx4 s[8:11], s[0:1], 16
    s_load_dwordx4 s[12:15], s[0:1], 32
    s_load_dwordx4 s[16:19], s[0:1], 48
    s_load_dwordx2 s[20:21], s[0:1], 64
    s_load_dwordx2 s[22:23], s[0:1], 88
    v_lshrrev_b32 v1, 6, v0
    v_and_b32 v2, 63, v0
    v_readfirstlane_b32 s24, v1
    s_and_b32 s52, s2, 7
    s_lshr_b32 s53, s2, 3
    s_lshr_b32 s25, s53, 4
    s_and_b32 s54, s53, 15
    s_lshr_b32 s55, s52, 1
    s_lshl_b32 s55, s55, 2
    s_lshr_b32 s56, s54, 2
    s_add_u32 s26, s55, s56
    s_and_b32 s55, s52, 1
    s_lshl_b32 s55, s55, 2
    s_and_b32 s56, s54, 3
    s_add_u32 s27, s55, s56
    s_cmp_eq_u32 s24, 0
    s_cbranch_scc0 L_nopf
    v_mov_b32 v10, v2
    s_getpc_b64 s[84:85]
L_pc_k1:
    s_add_u32 s84, s84, L_k1_body-L_pc_k1
    s_addc_u32 s85, s85, 0
    s_lshr_b32 s86, s2, 3
    s_cmp_lt_u32 s86, 4
    s_cbranch_scc0 L_pfskip_k1
    s_lshl_b32 s86, s86, 13
    v_lshlrev_b32 v10, 7, v10
    v_add_u32 v10, s86, v10
    v_min_u32 v10, L_k1_end-L_k1_body, v10
    global_load_dword v255, v10, s[84:85]
L_pfskip_k1:
L_nopf:
L_k1_body:
    s_cmp_ge_u32 s24, 4
    s_cbranch_scc0 L_consumer
    s_cmp_eq_u32 s25, 0
    s_cbranch_scc0 L_loader_F
L_loader_A:
    s_sub_u32 s57, s24, 4
    v_lshrrev_b32 v3, 3, v2
    s_lshl_b32 s58, s57, 3
    v_add_u32 v3, s58, v3
    s_lshl_b32 s59, s26, 7
    s_sub_u32 s59, s59, 16
    v_add_u32 v3, s59, v3
    s_and_b32 s58, s57, 1
    s_lshl_b32 s58, s58, 2
    v_lshrrev_b32 v4, 4, v2
    v_add_u32 v4, s58, v4
    v_and_b32 v5, 7, v2
    v_xor_b32 v4, v4, v5
    v_lshlrev_b32 v4, 4, v4
    s_movk_i32 s58, 1280
    s_movk_i32 s59, 2047
    v_add_u32 v5, 0, v3
    v_max_i32 v5, 0, v5
    v_mul_u32_u24 v5, s58, v5
    v_add_u32 v10, v5, v4
    v_add_u32 v5, 32, v3
    v_mul_u32_u24 v5, s58, v5
    v_add_u32 v11, v5, v4
    v_add_u32 v5, 64, v3
    v_mul_u32_u24 v5, s58, v5
    v_add_u32 v12, v5, v4
    v_add_u32 v5, 96, v3
    v_mul_u32_u24 v5, s58, v5
    v_add_u32 v13, v5, v4
    v_add_u32 v5, 128, v3
    v_mul_u32_u24 v5, s58, v5
    v_add_u32 v6, v5, v4
    s_lshl_b32 s58, s57, 6
    v_add_u32 v7, s58, v2
    s_mov_b32 s60, 3840
    v_mov_b32 v9, 0x7ffffff0
    s_mul_i32 s61, s27, 160
    s_waitcnt lgkmcnt(0)
    s_mov_b32 s28, s4
    s_mov_b32 s29, s5
    s_mov_b32 s30, 2621440
    s_mov_b32 s31, 0x20000
    s_mov_b32 s32, s6
    s_mov_b32 s33, s7
    s_mov_b32 s34, 2457600
    s_mov_b32 s35, 0x20000
    s_cmp_lt_u32 s57, 2
    s_cselect_b32 s36, s28, s32
    s_cselect_b32 s37, s29, s33
    s_cselect_b32 s38, s30, s34
    s_mov_b32 s39, 0x20000
    s_movk_i32 s73, 128
    s_cselect_b32 s73, s73, 245760
    s_and_b32 s79, s26, 7
    s_lshr_b32 s79, s79, 1
    s_mul_i32 s79, s79, 5
    s_lshr_b32 s79, s79, 1
    s_and_b32 s80, s27, 1
    s_lshl_b32 s81, s25, 1
    s_add_u32 s80, s80, s81
    s_mul_i32 s80, s80, 5
    s_lshr_b32 s80, s80, 1
    s_add_u32 s79, s79, s80
    s_cmp_ge_u32 s79, 10
    s_cselect_b32 s80, 10, 0
    s_sub_u32 s79, s79, s80
    s_lshl_b32 s74, s79, 7
    s_mul_i32 s75, s79, 245760
    s_mul_i32 s76, s79, s73
    s_lshl_b32 s77, s57, 10
    s_add_u32 m0, s77, 0
    s_nop 0
    buffer_load_dwordx4 v10, s[28:31], s74 offen  lds
    s_add_u32 m0, s77, 4096
    s_nop 0
    buffer_load_dwordx4 v11, s[28:31], s74 offen  lds
    s_add_u32 m0, s77, 8192
    s_nop 0
    buffer_load_dwordx4 v12, s[28:31], s74 offen  lds
    s_add_u32 m0, s77, 12288
    s_nop 0
    buffer_load_dwordx4 v13, s[28:31], s74 offen  lds
    v_subrev_u32 v3, 128, v7
    v_max_i32 v3, 0, v3
    v_mul_u32_u24 v4, 2185, v3
    v_lshrrev_b32 v4, 16, v4
    v_mul_u32_u24 v5, 30, v4
    v_sub_u32 v5, v3, v5
    v_lshrrev_b32 v3, 1, v4
    v_xor_b32 v3, v3, v4
    v_and_b32 v3, 4, v3
    v_mul_u32_u24 v3, 3, v3
    v_xor_b32 v4, v3, v4
    v_mul_u32_u24 v4, s60, v4
    v_mul_u32_u24 v3, 205, v5
    v_lshrrev_b32 v3, 11, v3
    v_mul_u32_u24 v3, 1120, v3
    v_lshlrev_b32 v5, 4, v5
    v_add3_u32 v5, v5, v3, s61
    v_add_u32 v8, v4, v5
    s_cmp_lt_u32 s57, 2
    s_cselect_b64 vcc, -1, 0
    v_cndmask_b32 v14, v8, v6, vcc
    s_add_u32 m0, s77, 16384
    s_nop 0
    buffer_load_dwordx4 v14, s[36:39], s76 offen  lds
    v_add_u32 v3, 128, v7
    v_mul_u32_u24 v4, 2185, v3
    v_lshrrev_b32 v4, 16, v4
    v_mul_u32_u24 v5, 30, v4
    v_sub_u32 v5, v3, v5
    v_lshrrev_b32 v3, 1, v4
    v_xor_b32 v3, v3, v4
    v_and_b32 v3, 4, v3
    v_mul_u32_u24 v3, 3, v3
    v_xor_b32 v4, v3, v4
    v_mul_u32_u24 v4, s60, v4
    v_mul_u32_u24 v3, 205, v5
    v_lshrrev_b32 v3, 11, v3
    v_mul_u32_u24 v3, 1120, v3
    v_lshlrev_b32 v5, 4, v5
    v_add3_u32 v5, v5, v3, s61
    v_add_u32 v15, v4, v5
    s_add_u32 m0, s77, 20480
    s_nop 0
    buffer_load_dwordx4 v15, s[32:35], s75 offen  lds
    v_add_u32 v3, 384, v7
    v_mul_u32_u24 v4, 2185, v3
    v_lshrrev_b32 v4, 16, v4
    v_mul_u32_u24 v5, 30, v4
    v_sub_u32 v5, v3, v5
    v_lshrrev_b32 v3, 1, v4
    v_xor_b32 v3, v3, v4
    v_and_b32 v3, 4, v3
    v_mul_u32_u24 v3, 3, v3
    v_xor_b32 v4, v3, v4
    v_mul_u32_u24 v4, s60, v4
    v_mul_u32_u24 v3, 205, v5
    v_lshrrev_b32 v3, 11, v3
    v_mul_u32_u24 v3, 1120, v3
    v_lshlrev_b32 v5, 4, v5
    v_add3_u32 v5, v5, v3, s61
    v_add_u32 v16, v4, v5
    s_add_u32 m0, s77, 24576
    s_nop 0
    buffer_load_dwordx4 v16, s[32:35], s75 offen  lds
    v_add_u32 v3, 640, v7
    v_mul_u32_u24 v4, 2185, v3
    v_lshrrev_b32 v4, 16, v4
    v_mul_u32_u24 v5, 30, v4
    v_sub_u32 v5, v3, v5
    v_lshrrev_b32 v3, 1, v4
    v_xor_b32 v3, v3, v4
    v_and_b32 v3, 4, v3
    v_mul_u32_u24 v3, 3, v3
    v_xor_b32 v4, v3, v4
    v_mul_u32_u24 v4, s60, v4
    v_mul_u32_u24 v3, 205, v5
    v_lshrrev_b32 v3, 11, v3
    v_mul_u32_u24 v3, 1120, v3
    v_lshlrev_b32 v5, 4, v5
    v_add3_u32 v5, v5, v3, s61
    v_add_u32 v17, v4, v5
    s_add_u32 m0, s77, 28672
    s_nop 0
    buffer_load_dwordx4 v17, s[32:35], s75 offen  lds
    v_add_u32 v3, 896, v7
    v_mul_u32_u24 v4, 2185, v3
    v_lshrrev_b32 v4, 16, v4
    v_mul_u32_u24 v5, 30, v4
    v_sub_u32 v5, v3, v5
    v_lshrrev_b32 v3, 1, v4
    v_xor_b32 v3, v3, v4
    v_and_b32 v3, 4, v3
    v_mul_u32_u24 v3, 3, v3
    v_xor_b32 v4, v3, v4
    v_mul_u32_u24 v4, s60, v4
    v_mul_u32_u24 v3, 205, v5
    v_lshrrev_b32 v3, 11, v3
    v_mul_u32_u24 v3, 1120, v3
    v_lshlrev_b32 v5, 4, v5
    v_add3_u32 v5, v5, v3, s61
    v_add_u32 v18, v4, v5
    s_add_u32 m0, s77, 32768
    s_nop 0
    buffer_load_dwordx4 v18, s[32:35], s75 offen  lds
    v_add_u32 v3, 1152, v7
    v_mul_u32_u24 v4, 2185, v3
    v_lshrrev_b32 v4, 16, v4
    v_mul_u32_u24 v5, 30, v4
    v_sub_u32 v5, v3, v5
    v_lshrrev_b32 v3, 1, v4
    v_xor_b32 v3, v3, v4
    v_and_b32 v3, 4, v3
    v_mul_u32_u24 v3, 3, v3
    v_xor_b32 v4, v3, v4
    v_mul_u32_u24 v4, s60, v4
    v_mul_u32_u24 v3, 205, v5
    v_lshrrev_b32 v3, 11, v3
    v_mul_u32_u24 v3, 1120, v3
    v_lshlrev_b32 v5, 4, v5
    v_add3_u32 v5, v5, v3, s61
    v_add_u32 v19, v4, v5
    s_add_u32 m0, s77, 36864
    s_nop 0
    buffer_load_dwordx4 v19, s[32:35], s75 offen  lds
    v_add_u32 v3, 1408, v7
    v_mul_u32_u24 v4, 2185, v3
    v_lshrrev_b32 v4, 16, v4
    v_mul_u32_u24 v5, 30, v4
    v_sub_u32 v5, v3, v5
    v_lshrrev_b32 v3, 1, v4
    v_xor_b32 v3, v3, v4
    v_and_b32 v3, 4, v3
    v_mul_u32_u24 v3, 3, v3
    v_xor_b32 v4, v3, v4
    v_mul_u32_u24 v4, s60, v4
    v_mul_u32_u24 v3, 205, v5
    v_lshrrev_b32 v3, 11, v3
    v_mul_u32_u24 v3, 1120, v3
    v_lshlrev_b32 v5, 4, v5
    v_add3_u32 v5, v5, v3, s61
    v_add_u32 v20, v4, v5
    s_add_u32 m0, s77, 40960
    s_nop 0
    buffer_load_dwordx4 v20, s[32:35], s75 offen  lds
    v_add_u32 v3, 1664, v7
    v_mul_u32_u24 v4, 2185, v3
    v_lshrrev_b32 v4, 16, v4
    v_mul_u32_u24 v5, 30, v4
    v_sub_u32 v5, v3, v5
    v_lshrrev_b32 v3, 1, v4
    v_xor_b32 v3, v3, v4
    v_and_b32 v3, 4, v3
    v_mul_u32_u24 v3, 3, v3
    v_xor_b32 v4, v3, v4
    v_mul_u32_u24 v4, s60, v4
    v_mul_u32_u24 v3, 205, v5
    v_lshrrev_b32 v3, 11, v3
    v_mul_u32_u24 v3, 1120, v3
    v_lshlrev_b32 v5, 4, v5
    v_add3_u32 v5, v5, v3, s61
    v_add_u32 v21, v4, v5
    s_add_u32 m0, s77, 45056
    s_nop 0
    buffer_load_dwordx4 v21, s[32:35], s75 offen  lds
    s_add_u32 s74, s74, 128
    s_add_u32 s75, s75, 245760
    s_add_u32 s76, s76, s73
    s_add_u32 s79, s79, 1
    s_cmp_eq_u32 s79, 10
    s_cselect_b32 s79, 0, s79
    s_cselect_b32 s74, 0, s74
    s_cselect_b32 s75, 0, s75
    s_cselect_b32 s76, 0, s76
    s_add_u32 m0, s77, 49152
    s_nop 0
    buffer_load_dwordx4 v10, s[28:31], s74 offen  lds
    s_add_u32 m0, s77, 53248
    s_nop 0
    buffer_load_dwordx4 v11, s[28:31], s74 offen  lds
    s_add_u32 m0, s77, 57344
    s_nop 0
    buffer_load_dwordx4 v12, s[28:31], s74 offen  lds
    s_add_u32 m0, s77, 61440
    s_nop 0
    buffer_load_dwordx4 v13, s[28:31], s74 offen  lds
    s_add_u32 m0, s77, 65536
    s_nop 0
    buffer_load_dwordx4 v14, s[36:39], s76 offen  lds
    s_add_u32 m0, s77, 69632
    s_nop 0
    buffer_load_dwordx4 v15, s[32:35], s75 offen  lds
    s_add_u32 m0, s77, 73728
    s_nop 0
    buffer_load_dwordx4 v16, s[32:35], s75 offen  lds
    s_add_u32 m0, s77, 77824
    s_nop 0
    buffer_load_dwordx4 v17, s[32:35], s75 offen  lds
    s_add_u32 m0, s77, 81920
    s_nop 0
    buffer_load_dwordx4 v18, s[32:35], s75 offen  lds
    s_add_u32 m0, s77, 86016
    s_nop 0
    buffer_load_dwordx4 v19, s[32:35], s75 offen  lds
    s_add_u32 m0, s77, 90112
    s_nop 0
    buffer_load_dwordx4 v20, s[32:35], s75 offen  lds
    s_add_u32 m0, s77, 94208
    s_nop 0
    buffer_load_dwordx4 v21, s[32:35], s75 offen  lds
    s_add_u32 s74, s74, 128
    s_add_u32 s75, s75, 245760
    s_add_u32 s76, s76, s73
    s_add_u32 s79, s79, 1
    s_cmp_eq_u32 s79, 10
    s_cselect_b32 s79, 0, s79
    s_cselect_b32 s74, 0, s74
    s_cselect_b32 s75, 0, s75
    s_cselect_b32 s76, 0, s76
    s_lshl_b32 s62, s26, 3
    s_add_u32 s62, s62, s27
    s_lshl_b32 s63, s57, 7
    s_add_u32 s62, s62, s63
    s_add_u32 s62, s62, 384
    s_cmp_lt_u32 s62, 592
    s_cselect_b32 s63, 1, 0
    s_cmp_lt_u32 s57, 3
    s_cselect_b32 s63, s63, 0
    s_and_b32 s64, s62, 7
    s_lshr_b32 s65, s62, 3
    s_lshl_b32 s66, s65, 5
    s_mov_b32 s67, 16
    s_mov_b32 s68, 4
    s_mul_i32 s69, s64, 54
    s_add_u32 s69, s69, s65
    s_mul_i32 s69, s69, 5120
    s_add_u32 s69, s69, 9699328
    s_mov_b32 s70, 0
    s_cmp_lt_u32 s65, 54
    s_cbranch_scc1 L_unit_done_A
    s_sub_u32 s65, s65, 54
    s_mov_b32 s70, 1
    s_mul_i32 s69, s64, 20
    s_add_u32 s69, s69, s65
    s_mul_i32 s69, s69, 5120
    s_add_u32 s69, s69, 11911168
    s_mul_i32 s66, s65, 40
    s_mov_b32 s67, 20
    s_cmp_lt_u32 s65, 16
    s_cbranch_scc1 L_unit_done_A
    s_sub_u32 s65, s65, 16
    s_mul_i32 s66, s65, 160
    s_add_u32 s66, s66, 16
    s_mov_b32 s67, 80
    s_mov_b32 s68, 20
L_unit_done_A:
    s_mul_i32 s71, s64, 160
    s_movk_i32 s58, 1280
    v_add_u32 v3, 0, v2
    v_mul_u32_u24 v4, 6554, v3
    v_lshrrev_b32 v4, 16, v4
    v_mul_u32_u24 v5, 10, v4
    v_sub_u32 v5, v3, v5
    v_lshlrev_b32 v5, 4, v5
    v_add_u32 v5, s71, v5
    v_lshrrev_b32 v3, 4, v4
    v_mul_u32_u24 v3, s67, v3
    v_bfe_u32 v6, v4, 2, 2
    v_mul_u32_u24 v6, s68, v6
    v_and_b32 v4, 3, v4
    v_add3_u32 v3, v3, v6, v4
    v_add_u32 v3, s66, v3
    v_mul_u32_u24 v3, s58, v3
    v_add_u32 v22, v3, v5
    v_add_u32 v3, 64, v2
    v_mul_u32_u24 v4, 6554, v3
    v_lshrrev_b32 v4, 16, v4
    v_mul_u32_u24 v5, 10, v4
    v_sub_u32 v5, v3, v5
    v_lshlrev_b32 v5, 4, v5
    v_add_u32 v5, s71, v5
    v_lshrrev_b32 v3, 4, v4
    v_mul_u32_u24 v3, s67, v3
    v_bfe_u32 v6, v4, 2, 2
    v_mul_u32_u24 v6, s68, v6
    v_and_b32 v4, 3, v4
    v_add3_u32 v3, v3, v6, v4
    v_add_u32 v3, s66, v3
    v_mul_u32_u24 v3, s58, v3
    v_add_u32 v23, v3, v5
    v_add_u32 v3, 128, v2
    v_mul_u32_u24 v4, 6554, v3
    v_lshrrev_b32 v4, 16, v4
    v_mul_u32_u24 v5, 10, v4
    v_sub_u32 v5, v3, v5
    v_lshlrev_b32 v5, 4, v5
    v_add_u32 v5, s71, v5
    v_lshrrev_b32 v3, 4, v4
    v_mul_u32_u24 v3, s67, v3
    v_bfe_u32 v6, v4, 2, 2
    v_mul_u32_u24 v6, s68, v6
    v_and_b32 v4, 3, v4
    v_add3_u32 v3, v3, v6, v4
    v_add_u32 v3, s66, v3
    v_mul_u32_u24 v3, s58, v3
    v_add_u32 v24, v3, v5
    v_add_u32 v3, 192, v2
    v_mul_u32_u24 v4, 6554, v3
    v_lshrrev_b32 v4, 16, v4
    v_mul_u32_u24 v5, 10, v4
    v_sub_u32 v5, v3, v5
    v_lshlrev_b32 v5, 4, v5
    v_add_u32 v5, s71, v5
    v_lshrrev_b32 v3, 4, v4
    v_mul_u32_u24 v3, s67, v3
    v_bfe_u32 v6, v4, 2, 2
    v_mul_u32_u24 v6, s68, v6
    v_and_b32 v4, 3, v4
    v_add3_u32 v3, v3, v6, v4
    v_add_u32 v3, s66, v3
    v_mul_u32_u24 v3, s58, v3
    v_add_u32 v25, v3, v5
    v_add_u32 v3, 256, v2
    v_mul_u32_u24 v4, 6554, v3
    v_lshrrev_b32 v4, 16, v4
    v_mul_u32_u24 v5, 10, v4
    v_sub_u32 v5, v3, v5
    v_lshlrev_b32 v5, 4, v5
    v_add_u32 v5, s71, v5
    v_lshrrev_b32 v3, 4, v4
    v_mul_u32_u24 v3, s67, v3
    v_bfe_u32 v6, v4, 2, 2
    v_mul_u32_u24 v6, s68, v6
    v_and_b32 v4, 3, v4
    v_add3_u32 v3, v3, v6, v4
    v_add_u32 v3, s66, v3
    v_mul_u32_u24 v3, s58, v3
    v_add_u32 v26, v3, v5
    v_lshrrev_b32 v3, 2, v2
    v_mul_u32_u24 v3, 160, v3
    s_mul_i32 s72, s57, 5120
    s_add_u32 s72, s72, 147456
    v_add_u32 v3, s72, v3
    v_and_b32 v4, 3, v2
    v_lshl_add_u32 v27, v4, 4, v3
    v_lshl_add_u32 v28, v4, 3, v3
    v_lshlrev_b32 v29, 4, v2
    v_add_u32 v30, 4096, v29
    s_mov_b32 s40, s22
    s_mov_b32 s41, s23
    s_mov_b32 s42, 12750848
    s_mov_b32 s43, 0x20000
    s_cmp_eq_u32 s70, 0
    s_cselect_b32 s44, s16, s8
    s_cselect_b32 s45, s17, s9
    s_mov_b32 s46, 2211840
    s_cselect_b32 s46, s46, 819200
    s_mov_b32 s47, 0x20000
    s_waitcnt vmcnt(12)
    s_barrier
    s_add_u32 m0, s77, 98304
    s_nop 0
    buffer_load_dwordx4 v10, s[28:31], s74 offen  lds
    s_add_u32 m0, s77, 102400
    s_nop 0
    buffer_load_dwordx4 v11, s[28:31], s74 offen  lds
    s_add_u32 m0, s77, 106496
    s_nop 0
    buffer_load_dwordx4 v12, s[28:31], s74 offen  lds
    s_add_u32 m0, s77, 110592
    s_nop 0
    buffer_load_dwordx4 v13, s[28:31], s74 offen  lds
    s_add_u32 m0, s77, 114688
    s_nop 0
    buffer_load_dwordx4 v14, s[36:39], s76 offen  lds
    s_add_u32 m0, s77, 118784
    s_nop 0
    buffer_load_dwordx4 v15, s[32:35], s75 offen  lds
    s_add_u32 m0, s77, 122880
    s_nop 0
    buffer_load_dwordx4 v16, s[32:35], s75 offen  lds
    s_add_u32 m0, s77, 126976
    s_nop 0
    buffer_load_dwordx4 v17, s[32:35], s75 offen  lds
    s_add_u32 m0, s77, 131072
    s_nop 0
    buffer_load_dwordx4 v18, s[32:35], s75 offen  lds
    s_add_u32 m0, s77, 135168
    s_nop 0
    buffer_load_dwordx4 v19, s[32:35], s75 offen  lds
    s_add_u32 m0, s77, 139264
    s_nop 0
    buffer_load_dwordx4 v20, s[32:35], s75 offen  lds
    s_add_u32 m0, s77, 143360
    s_nop 0
    buffer_load_dwordx4 v21, s[32:35], s75 offen  lds
    s_add_u32 s74, s74, 128
    s_add_u32 s75, s75, 245760
    s_add_u32 s76, s76, s73
    s_add_u32 s79, s79, 1
    s_cmp_eq_u32 s79, 10
    s_cselect_b32 s79, 0, s79
    s_cselect_b32 s74, 0, s74
    s_cselect_b32 s75, 0, s75
    s_cselect_b32 s76, 0, s76
    s_waitcnt vmcnt(12)
    s_barrier
    s_add_u32 m0, s77, 0
    s_nop 0
    buffer_load_dwordx4 v10, s[28:31], s74 offen  lds
    s_add_u32 m0, s77, 4096
    s_nop 0
    buffer_load_dwordx4 v11, s[28:31], s74 offen  lds
    s_add_u32 m0, s77, 8192
    s_nop 0
    buffer_load_dwordx4 v12, s[28:31], s74 offen  lds
    s_add_u32 m0, s77, 12288
    s_nop 0
    buffer_load_dwordx4 v13, s[28:31], s74 offen  lds
    s_add_u32 m0, s77, 16384
    s_nop 0
    buffer_load_dwordx4 v14, s[36:39], s76 offen  lds
    s_add_u32 m0, s77, 20480
    s_nop 0
    buffer_load_dwordx4 v15, s[32:35], s75 offen  lds
    s_add_u32 m0, s77, 24576
    s_nop 0
    buffer_load_dwordx4 v16, s[32:35], s75 offen  lds
    s_add_u32 m0, s77, 28672
    s_nop 0
    buffer_load_dwordx4 v17, s[32:35], s75 offen  lds
    s_add_u32 m0, s77, 32768
    s_nop 0
    buffer_load_dwordx4 v18, s[32:35], s75 offen  lds
    s_add_u32 m0, s77, 36864
    s_nop 0
    buffer_load_dwordx4 v19, s[32:35], s75 offen  lds
    s_add_u32 m0, s77, 40960
    s_nop 0
    buffer_load_dwordx4 v20, s[32:35], s75 offen  lds
    s_add_u32 m0, s77, 45056
    s_nop 0
    buffer_load_dwordx4 v21, s[32:35], s75 offen  lds
    s_add_u32 s74, s74, 128
    s_add_u32 s75, s75, 245760
    s_add_u32 s76, s76, s73
    s_add_u32 s79, s79, 1
    s_cmp_eq_u32 s79, 10
    s_cselect_b32 s79, 0, s79
    s_cselect_b32 s74, 0, s74
    s_cselect_b32 s75, 0, s75
    s_cselect_b32 s76, 0, s76
    s_waitcnt vmcnt(12)
    s_barrier
    s_add_u32 m0, s77, 49152
    s_nop 0
    buffer_load_dwordx4 v10, s[28:31], s74 offen  lds
    s_add_u32 m0, s77, 53248
    s_nop 0
    buffer_load_dwordx4 v11, s[28:31], s74 offen  lds
    s_add_u32 m0, s77, 57344
    s_nop 0
    buffer_load_dwordx4 v12, s[28:31], s74 offen  lds
    s_add_u32 m0, s77, 61440
    s_nop 0
    buffer_load_dwordx4 v13, s[28:31], s74 offen  lds
    s_add_u32 m0, s77, 65536
    s_nop 0
    buffer_load_dwordx4 v14, s[36:39], s76 offen  lds
    s_add_u32 m0, s77, 69632
    s_nop 0
    buffer_load_dwordx4 v15, s[32:35], s75 offen  lds
    s_add_u32 m0, s77, 73728
    s_nop 0
    buffer_load_dwordx4 v16, s[32:35], s75 offen  lds
    s_add_u32 m0, s77, 77824
    s_nop 0
    buffer_load_dwordx4 v17, s[32:35], s75 offen  lds
    s_add_u32 m0, s77, 81920
    s_nop 0
    buffer_load_dwordx4 v18, s[32:35], s75 offen  lds
    s_add_u32 m0, s77, 86016
    s_nop 0
    buffer_load_dwordx4 v19, s[32:35], s75 offen  lds
    s_add_u32 m0, s77, 90112
    s_nop 0
    buffer_load_dwordx4 v20, s[32:35], s75 offen  lds
    s_add_u32 m0, s77, 94208
    s_nop 0
    buffer_load_dwordx4 v21, s[32:35], s75 offen  lds
    s_add_u32 s74, s74, 128
    s_add_u32 s75, s75, 245760
    s_add_u32 s76, s76, s73
    s_add_u32 s79, s79, 1
    s_cmp_eq_u32 s79, 10
    s_cselect_b32 s79, 0, s79
    s_cselect_b32 s74, 0, s74
    s_cselect_b32 s75, 0, s75
    s_cselect_b32 s76, 0, s76
    s_waitcnt vmcnt(12)
    s_barrier
    s_add_u32 m0, s77, 98304
    s_nop 0
    buffer_load_dwordx4 v10, s[28:31], s74 offen  lds
    s_add_u32 m0, s77, 102400
    s_nop 0
    buffer_load_dwordx4 v11, s[28:31], s74 offen  lds
    s_add_u32 m0, s77, 106496
    s_nop 0
    buffer_load_dwordx4 v12, s[28:31], s74 offen  lds
    s_add_u32 m0, s77, 110592
    s_nop 0
    buffer_load_dwordx4 v13, s[28:31], s74 offen  lds
    s_add_u32 m0, s77, 114688
    s_nop 0
    buffer_load_dwordx4 v14, s[36:39], s76 offen  lds
    s_add_u32 m0, s77, 118784
    s_nop 0
    buffer_load_dwordx4 v15, s[32:35], s75 offen  lds
    s_add_u32 m0, s77, 122880
    s_nop 0
    buffer_load_dwordx4 v16, s[32:35], s75 offen  lds
    s_add_u32 m0, s77, 126976
    s_nop 0
    buffer_load_dwordx4 v17, s[32:35], s75 offen  lds
    s_add_u32 m0, s77, 131072
    s_nop 0
    buffer_load_dwordx4 v18, s[32:35], s75 offen  lds
    s_add_u32 m0, s77, 135168
    s_nop 0
    buffer_load_dwordx4 v19, s[32:35], s75 offen  lds
    s_add_u32 m0, s77, 139264
    s_nop 0
    buffer_load_dwordx4 v20, s[32:35], s75 offen  lds
    s_add_u32 m0, s77, 143360
    s_nop 0
    buffer_load_dwordx4 v21, s[32:35], s75 offen  lds
    s_add_u32 s74, s74, 128
    s_add_u32 s75, s75, 245760
    s_add_u32 s76, s76, s73
    s_add_u32 s79, s79, 1
    s_cmp_eq_u32 s79, 10
    s_cselect_b32 s79, 0, s79
    s_cselect_b32 s74, 0, s74
    s_cselect_b32 s75, 0, s75
    s_cselect_b32 s76, 0, s76
    s_waitcnt vmcnt(12)
    s_barrier
    s_add_u32 m0, s77, 0
    s_nop 0
    buffer_load_dwordx4 v10, s[28:31], s74 offen  lds
    s_add_u32 m0, s77, 4096
    s_nop 0
    buffer_load_dwordx4 v11, s[28:31], s74 offen  lds
    s_add_u32 m0, s77, 8192
    s_nop 0
    buffer_load_dwordx4 v12, s[28:31], s74 offen  lds
    s_add_u32 m0, s77, 12288
    s_nop 0
    buffer_load_dwordx4 v13, s[28:31], s74 offen  lds
    s_add_u32 m0, s77, 16384
    s_nop 0
    buffer_load_dwordx4 v14, s[36:39], s76 offen  lds
    s_add_u32 m0, s77, 20480
    s_nop 0
    buffer_load_dwordx4 v15, s[32:35], s75 offen  lds
    s_add_u32 m0, s77, 24576
    s_nop 0
    buffer_load_dwordx4 v16, s[32:35], s75 offen  lds
    s_add_u32 m0, s77, 28672
    s_nop 0
    buffer_load_dwordx4 v17, s[32:35], s75 offen  lds
    s_add_u32 m0, s77, 32768
    s_nop 0
    buffer_load_dwordx4 v18, s[32:35], s75 offen  lds
    s_add_u32 m0, s77, 36864
    s_nop 0
    buffer_load_dwordx4 v19, s[32:35], s75 offen  lds
    s_add_u32 m0, s77, 40960
    s_nop 0
    buffer_load_dwordx4 v20, s[32:35], s75 offen  lds
    s_add_u32 m0, s77, 45056
    s_nop 0
    buffer_load_dwordx4 v21, s[32:35], s75 offen  lds
    s_add_u32 s74, s74, 128
    s_add_u32 s75, s75, 245760
    s_add_u32 s76, s76, s73
    s_add_u32 s79, s79, 1
    s_cmp_eq_u32 s79, 10
    s_cselect_b32 s79, 0, s79
    s_cselect_b32 s74, 0, s74
    s_cselect_b32 s75, 0, s75
    s_cselect_b32 s76, 0, s76
    s_waitcnt vmcnt(12)
    s_barrier
    s_add_u32 m0, s77, 49152
    s_nop 0
    buffer_load_dwordx4 v10, s[28:31], s74 offen  lds
    s_add_u32 m0, s77, 53248
    s_nop 0
    buffer_load_dwordx4 v11, s[28:31], s74 offen  lds
    s_add_u32 m0, s77, 57344
    s_nop 0
    buffer_load_dwordx4 v12, s[28:31], s74 offen  lds
    s_add_u32 m0, s77, 61440
    s_nop 0
    buffer_load_dwordx4 v13, s[28:31], s74 offen  lds
    s_add_u32 m0, s77, 65536
    s_nop 0
    buffer_load_dwordx4 v14, s[36:39], s76 offen  lds
    s_add_u32 m0, s77, 69632
    s_nop 0
    buffer_load_dwordx4 v15, s[32:35], s75 offen  lds
    s_add_u32 m0, s77, 73728
    s_nop 0
    buffer_load_dwordx4 v16, s[32:35], s75 offen  lds
    s_add_u32 m0, s77, 77824
    s_nop 0
    buffer_load_dwordx4 v17, s[32:35], s75 offen  lds
    s_add_u32 m0, s77, 81920
    s_nop 0
    buffer_load_dwordx4 v18, s[32:35], s75 offen  lds
    s_add_u32 m0, s77, 86016
    s_nop 0
    buffer_load_dwordx4 v19, s[32:35], s75 offen  lds
    s_add_u32 m0, s77, 90112
    s_nop 0
    buffer_load_dwordx4 v20, s[32:35], s75 offen  lds
    s_add_u32 m0, s77, 94208
    s_nop 0
    buffer_load_dwordx4 v21, s[32:35], s75 offen  lds
    s_add_u32 s74, s74, 128
    s_add_u32 s75, s75, 245760
    s_add_u32 s76, s76, s73
    s_add_u32 s79, s79, 1
    s_cmp_eq_u32 s79, 10
    s_cselect_b32 s79, 0, s79
    s_cselect_b32 s74, 0, s74
    s_cselect_b32 s75, 0, s75
    s_cselect_b32 s76, 0, s76
    s_waitcnt vmcnt(12)
    s_barrier
    s_add_u32 m0, s77, 98304
    s_nop 0
    buffer_load_dwordx4 v10, s[28:31], s74 offen  lds
    s_add_u32 m0, s77, 102400
    s_nop 0
    buffer_load_dwordx4 v11, s[28:31], s74 offen  lds
    s_add_u32 m0, s77, 106496
    s_nop 0
    buffer_load_dwordx4 v12, s[28:31], s74 offen  lds
    s_add_u32 m0, s77, 110592
    s_nop 0
    buffer_load_dwordx4 v13, s[28:31], s74 offen  lds
    s_add_u32 m0, s77, 114688
    s_nop 0
    buffer_load_dwordx4 v14, s[36:39], s76 offen  lds
    s_add_u32 m0, s77, 118784
    s_nop 0
    buffer_load_dwordx4 v15, s[32:35], s75 offen  lds
    s_add_u32 m0, s77, 122880
    s_nop 0
    buffer_load_dwordx4 v16, s[32:35], s75 offen  lds
    s_add_u32 m0, s77, 126976
    s_nop 0
    buffer_load_dwordx4 v17, s[32:35], s75 offen  lds
    s_add_u32 m0, s77, 131072
    s_nop 0
    buffer_load_dwordx4 v18, s[32:35], s75 offen  lds
    s_add_u32 m0, s77, 135168
    s_nop 0
    buffer_load_dwordx4 v19, s[32:35], s75 offen  lds
    s_add_u32 m0, s77, 139264
    s_nop 0
    buffer_load_dwordx4 v20, s[32:35], s75 offen  lds
    s_add_u32 m0, s77, 143360
    s_nop 0
    buffer_load_dwordx4 v21, s[32:35], s75 offen  lds
    s_add_u32 s74, s74, 128
    s_add_u32 s75, s75, 245760
    s_add_u32 s76, s76, s73
    s_add_u32 s79, s79, 1
    s_cmp_eq_u32 s79, 10
    s_cselect_b32 s79, 0, s79
    s_cselect_b32 s74, 0, s74
    s_cselect_b32 s75, 0, s75
    s_cselect_b32 s76, 0, s76
    s_waitcnt vmcnt(12)
    s_barrier
    s_add_u32 m0, s77, 0
    s_nop 0
    buffer_load_dwordx4 v10, s[28:31], s74 offen  lds
    s_add_u32 m0, s77, 4096
    s_nop 0
    buffer_load_dwordx4 v11, s[28:31], s74 offen  lds
    s_add_u32 m0, s77, 8192
    s_nop 0
    buffer_load_dwordx4 v12, s[28:31], s74 offen  lds
    s_add_u32 m0, s77, 12288
    s_nop 0
    buffer_load_dwordx4 v13, s[28:31], s74 offen  lds
    s_add_u32 m0, s77, 16384
    s_nop 0
    buffer_load_dwordx4 v14, s[36:39], s76 offen  lds
    s_add_u32 m0, s77, 20480
    s_nop 0
    buffer_load_dwordx4 v15, s[32:35], s75 offen  lds
    s_add_u32 m0, s77, 24576
    s_nop 0
    buffer_load_dwordx4 v16, s[32:35], s75 offen  lds
    s_add_u32 m0, s77, 28672
    s_nop 0
    buffer_load_dwordx4 v17, s[32:35], s75 offen  lds
    s_add_u32 m0, s77, 32768
    s_nop 0
    buffer_load_dwordx4 v18, s[32:35], s75 offen  lds
    s_add_u32 m0, s77, 36864
    s_nop 0
    buffer_load_dwordx4 v19, s[32:35], s75 offen  lds
    s_add_u32 m0, s77, 40960
    s_nop 0
    buffer_load_dwordx4 v20, s[32:35], s75 offen  lds
    s_add_u32 m0, s77, 45056
    s_nop 0
    buffer_load_dwordx4 v21, s[32:35], s75 offen  lds
    s_add_u32 s74, s74, 128
    s_add_u32 s75, s75, 245760
    s_add_u32 s76, s76, s73
    s_add_u32 s79, s79, 1
    s_cmp_eq_u32 s79, 10
    s_cselect_b32 s79, 0, s79
    s_cselect_b32 s74, 0, s74
    s_cselect_b32 s75, 0, s75
    s_cselect_b32 s76, 0, s76
    s_waitcnt vmcnt(12)
    s_barrier
    s_cmp_eq_u32 s63, 0
    s_cbranch_scc1 L_nounit_ld_A
    s_add_u32 m0, s72, 0
    s_nop 0
    buffer_load_dwordx4 v22, s[44:47], 0 offen nt lds
    s_add_u32 m0, s72, 1024
    s_nop 0
    buffer_load_dwordx4 v23, s[44:47], 0 offen nt lds
    s_add_u32 m0, s72, 2048
    s_nop 0
    buffer_load_dwordx4 v24, s[44:47], 0 offen nt lds
    s_add_u32 m0, s72, 3072
    s_nop 0
    buffer_load_dwordx4 v25, s[44:47], 0 offen nt lds
    s_add_u32 m0, s72, 4096
    s_nop 0
    buffer_load_dwordx4 v26, s[44:47], 0 offen nt lds
L_nounit_ld_A:
    s_cmp_eq_u32 s63, 0
    s_cbranch_scc1 L_w8a_A
    s_waitcnt vmcnt(5)
    s_branch L_w8b_A
L_w8a_A:
    s_waitcnt vmcnt(0)
L_w8b_A:
    s_barrier
    s_cmp_eq_u32 s57, 3
    s_cbranch_scc0 L_nok2pf_A
    v_mov_b32 v34, v2
    s_getpc_b64 s[84:85]
L_pc_k2pfA:
    s_add_u32 s84, s84, gm_k2_kernel-L_pc_k2pfA
    s_addc_u32 s85, s85, 0
    s_lshr_b32 s86, s2, 3
    s_cmp_lt_u32 s86, 2
    s_cbranch_scc0 L_pfskip_k2pfA
    s_lshl_b32 s86, s86, 13
    v_lshlrev_b32 v34, 7, v34
    v_add_u32 v34, s86, v34
    v_min_u32 v34, L_k2_end-gm_k2_kernel, v34
    global_load_dword v255, v34, s[84:85]
L_pfskip_k2pfA:
L_nok2pf_A:
    s_waitcnt vmcnt(0) lgkmcnt(0)
    s_cmp_eq_u32 s63, 0
    s_cbranch_scc1 L_nounit_A
    ds_read_b64_tr_b16 v[84:85], v27 offset:0
    ds_read_b64_tr_b16 v[86:87], v27 offset:2560
    ds_read_b64_tr_b16 v[88:89], v27 offset:8
    ds_read_b64_tr_b16 v[90:91], v27 offset:2568
    ds_read_b64_tr_b16 v[92:93], v27 offset:64
    ds_read_b64_tr_b16 v[94:95], v27 offset:2624
    ds_read_b64_tr_b16 v[96:97], v27 offset:72
    ds_read_b64_tr_b16 v[98:99], v27 offset:2632
    ds_read_b64_tr_b16 v[100:101], v28 offset:128
    ds_read_b64_tr_b16 v[102:103], v28 offset:2688
    s_waitcnt lgkmcnt(8)
    buffer_store_dwordx4 v[84:87], v29, s[40:43], s69 offen offset:0 sc1
    s_waitcnt lgkmcnt(6)
    buffer_store_dwordx4 v[88:91], v29, s[40:43], s69 offen offset:1024 sc1
    s_waitcnt lgkmcnt(4)
    buffer_store_dwordx4 v[92:95], v29, s[40:43], s69 offen offset:2048 sc1
    s_waitcnt lgkmcnt(2)
    buffer_store_dwordx4 v[96:99], v29, s[40:43], s69 offen offset:3072 sc1
    s_waitcnt lgkmcnt(0)
    buffer_store_dwordx4 v[100:103], v30, s[40:43], s69 offen sc1
L_nounit_A:
    s_endpgm
L_consumer:
    s_cmp_eq_u32 s25, 0
    s_cbranch_scc0 L_cons_F
    s_waitcnt lgkmcnt(0)
    s_and_b32 s55, s24, 1
    s_lshr_b32 s56, s24, 1
    v_and_b32 v3, 15, v2
    v_lshrrev_b32 v4, 4, v2
    v_lshrrev_b32 v5, 1, v3
    v_xor_b32 v5, v5, v4
    v_lshlrev_b32 v5, 4, v5
    v_lshl_add_u32 v5, v3, 7, v5
    v_mov_b32 v224, v5
    v_xor_b32 v225, 64, v224
    v_lshrrev_b32 v5, 5, v2
    v_lshlrev_b32 v5, 4, v5
    v_bfe_u32 v6, v2, 4, 1
    v_lshl_add_u32 v5, v6, 2, v5
    v_bfe_u32 v6, v2, 2, 2
    v_add_u32 v5, v5, v6
    v_mul_u32_u24 v5, 480, v5
    s_mul_i32 s57, s55, 80
    s_add_u32 s57, s57, 18432
    v_add_u32 v5, s57, v5
    v_and_b32 v6, 3, v2
    v_lshl_add_u32 v226, v6, 3, v5
    v_and_b32 v7, 1, v6
    v_mul_u32_u24 v7, 40, v7
    v_add_u32 v7, v7, v5
    v_lshrrev_b32 v6, 1, v6
    v_mul_u32_u24 v6, 160, v6
    v_add3_u32 v227, v7, v6, 32
    v_add_u32 v228, 352, v7
    v_lshlrev_b32 v5, 2, v4
    v_sub_u32 v5, v3, v5
    s_mov_b32 s58, 0xf149f2ca
    v_mov_b32 v8, s58
    s_or_b32 s59, s26, s56
    s_cmp_eq_u32 s59, 0
    s_cselect_b64 s[60:61], -1, 0
    v_subrev_u32 v6, 0, v5
    v_and_b32 v7, 1, v6
    v_cmp_eq_u32 s[62:63], 0, v7
    v_cmp_ge_i32 s[64:65], v6, 0
    s_nop 3
    s_and_b64 s[66:67], s[62:63], s[64:65]
    s_andn2_b64 s[68:69], s[62:63], s[64:65]
    v_cndmask_b32 v236, v8, 0, s[66:67]
    v_cndmask_b32 v232, v8, 0, s[68:69]
    v_cndmask_b32 v240, v232, v8, s[60:61]
    v_subrev_u32 v6, 1, v5
    v_and_b32 v7, 1, v6
    v_cmp_eq_u32 s[62:63], 0, v7
    v_cmp_ge_i32 s[64:65], v6, 0
    s_nop 3
    s_and_b64 s[66:67], s[62:63], s[64:65]
    s_andn2_b64 s[68:69], s[62:63], s[64:65]
    v_cndmask_b32 v237, v8, 0, s[66:67]
    v_cndmask_b32 v233, v8, 0, s[68:69]
    v_cndmask_b32 v241, v233, v8, s[60:61]
    v_subrev_u32 v6, 2, v5
    v_and_b32 v7, 1, v6
    v_cmp_eq_u32 s[62:63], 0, v7
    v_cmp_ge_i32 s[64:65], v6, 0
    s_nop 3
    s_and_b64 s[66:67], s[62:63], s[64:65]
    s_andn2_b64 s[68:69], s[62:63], s[64:65]
    v_cndmask_b32 v238, v8, 0, s[66:67]
    v_cndmask_b32 v234, v8, 0, s[68:69]
    v_cndmask_b32 v242, v234, v8, s[60:61]
    v_subrev_u32 v6, 3, v5
    v_and_b32 v7, 1, v6
    v_cmp_eq_u32 s[62:63], 0, v7
    v_cmp_ge_i32 s[64:65], v6, 0
    s_nop 3
    s_and_b64 s[66:67], s[62:63], s[64:65]
    s_andn2_b64 s[68:69], s[62:63], s[64:65]
    v_cndmask_b32 v239, v8, 0, s[66:67]
    v_cndmask_b32 v235, v8, 0, s[68:69]
    v_cndmask_b32 v243, v235, v8, s[60:61]
    v_and_b32 v7, 1, v3
    v_cmp_eq_u32 s[62:63], 0, v7
    v_mov_b32 v6, 0x1000c0c
    v_mov_b32 v9, 0xc0c0100
    v_cndmask_b32 v9, v6, v9, s[62:63]
    v_sub_u32 v6, v5, v7
    v_cmp_ge_i32 s[64:65], v6, 0
    v_mov_b32 v6, 0x0c0c0c0c
    s_nop 0
    v_cndmask_b32 v244, v9, v6, s[64:65]
    v_cndmask_b32 v246, v6, v9, s[64:65]
    v_mov_b32 v6, 0x3020c0c
    v_mov_b32 v9, 0xc0c0302
    v_cndmask_b32 v9, v6, v9, s[62:63]
    v_sub_u32 v6, v5, v7
    v_subrev_u32 v6, 2, v6
    v_cmp_ge_i32 s[64:65], v6, 0
    v_mov_b32 v6, 0x0c0c0c0c
    s_nop 0
    v_cndmask_b32 v245, v9, v6, s[64:65]
    v_cndmask_b32 v247, v6, v9, s[64:65]
    v_lshlrev_b32 v248, 4, v2
    s_lshl_b32 s57, s55, 13
    s_add_u32 s57, s57, 98304
    v_add_u32 v249, s57, v248
    v_lshrrev_b32 v250, 1, v248
    v_add_u32 v250, s57, v250
    s_lshl_b32 s57, s55, 3
    s_add_u32 s57, s57, 162816
    v_mov_b32 v251, s57
    v_mov_b32 v252, 0
    v_mov_b32 v253, 0
    ds_write_b64 v251, v[252:253]
    v_mov_b32 v0, 0
    v_mov_b32 v1, 0
    v_mov_b32 v2, 0
    v_mov_b32 v3, 0
    v_mov_b32 v4, 0
    v_mov_b32 v5, 0
    v_mov_b32 v6, 0
    v_mov_b32 v7, 0
    v_mov_b32 v8, 0
    v_mov_b32 v9, 0
    v_mov_b32 v10, 0
    v_mov_b32 v11, 0
    v_mov_b32 v12, 0
    v_mov_b32 v13, 0
    v_mov_b32 v14, 0
    v_mov_b32 v15, 0
    v_mov_b32 v16, 0
    v_mov_b32 v17, 0
    v_mov_b32 v18, 0
    v_mov_b32 v19, 0
    v_mov_b32 v20, 0
    v_mov_b32 v21, 0
    v_mov_b32 v22, 0
    v_mov_b32 v23, 0
    v_mov_b32 v24, 0
    v_mov_b32 v25, 0
    v_mov_b32 v26, 0
    v_mov_b32 v27, 0
    v_mov_b32 v28, 0
    v_mov_b32 v29, 0
    v_mov_b32 v30, 0
    v_mov_b32 v31, 0
    v_mov_b32 v32, 0
    v_mov_b32 v33, 0
    v_mov_b32 v34, 0
    v_mov_b32 v35, 0
    v_mov_b32 v36, 0
    v_mov_b32 v37, 0
    v_mov_b32 v38, 0
    v_mov_b32 v39, 0
    v_mov_b32 v40, 0
    v_mov_b32 v41, 0
    v_mov_b32 v42, 0
    v_mov_b32 v43, 0
    v_mov_b32 v44, 0
    v_mov_b32 v45, 0
    v_mov_b32 v46, 0
    v_mov_b32 v47, 0
    v_mov_b32 v48, 0
    v_mov_b32 v49, 0
    v_mov_b32 v50, 0
    v_mov_b32 v51, 0
    v_mov_b32 v52, 0
    v_mov_b32 v53, 0
    v_mov_b32 v54, 0
    v_mov_b32 v55, 0
    v_mov_b32 v56, 0
    v_mov_b32 v57, 0
    v_mov_b32 v58, 0
    v_mov_b32 v59, 0
    v_mov_b32 v60, 0
    v_mov_b32 v61, 0
    v_mov_b32 v62, 0
    v_mov_b32 v63, 0
    v_mov_b32 v64, 0
    v_mov_b32 v65, 0
    v_mov_b32 v66, 0
    v_mov_b32 v67, 0
    v_mov_b32 v68, 0
    v_mov_b32 v69, 0
    v_mov_b32 v70, 0
    v_mov_b32 v71, 0
    v_mov_b32 v72, 0
    v_mov_b32 v73, 0
    v_mov_b32 v74, 0
    v_mov_b32 v75, 0
    v_mov_b32 v76, 0
    v_mov_b32 v77, 0
    v_mov_b32 v78, 0
    v_mov_b32 v79, 0
    v_mov_b32 v80, 0
    v_mov_b32 v81, 0
    v_mov_b32 v82, 0
    v_mov_b32 v83, 0
    v_mov_b32 v84, 0
    v_mov_b32 v85, 0
    v_mov_b32 v86, 0
    v_mov_b32 v87, 0
    v_mov_b32 v88, 0
    v_mov_b32 v89, 0
    v_mov_b32 v90, 0
    v_mov_b32 v91, 0
    v_mov_b32 v92, 0
    v_mov_b32 v93, 0
    v_mov_b32 v94, 0
    v_mov_b32 v95, 0
    v_mov_b32 v96, 0
    v_mov_b32 v97, 0
    v_mov_b32 v98, 0
    v_mov_b32 v99, 0
    v_mov_b32 v100, 0
    v_mov_b32 v101, 0
    v_mov_b32 v102, 0
    v_mov_b32 v103, 0
    v_mov_b32 v104, 0
    v_mov_b32 v105, 0
    v_mov_b32 v106, 0
    v_mov_b32 v107, 0
    v_mov_b32 v108, 0
    v_mov_b32 v109, 0
    v_mov_b32 v110, 0
    v_mov_b32 v111, 0
    v_mov_b32 v112, 0
    v_mov_b32 v113, 0
    v_mov_b32 v114, 0
    v_mov_b32 v115, 0
    v_mov_b32 v116, 0
    v_mov_b32 v117, 0
    v_mov_b32 v118, 0
    v_mov_b32 v119, 0
    v_mov_b32 v120, 0
    v_mov_b32 v121, 0
    v_mov_b32 v122, 0
    v_mov_b32 v123, 0
    v_mov_b32 v124, 0
    v_mov_b32 v125, 0
    v_mov_b32 v126, 0
    v_mov_b32 v127, 0
    v_mov_b32 v128, 0
    v_mov_b32 v129, 0
    v_mov_b32 v130, 0
    v_mov_b32 v131, 0
    v_mov_b32 v132, 0
    v_mov_b32 v133, 0
    v_mov_b32 v134, 0
    v_mov_b32 v135, 0
    v_mov_b32 v136, 0
    v_mov_b32 v137, 0
    v_mov_b32 v138, 0
    v_mov_b32 v139, 0
    v_mov_b32 v140, 0
    v_mov_b32 v141, 0
    v_mov_b32 v142, 0
    v_mov_b32 v143, 0
    v_mov_b32 v144, 0
    v_mov_b32 v145, 0
    v_mov_b32 v146, 0
    v_mov_b32 v147, 0
    v_mov_b32 v148, 0
    v_mov_b32 v149, 0
    v_mov_b32 v150, 0
    v_mov_b32 v151, 0
    s_lshl_b32 s65, s26, 3
    s_lshl_b32 s66, s56, 2
    s_add_u32 s65, s65, s66
    s_mul_i32 s66, s65, 20
    s_lshl_b32 s67, s27, 1
    s_add_u32 s67, s67, s55
    s_add_u32 s66, s66, s67
    s_lshl_b32 s66, s66, 10
    s_add_u32 s66, s66, 7077888
    s_and_b32 s67, s27, 1
    s_lshl_b32 s67, s67, 1
    s_add_u32 s67, s67, s65
    s_mul_i32 s67, s67, 20
    s_lshr_b32 s68, s27, 1
    s_add_u32 s67, s67, s68
    s_add_u32 s67, s67, 16
    s_lshl_b32 s67, s67, 10
    s_lshl_b32 s68, s55, 9
    s_add_u32 s67, s67, s68
    s_add_u32 s67, s67, 7077888
    s_mov_b32 s40, s22
    s_mov_b32 s41, s23
    s_mov_b32 s42, 12750848
    s_mov_b32 s43, 0x20000
    s_mov_b32 s28, s4
    s_mov_b32 s29, s5
    s_mov_b32 s30, 2621440
    s_mov_b32 s31, 0x20000
    s_mov_b32 s32, s6
    s_mov_b32 s33, s7
    s_mov_b32 s34, 2457600
    s_mov_b32 s35, 0x20000
    s_waitcnt lgkmcnt(0)
    s_barrier
    s_cmp_eq_u32 s56, 0
    s_cbranch_scc0 L_attn_th1
    ds_read_b64_tr_b16 v[152:153], v226 offset:0
    ds_read_b64_tr_b16 v[154:155], v226 offset:3840
    ds_read_b64_tr_b16 v[156:157], v226 offset:40
    ds_read_b64_tr_b16 v[158:159], v226 offset:3880
    ds_read_b128 v[184:187], v224 offset:0
    ds_read_b64_tr_b16 v[160:161], v226 offset:160
    ds_read_b64_tr_b16 v[162:163], v226 offset:4000
    ds_read_b128 v[188:191], v224 offset:2048
    ds_read_b128 v[192:195], v224 offset:4096
    ds_read_b128 v[196:199], v224 offset:6144
    ds_read_b64_tr_b16 v[164:165], v226 offset:200
    ds_read_b64_tr_b16 v[166:167], v226 offset:4040
    ds_read_b128 v[200:203], v224 offset:8192
    ds_read_b64_tr_b16 v[168:169], v227 offset:0
    ds_read_b64_tr_b16 v[170:171], v227 offset:3840
    ds_read_b64_tr_b16 v[172:173], v226 offset:320
    ds_read_b64_tr_b16 v[174:175], v226 offset:4160
    ds_read_b64_tr_b16 v[176:177], v226 offset:360
    ds_read_b64_tr_b16 v[178:179], v226 offset:4200
    s_mov_b32 s52, 0
    s_mov_b32 s53, 0
    s_mov_b32 s51, 4294868992
L_loop_A0:
    s_waitcnt lgkmcnt(6)
    v_mfma_f32_16x16x32_bf16 v[0:3], v[152:155], v[188:191], v[0:3]
    ds_read_b64_tr_b16 v[180:181], v228 offset:0
    v_mfma_f32_16x16x32_bf16 v[4:7], v[152:155], v[192:195], v[4:7]
    ds_read_b64_tr_b16 v[182:183], v228 offset:3840
    v_mfma_f32_16x16x32_bf16 v[8:11], v[152:155], v[196:199], v[8:11]
    ds_read_b128 v[204:207], v225 offset:0
    v_mfma_f32_16x16x32_bf16 v[12:15], v[152:155], v[200:203], v[12:15]
    ds_read_b128 v[208:211], v225 offset:2048
    v_mfma_f32_16x16x32_bf16 v[16:19], v[156:159], v[188:191], v[16:19]
    ds_read_b64_tr_b16 v[152:153], v226 offset:15360
    v_mfma_f32_16x16x32_bf16 v[20:23], v[156:159], v[192:195], v[20:23]
    ds_read_b64_tr_b16 v[154:155], v226 offset:19200
    v_mfma_f32_16x16x32_bf16 v[24:27], v[156:159], v[196:199], v[24:27]
    ds_read_b128 v[212:215], v225 offset:4096
    v_mfma_f32_16x16x32_bf16 v[28:31], v[156:159], v[200:203], v[28:31]
    ds_read_b128 v[216:219], v225 offset:6144
    v_mfma_f32_16x16x32_bf16 v[32:35], v[160:163], v[184:187], v[32:35]
    ds_read_b64_tr_b16 v[156:157], v226 offset:15400
    v_mfma_f32_16x16x32_bf16 v[36:39], v[160:163], v[188:191], v[36:39]
    ds_read_b64_tr_b16 v[158:159], v226 offset:19240
    v_mfma_f32_16x16x32_bf16 v[40:43], v[160:163], v[192:195], v[40:43]
    ds_read_b128 v[220:223], v225 offset:8192
    v_mfma_f32_16x16x32_bf16 v[44:47], v[160:163], v[196:199], v[44:47]
    v_mfma_f32_16x16x32_bf16 v[48:51], v[160:163], v[200:203], v[48:51]
    v_mfma_f32_16x16x32_bf16 v[52:55], v[164:167], v[184:187], v[52:55]
    ds_read_b64_tr_b16 v[160:161], v226 offset:15520
    v_mfma_f32_16x16x32_bf16 v[56:59], v[164:167], v[188:191], v[56:59]
    ds_read_b64_tr_b16 v[162:163], v226 offset:19360
    v_mfma_f32_16x16x32_bf16 v[60:63], v[164:167], v[192:195], v[60:63]
    v_mfma_f32_16x16x32_bf16 v[64:67], v[164:167], v[196:199], v[64:67]
    v_mfma_f32_16x16x32_bf16 v[68:71], v[164:167], v[200:203], v[68:71]
    s_waitcnt lgkmcnt(15)
    v_mfma_f32_16x16x32_bf16 v[72:75], v[168:171], v[184:187], v[72:75]
    ds_read_b64_tr_b16 v[164:165], v226 offset:15560
    v_mfma_f32_16x16x32_bf16 v[76:79], v[168:171], v[188:191], v[76:79]
    ds_read_b64_tr_b16 v[166:167], v226 offset:19400
    v_mfma_f32_16x16x32_bf16 v[80:83], v[168:171], v[192:195], v[80:83]
    v_mfma_f32_16x16x32_bf16 v[84:87], v[168:171], v[196:199], v[84:87]
    v_mfma_f32_16x16x32_bf16 v[88:91], v[168:171], v[200:203], v[88:91]
    v_mfma_f32_16x16x32_bf16 v[96:99], v[188:191], v[172:175], v[96:99]
    ds_read_b64_tr_b16 v[168:169], v227 offset:15360
    v_mfma_f32_16x16x32_bf16 v[100:103], v[192:195], v[172:175], v[100:103]
    ds_read_b64_tr_b16 v[170:171], v227 offset:19200
    v_mfma_f32_16x16x32_bf16 v[104:107], v[196:199], v[172:175], v[104:107]
    v_mfma_f32_16x16x32_bf16 v[108:111], v[200:203], v[172:175], v[108:111]
    s_waitcnt lgkmcnt(15)
    v_mfma_f32_16x16x32_bf16 v[116:119], v[188:191], v[176:179], v[116:119]
    ds_read_b64_tr_b16 v[172:173], v226 offset:15680
    v_mfma_f32_16x16x32_bf16 v[120:123], v[192:195], v[176:179], v[120:123]
    ds_read_b64_tr_b16 v[174:175], v226 offset:19520
    v_mfma_f32_16x16x32_bf16 v[124:127], v[196:199], v[176:179], v[124:127]
    v_mfma_f32_16x16x32_bf16 v[128:131], v[200:203], v[176:179], v[128:131]
    v_mfma_f32_16x16x32_bf16 v[136:139], v[188:191], v[180:183], v[136:139]
    ds_read_b64_tr_b16 v[176:177], v226 offset:15720
    v_mfma_f32_16x16x32_bf16 v[140:143], v[192:195], v[180:183], v[140:143]
    ds_read_b64_tr_b16 v[178:179], v226 offset:19560
    s_add_u32 s53, s53, 49152
    s_cmp_eq_u32 s53, 147456
    v_mfma_f32_16x16x32_bf16 v[144:147], v[196:199], v[180:183], v[144:147]
    s_cselect_b32 s54, s51, 49152
    s_cselect_b32 s53, 0, s53
    v_mfma_f32_16x16x32_bf16 v[148:151], v[200:203], v[180:183], v[148:151]
    s_waitcnt lgkmcnt(10)
    v_mfma_f32_16x16x32_bf16 v[0:3], v[152:155], v[208:211], v[0:3]
    ds_read_b64_tr_b16 v[180:181], v228 offset:15360
    v_mfma_f32_16x16x32_bf16 v[4:7], v[152:155], v[212:215], v[4:7]
    ds_read_b64_tr_b16 v[182:183], v228 offset:19200
    v_mfma_f32_16x16x32_bf16 v[8:11], v[152:155], v[216:219], v[8:11]
    v_add_u32 v226, s54, v226
    v_mfma_f32_16x16x32_bf16 v[12:15], v[152:155], v[220:223], v[12:15]
    v_add_u32 v224, s54, v224
    v_mfma_f32_16x16x32_bf16 v[16:19], v[156:159], v[208:211], v[16:19]
    v_add_u32 v225, s54, v225
    v_mfma_f32_16x16x32_bf16 v[20:23], v[156:159], v[212:215], v[20:23]
    v_add_u32 v227, s54, v227
    v_mfma_f32_16x16x32_bf16 v[24:27], v[156:159], v[216:219], v[24:27]
    v_add_u32 v228, s54, v228
    v_mfma_f32_16x16x32_bf16 v[28:31], v[156:159], v[220:223], v[28:31]
    s_waitcnt lgkmcnt(0)
    s_barrier
    v_mfma_f32_16x16x32_bf16 v[32:35], v[160:163], v[204:207], v[32:35]
    ds_read_b64_tr_b16 v[152:153], v226 offset:0
    v_mfma_f32_16x16x32_bf16 v[36:39], v[160:163], v[208:211], v[36:39]
    ds_read_b64_tr_b16 v[154:155], v226 offset:3840
    v_mfma_f32_16x16x32_bf16 v[40:43], v[160:163], v[212:215], v[40:43]
    ds_read_b64_tr_b16 v[156:157], v226 offset:40
    v_mfma_f32_16x16x32_bf16 v[44:47], v[160:163], v[216:219], v[44:47]
    ds_read_b64_tr_b16 v[158:159], v226 offset:3880
    v_mfma_f32_16x16x32_bf16 v[48:51], v[160:163], v[220:223], v[48:51]
    ds_read_b128 v[184:187], v224 offset:0
    v_mfma_f32_16x16x32_bf16 v[52:55], v[164:167], v[204:207], v[52:55]
    ds_read_b64_tr_b16 v[160:161], v226 offset:160
    v_mfma_f32_16x16x32_bf16 v[56:59], v[164:167], v[208:211], v[56:59]
    ds_read_b64_tr_b16 v[162:163], v226 offset:4000
    v_mfma_f32_16x16x32_bf16 v[60:63], v[164:167], v[212:215], v[60:63]
    ds_read_b128 v[188:191], v224 offset:2048
    v_mfma_f32_16x16x32_bf16 v[64:67], v[164:167], v[216:219], v[64:67]
    ds_read_b128 v[192:195], v224 offset:4096
    v_mfma_f32_16x16x32_bf16 v[68:71], v[164:167], v[220:223], v[68:71]
    ds_read_b128 v[196:199], v224 offset:6144
    v_mfma_f32_16x16x32_bf16 v[72:75], v[168:171], v[204:207], v[72:75]
    ds_read_b64_tr_b16 v[164:165], v226 offset:200
    v_mfma_f32_16x16x32_bf16 v[76:79], v[168:171], v[208:211], v[76:79]
    ds_read_b64_tr_b16 v[166:167], v226 offset:4040
    v_mfma_f32_16x16x32_bf16 v[80:83], v[168:171], v[212:215], v[80:83]
    ds_read_b128 v[200:203], v224 offset:8192
    v_mfma_f32_16x16x32_bf16 v[84:87], v[168:171], v[216:219], v[84:87]
    v_mfma_f32_16x16x32_bf16 v[88:91], v[168:171], v[220:223], v[88:91]
    v_mfma_f32_16x16x32_bf16 v[96:99], v[208:211], v[172:175], v[96:99]
    ds_read_b64_tr_b16 v[168:169], v227 offset:0
    v_mfma_f32_16x16x32_bf16 v[100:103], v[212:215], v[172:175], v[100:103]
    ds_read_b64_tr_b16 v[170:171], v227 offset:3840
    v_mfma_f32_16x16x32_bf16 v[104:107], v[216:219], v[172:175], v[104:107]
    v_mfma_f32_16x16x32_bf16 v[108:111], v[220:223], v[172:175], v[108:111]
    v_mfma_f32_16x16x32_bf16 v[116:119], v[208:211], v[176:179], v[116:119]
    ds_read_b64_tr_b16 v[172:173], v226 offset:320
    v_mfma_f32_16x16x32_bf16 v[120:123], v[212:215], v[176:179], v[120:123]
    ds_read_b64_tr_b16 v[174:175], v226 offset:4160
    v_mfma_f32_16x16x32_bf16 v[124:127], v[216:219], v[176:179], v[124:127]
    v_mfma_f32_16x16x32_bf16 v[128:131], v[220:223], v[176:179], v[128:131]
    v_mfma_f32_16x16x32_bf16 v[136:139], v[208:211], v[180:183], v[136:139]
    ds_read_b64_tr_b16 v[176:177], v226 offset:360
    v_mfma_f32_16x16x32_bf16 v[140:143], v[212:215], v[180:183], v[140:143]
    ds_read_b64_tr_b16 v[178:179], v226 offset:4200
    v_mfma_f32_16x16x32_bf16 v[144:147], v[216:219], v[180:183], v[144:147]
    v_mfma_f32_16x16x32_bf16 v[148:151], v[220:223], v[180:183], v[148:151]
    s_add_u32 s52, s52, 1
    s_cmp_lt_u32 s52, 9
    s_cbranch_scc1 L_loop_A0
    s_waitcnt lgkmcnt(6)
    v_mfma_f32_16x16x32_bf16 v[0:3], v[152:155], v[188:191], v[0:3]
    ds_read_b64_tr_b16 v[180:181], v228 offset:0
    v_mfma_f32_16x16x32_bf16 v[4:7], v[152:155], v[192:195], v[4:7]
    ds_read_b64_tr_b16 v[182:183], v228 offset:3840
    v_mfma_f32_16x16x32_bf16 v[8:11], v[152:155], v[196:199], v[8:11]
    ds_read_b128 v[204:207], v225 offset:0
    v_mfma_f32_16x16x32_bf16 v[12:15], v[152:155], v[200:203], v[12:15]
    ds_read_b128 v[208:211], v225 offset:2048
    v_mfma_f32_16x16x32_bf16 v[16:19], v[156:159], v[188:191], v[16:19]
    ds_read_b64_tr_b16 v[152:153], v226 offset:15360
    v_mfma_f32_16x16x32_bf16 v[20:23], v[156:159], v[192:195], v[20:23]
    ds_read_b64_tr_b16 v[154:155], v226 offset:19200
    v_mfma_f32_16x16x32_bf16 v[24:27], v[156:159], v[196:199], v[24:27]
    ds_read_b128 v[212:215], v225 offset:4096
    v_mfma_f32_16x16x32_bf16 v[28:31], v[156:159], v[200:203], v[28:31]
    ds_read_b128 v[216:219], v225 offset:6144
    v_mfma_f32_16x16x32_bf16 v[32:35], v[160:163], v[184:187], v[32:35]
    ds_read_b64_tr_b16 v[156:157], v226 offset:15400
    v_mfma_f32_16x16x32_bf16 v[36:39], v[160:163], v[188:191], v[36:39]
    ds_read_b64_tr_b16 v[158:159], v226 offset:19240
    v_mfma_f32_16x16x32_bf16 v[40:43], v[160:163], v[192:195], v[40:43]
    ds_read_b128 v[220:223], v225 offset:8192
    v_mfma_f32_16x16x32_bf16 v[44:47], v[160:163], v[196:199], v[44:47]
    v_mfma_f32_16x16x32_bf16 v[48:51], v[160:163], v[200:203], v[48:51]
    v_mfma_f32_16x16x32_bf16 v[52:55], v[164:167], v[184:187], v[52:55]
    ds_read_b64_tr_b16 v[160:161], v226 offset:15520
    v_mfma_f32_16x16x32_bf16 v[56:59], v[164:167], v[188:191], v[56:59]
    ds_read_b64_tr_b16 v[162:163], v226 offset:19360
    v_mfma_f32_16x16x32_bf16 v[60:63], v[164:167], v[192:195], v[60:63]
    v_mfma_f32_16x16x32_bf16 v[64:67], v[164:167], v[196:199], v[64:67]
    v_mfma_f32_16x16x32_bf16 v[68:71], v[164:167], v[200:203], v[68:71]
    s_waitcnt lgkmcnt(15)
    v_mfma_f32_16x16x32_bf16 v[72:75], v[168:171], v[184:187], v[72:75]
    ds_read_b64_tr_b16 v[164:165], v226 offset:15560
    v_mfma_f32_16x16x32_bf16 v[76:79], v[168:171], v[188:191], v[76:79]
    ds_read_b64_tr_b16 v[166:167], v226 offset:19400
    v_mfma_f32_16x16x32_bf16 v[80:83], v[168:171], v[192:195], v[80:83]
    v_mfma_f32_16x16x32_bf16 v[84:87], v[168:171], v[196:199], v[84:87]
    v_mfma_f32_16x16x32_bf16 v[88:91], v[168:171], v[200:203], v[88:91]
    v_mfma_f32_16x16x32_bf16 v[96:99], v[188:191], v[172:175], v[96:99]
    ds_read_b64_tr_b16 v[168:169], v227 offset:15360
    v_mfma_f32_16x16x32_bf16 v[100:103], v[192:195], v[172:175], v[100:103]
    ds_read_b64_tr_b16 v[170:171], v227 offset:19200
    v_mfma_f32_16x16x32_bf16 v[104:107], v[196:199], v[172:175], v[104:107]
    v_mfma_f32_16x16x32_bf16 v[108:111], v[200:203], v[172:175], v[108:111]
    s_waitcnt lgkmcnt(15)
    v_mfma_f32_16x16x32_bf16 v[116:119], v[188:191], v[176:179], v[116:119]
    ds_read_b64_tr_b16 v[172:173], v226 offset:15680
    v_mfma_f32_16x16x32_bf16 v[120:123], v[192:195], v[176:179], v[120:123]
    ds_read_b64_tr_b16 v[174:175], v226 offset:19520
    v_mfma_f32_16x16x32_bf16 v[124:127], v[196:199], v[176:179], v[124:127]
    v_mfma_f32_16x16x32_bf16 v[128:131], v[200:203], v[176:179], v[128:131]
    v_mfma_f32_16x16x32_bf16 v[136:139], v[188:191], v[180:183], v[136:139]
    ds_read_b64_tr_b16 v[176:177], v226 offset:15720
    v_mfma_f32_16x16x32_bf16 v[140:143], v[192:195], v[180:183], v[140:143]
    ds_read_b64_tr_b16 v[178:179], v226 offset:19560
    s_add_u32 s53, s53, 49152
    s_cmp_eq_u32 s53, 147456
    v_mfma_f32_16x16x32_bf16 v[144:147], v[196:199], v[180:183], v[144:147]
    s_cselect_b32 s54, s51, 49152
    s_cselect_b32 s53, 0, s53
    v_mfma_f32_16x16x32_bf16 v[148:151], v[200:203], v[180:183], v[148:151]
    s_waitcnt lgkmcnt(10)
    v_mfma_f32_16x16x32_bf16 v[0:3], v[152:155], v[208:211], v[0:3]
    ds_read_b64_tr_b16 v[180:181], v228 offset:15360
    v_mfma_f32_16x16x32_bf16 v[4:7], v[152:155], v[212:215], v[4:7]
    ds_read_b64_tr_b16 v[182:183], v228 offset:19200
    v_mfma_f32_16x16x32_bf16 v[8:11], v[152:155], v[216:219], v[8:11]
    v_mfma_f32_16x16x32_bf16 v[12:15], v[152:155], v[220:223], v[12:15]
    v_mfma_f32_16x16x32_bf16 v[16:19], v[156:159], v[208:211], v[16:19]
    v_mfma_f32_16x16x32_bf16 v[20:23], v[156:159], v[212:215], v[20:23]
    v_mfma_f32_16x16x32_bf16 v[24:27], v[156:159], v[216:219], v[24:27]
    v_mfma_f32_16x16x32_bf16 v[28:31], v[156:159], v[220:223], v[28:31]
    s_waitcnt lgkmcnt(10)
    v_mfma_f32_16x16x32_bf16 v[32:35], v[160:163], v[204:207], v[32:35]
    v_cvt_pk_bf16_f32 v0, v0, v1
    v_cvt_pk_bf16_f32 v1, v2, v3
    v_mfma_f32_16x16x32_bf16 v[36:39], v[160:163], v[208:211], v[36:39]
    v_cvt_pk_bf16_f32 v4, v4, v5
    v_cvt_pk_bf16_f32 v5, v6, v7
    v_mfma_f32_16x16x32_bf16 v[40:43], v[160:163], v[212:215], v[40:43]
    v_cvt_pk_bf16_f32 v8, v8, v9
    v_cvt_pk_bf16_f32 v9, v10, v11
    v_mfma_f32_16x16x32_bf16 v[44:47], v[160:163], v[216:219], v[44:47]
    v_cvt_pk_bf16_f32 v12, v12, v13
    v_cvt_pk_bf16_f32 v13, v14, v15
    v_mfma_f32_16x16x32_bf16 v[48:51], v[160:163], v[220:223], v[48:51]
    s_waitcnt lgkmcnt(8)
    v_mfma_f32_16x16x32_bf16 v[52:55], v[164:167], v[204:207], v[52:55]
    v_cvt_pk_bf16_f32 v16, v16, v17
    v_cvt_pk_bf16_f32 v17, v18, v19
    v_mfma_f32_16x16x32_bf16 v[56:59], v[164:167], v[208:211], v[56:59]
    v_cvt_pk_bf16_f32 v20, v20, v21
    v_cvt_pk_bf16_f32 v21, v22, v23
    v_mfma_f32_16x16x32_bf16 v[60:63], v[164:167], v[212:215], v[60:63]
    v_cvt_pk_bf16_f32 v24, v24, v25
    v_cvt_pk_bf16_f32 v25, v26, v27
    v_mfma_f32_16x16x32_bf16 v[64:67], v[164:167], v[216:219], v[64:67]
    v_cvt_pk_bf16_f32 v28, v28, v29
    v_cvt_pk_bf16_f32 v29, v30, v31
    v_mfma_f32_16x16x32_bf16 v[68:71], v[164:167], v[220:223], v[68:71]
    s_waitcnt lgkmcnt(6)
    v_mfma_f32_16x16x32_bf16 v[72:75], v[168:171], v[204:207], v[72:75]
    v_cvt_pk_bf16_f32 v32, v32, v33
    v_cvt_pk_bf16_f32 v33, v34, v35
    v_mfma_f32_16x16x32_bf16 v[76:79], v[168:171], v[208:211], v[76:79]
    v_cvt_pk_bf16_f32 v36, v36, v37
    v_cvt_pk_bf16_f32 v37, v38, v39
    v_mfma_f32_16x16x32_bf16 v[80:83], v[168:171], v[212:215], v[80:83]
    v_cvt_pk_bf16_f32 v40, v40, v41
    v_cvt_pk_bf16_f32 v41, v42, v43
    v_mfma_f32_16x16x32_bf16 v[84:87], v[168:171], v[216:219], v[84:87]
    v_cvt_pk_bf16_f32 v44, v44, v45
    v_cvt_pk_bf16_f32 v45, v46, v47
    v_mfma_f32_16x16x32_bf16 v[88:91], v[168:171], v[220:223], v[88:91]
    v_cvt_pk_bf16_f32 v48, v48, v49
    v_cvt_pk_bf16_f32 v49, v50, v51
    s_waitcnt lgkmcnt(4)
    v_mfma_f32_16x16x32_bf16 v[96:99], v[208:211], v[172:175], v[96:99]
    v_cvt_pk_bf16_f32 v52, v52, v53
    v_cvt_pk_bf16_f32 v53, v54, v55
    v_mfma_f32_16x16x32_bf16 v[100:103], v[212:215], v[172:175], v[100:103]
    v_cvt_pk_bf16_f32 v56, v56, v57
    v_cvt_pk_bf16_f32 v57, v58, v59
    v_mfma_f32_16x16x32_bf16 v[104:107], v[216:219], v[172:175], v[104:107]
    v_cvt_pk_bf16_f32 v60, v60, v61
    v_cvt_pk_bf16_f32 v61, v62, v63
    v_mfma_f32_16x16x32_bf16 v[108:111], v[220:223], v[172:175], v[108:111]
    v_cvt_pk_bf16_f32 v64, v64, v65
    v_cvt_pk_bf16_f32 v65, v66, v67
    s_waitcnt lgkmcnt(2)
    v_mfma_f32_16x16x32_bf16 v[116:119], v[208:211], v[176:179], v[116:119]
    v_cvt_pk_bf16_f32 v68, v68, v69
    v_cvt_pk_bf16_f32 v69, v70, v71
    v_mfma_f32_16x16x32_bf16 v[120:123], v[212:215], v[176:179], v[120:123]
    v_cvt_pk_bf16_f32 v72, v72, v73
    v_cvt_pk_bf16_f32 v73, v74, v75
    v_mfma_f32_16x16x32_bf16 v[124:127], v[216:219], v[176:179], v[124:127]
    v_cvt_pk_bf16_f32 v76, v76, v77
    v_cvt_pk_bf16_f32 v77, v78, v79
    v_mfma_f32_16x16x32_bf16 v[128:131], v[220:223], v[176:179], v[128:131]
    v_cvt_pk_bf16_f32 v80, v80, v81
    v_cvt_pk_bf16_f32 v81, v82, v83
    s_waitcnt lgkmcnt(0)
    v_mfma_f32_16x16x32_bf16 v[136:139], v[208:211], v[180:183], v[136:139]
    v_cvt_pk_bf16_f32 v84, v84, v85
    v_cvt_pk_bf16_f32 v85, v86, v87
    v_mfma_f32_16x16x32_bf16 v[140:143], v[212:215], v[180:183], v[140:143]
    v_cvt_pk_bf16_f32 v88, v88, v89
    v_cvt_pk_bf16_f32 v89, v90, v91
    v_mfma_f32_16x16x32_bf16 v[144:147], v[216:219], v[180:183], v[144:147]
    v_mov_b32 v34, v72
    v_mov_b32 v35, v73
    v_mfma_f32_16x16x32_bf16 v[148:151], v[220:223], v[180:183], v[148:151]
    v_mov_b32 v38, v76
    v_mov_b32 v39, v77
    v_mov_b32 v42, v80
    v_mov_b32 v43, v81
    v_mov_b32 v46, v84
    v_mov_b32 v47, v85
    v_mov_b32 v50, v88
    v_mov_b32 v51, v89
    s_waitcnt lgkmcnt(0)
    s_nop 7
    v_cvt_pk_bf16_f32 v94, v96, v97
    v_cvt_pk_bf16_f32 v95, v98, v99
    v_cvt_pk_bf16_f32 v114, v116, v117
    v_cvt_pk_bf16_f32 v115, v118, v119
    v_cvt_pk_bf16_f32 v134, v136, v137
    v_cvt_pk_bf16_f32 v135, v138, v139
    v_cvt_pk_bf16_f32 v96, v100, v101
    v_cvt_pk_bf16_f32 v97, v102, v103
    v_cvt_pk_bf16_f32 v116, v120, v121
    v_cvt_pk_bf16_f32 v117, v122, v123
    v_cvt_pk_bf16_f32 v136, v140, v141
    v_cvt_pk_bf16_f32 v137, v142, v143
    v_cvt_pk_bf16_f32 v98, v104, v105
    v_cvt_pk_bf16_f32 v99, v106, v107
    v_cvt_pk_bf16_f32 v118, v124, v125
    v_cvt_pk_bf16_f32 v119, v126, v127
    v_cvt_pk_bf16_f32 v138, v144, v145
    v_cvt_pk_bf16_f32 v139, v146, v147
    v_cvt_pk_bf16_f32 v100, v108, v109
    v_cvt_pk_bf16_f32 v101, v110, v111
    v_cvt_pk_bf16_f32 v120, v128, v129
    v_cvt_pk_bf16_f32 v121, v130, v131
    v_cvt_pk_bf16_f32 v140, v148, v149
    v_cvt_pk_bf16_f32 v141, v150, v151
    v_permlane32_swap_b32 v88, v50
    v_permlane32_swap_b32 v89, v51
    v_mov_b32 v70, v50
    v_mov_b32 v71, v51
    ds_write_b128 v249, v[48:51]
    ds_write_b128 v249, v[68:71] offset:1024
    ds_write_b64 v250, v[100:101] offset:2048
    ds_write_b64 v250, v[120:121] offset:2560
    ds_write_b64 v250, v[140:141] offset:3072
    s_waitcnt lgkmcnt(0)
    v_mov_b32 v252, 1
    ds_write_b32 v251, v252
    v_permlane32_swap_b32 v72, v34
    v_permlane32_swap_b32 v73, v35
    v_permlane32_swap_b32 v76, v38
    v_permlane32_swap_b32 v77, v39
    v_permlane32_swap_b32 v80, v42
    v_permlane32_swap_b32 v81, v43
    v_permlane32_swap_b32 v84, v46
    v_permlane32_swap_b32 v85, v47
    v_mov_b32 v54, v34
    v_mov_b32 v55, v35
    v_mov_b32 v58, v38
    v_mov_b32 v59, v39
    v_mov_b32 v62, v42
    v_mov_b32 v63, v43
    v_mov_b32 v66, v46
    v_mov_b32 v67, v47
    s_mov_b32 s60, 0x0000ffff
    s_mov_b32 s61, 0
    s_mov_b32 s62, 0xffff0000
    s_mov_b32 s63, 0
    v_cndmask_b32 v2, 0, v76, s[60:61]
    v_cndmask_b32 v3, 0, v77, s[60:61]
    v_cndmask_b32 v18, 0, v76, s[62:63]
    v_cndmask_b32 v19, 0, v77, s[62:63]
    v_cndmask_b32 v6, 0, v80, s[60:61]
    v_cndmask_b32 v7, 0, v81, s[60:61]
    v_cndmask_b32 v22, 0, v80, s[62:63]
    v_cndmask_b32 v23, 0, v81, s[62:63]
    v_cndmask_b32 v10, 0, v84, s[60:61]
    v_cndmask_b32 v11, 0, v85, s[60:61]
    v_cndmask_b32 v26, 0, v84, s[62:63]
    v_cndmask_b32 v27, 0, v85, s[62:63]
    v_cndmask_b32 v14, 0, v88, s[60:61]
    v_cndmask_b32 v15, 0, v89, s[60:61]
    v_cndmask_b32 v30, 0, v88, s[62:63]
    v_cndmask_b32 v31, 0, v89, s[62:63]
    v_mfma_f32_16x16x32_bf16 v[200:203], v[44:47], v[12:15], v[232:235]
    v_mfma_f32_16x16x32_bf16 v[204:207], v[48:51], v[12:15], v[236:239]
    v_mfma_f32_16x16x32_bf16 v[208:211], v[64:67], v[28:31], v[232:235]
    v_mfma_f32_16x16x32_bf16 v[212:215], v[68:71], v[28:31], v[236:239]
    v_mfma_f32_16x16x32_bf16 v[184:187], v[40:43], v[8:11], v[232:235]
    v_mfma_f32_16x16x32_bf16 v[188:191], v[44:47], v[8:11], v[236:239]
    v_mfma_f32_16x16x32_bf16 v[192:195], v[60:63], v[24:27], v[232:235]
    v_mfma_f32_16x16x32_bf16 v[196:199], v[64:67], v[24:27], v[236:239]
    v_mfma_f32_16x16x32_bf16 v[168:171], v[36:39], v[4:7], v[232:235]
    v_mfma_f32_16x16x32_bf16 v[172:175], v[40:43], v[4:7], v[236:239]
    v_mfma_f32_16x16x32_bf16 v[176:179], v[56:59], v[20:23], v[232:235]
    v_mfma_f32_16x16x32_bf16 v[180:183], v[60:63], v[20:23], v[236:239]
L_xspin0:
    ds_read_b32 v252, v251 offset:4
    s_waitcnt lgkmcnt(0)
    v_readfirstlane_b32 s70, v252
    s_nop 3
    s_cmp_eq_u32 s70, 0
    s_cbranch_scc1 L_xspin0
    ds_read_b64 v[92:93], v250 offset:4096
    ds_read_b64 v[112:113], v250 offset:4608
    ds_read_b64 v[132:133], v250 offset:5120
    s_waitcnt lgkmcnt(0)
    v_mfma_f32_16x16x32_bf16 v[152:155], v[32:35], v[0:3], v[240:243]
    v_mfma_f32_16x16x32_bf16 v[156:159], v[36:39], v[0:3], v[236:239]
    v_mfma_f32_16x16x32_bf16 v[160:163], v[52:55], v[16:19], v[240:243]
    v_mfma_f32_16x16x32_bf16 v[164:167], v[56:59], v[16:19], v[236:239]
    s_mov_b32 s64, 0x3ea52b5c
    s_mov_b32 s65, 0x3ea52b5c
    v_max3_f32 v200, v200, v201, v204
    v_max3_f32 v202, v202, v203, v206
    v_max3_f32 v208, v208, v209, v212
    v_max3_f32 v210, v210, v211, v214
    v_max3_f32 v184, v184, v185, v188
    v_max3_f32 v186, v186, v187, v190
    v_max3_f32 v192, v192, v193, v196
    v_max3_f32 v194, v194, v195, v198
    v_max3_f32 v168, v168, v169, v172
    v_max3_f32 v170, v170, v171, v174
    v_max3_f32 v176, v176, v177, v180
    v_max3_f32 v178, v178, v179, v182
    v_max3_f32 v152, v152, v153, v156
    v_max3_f32 v154, v154, v155, v158
    v_max3_f32 v160, v160, v161, v164
    v_max3_f32 v162, v162, v163, v166
    v_max_f32 v200, v200, v205
    v_max_f32 v201, v202, v207
    v_max_f32 v208, v208, v213
    v_max_f32 v209, v210, v215
    v_max_f32 v184, v184, v189
    v_max_f32 v185, v186, v191
    v_max_f32 v192, v192, v197
    v_max_f32 v193, v194, v199
    v_max_f32 v168, v168, v173
    v_max_f32 v169, v170, v175
    v_max_f32 v176, v176, v181
    v_max_f32 v177, v178, v183
    v_max_f32 v152, v152, v157
    v_max_f32 v153, v154, v159
    v_max_f32 v160, v160, v165
    v_max_f32 v161, v162, v167
    v_max_f32 v202, v200, v201
    v_max_f32 v210, v208, v209
    v_max_f32 v186, v184, v185
    v_max_f32 v194, v192, v193
    v_max_f32 v170, v168, v169
    v_max_f32 v178, v176, v177
    v_max_f32 v154, v152, v153
    v_max_f32 v162, v160, v161
    v_permlane32_swap_b32 v202, v210
    v_permlane32_swap_b32 v186, v194
    v_permlane32_swap_b32 v170, v178
    v_permlane32_swap_b32 v154, v162
    v_max_f32 v202, v202, v210
    v_max_f32 v186, v186, v194
    v_max_f32 v170, v170, v178
    v_max_f32 v154, v154, v162
    v_permlane16_swap_b32 v202, v186
    s_nop 0
    v_permlane16_swap_b32 v170, v154
    v_max_f32 v202, v202, v186
    v_max_f32 v170, v170, v154
    v_mul_f32 v202, s64, v202
    v_mul_f32 v170, s64, v170
    v_mov_b32 v186, v202
    v_mov_b32 v154, v170
    s_nop 0
    v_permlane16_swap_b32 v202, v186
    v_permlane16_swap_b32 v170, v154
    v_mov_b32 v210, v202
    v_mov_b32 v194, v186
    v_mov_b32 v178, v170
    v_mov_b32 v162, v154
    v_permlane32_swap_b32 v202, v210
    v_permlane32_swap_b32 v186, v194
    v_permlane32_swap_b32 v170, v178
    v_permlane32_swap_b32 v154, v162
    v_pk_fma_f32 v[200:201], v[200:201], s[64:65], v[202:203] op_sel_hi:[1,1,0] neg_lo:[0,0,1] neg_hi:[0,0,1]
    v_pk_fma_f32 v[208:209], v[208:209], s[64:65], v[210:211] op_sel_hi:[1,1,0] neg_lo:[0,0,1] neg_hi:[0,0,1]
    v_pk_fma_f32 v[184:185], v[184:185], s[64:65], v[186:187] op_sel_hi:[1,1,0] neg_lo:[0,0,1] neg_hi:[0,0,1]
    v_pk_fma_f32 v[192:193], v[192:193], s[64:65], v[194:195] op_sel_hi:[1,1,0] neg_lo:[0,0,1] neg_hi:[0,0,1]
    v_pk_fma_f32 v[168:169], v[168:169], s[64:65], v[170:171] op_sel_hi:[1,1,0] neg_lo:[0,0,1] neg_hi:[0,0,1]
    v_pk_fma_f32 v[176:177], v[176:177], s[64:65], v[178:179] op_sel_hi:[1,1,0] neg_lo:[0,0,1] neg_hi:[0,0,1]
    v_pk_fma_f32 v[152:153], v[152:153], s[64:65], v[154:155] op_sel_hi:[1,1,0] neg_lo:[0,0,1] neg_hi:[0,0,1]
    v_pk_fma_f32 v[160:161], v[160:161], s[64:65], v[162:163] op_sel_hi:[1,1,0] neg_lo:[0,0,1] neg_hi:[0,0,1]
    v_exp_f32 v200, v200
    v_exp_f32 v201, v201
    v_exp_f32 v208, v208
    v_exp_f32 v209, v209
    v_exp_f32 v184, v184
    v_exp_f32 v185, v185
    v_exp_f32 v192, v192
    v_exp_f32 v193, v193
    v_exp_f32 v168, v168
    v_exp_f32 v169, v169
    v_exp_f32 v176, v176
    v_exp_f32 v177, v177
    v_exp_f32 v152, v152
    v_exp_f32 v153, v153
    v_exp_f32 v160, v160
    v_exp_f32 v161, v161
    v_add_f32 v202, v200, v201
    v_add_f32 v210, v208, v209
    v_add_f32 v186, v184, v185
    v_add_f32 v194, v192, v193
    v_add_f32 v170, v168, v169
    v_add_f32 v178, v176, v177
    v_add_f32 v154, v152, v153
    v_add_f32 v162, v160, v161
    v_permlane32_swap_b32 v202, v210
    v_permlane32_swap_b32 v186, v194
    v_permlane32_swap_b32 v170, v178
    v_permlane32_swap_b32 v154, v162
    v_add_f32 v202, v202, v210
    v_add_f32 v186, v186, v194
    v_add_f32 v170, v170, v178
    v_add_f32 v154, v154, v162
    v_permlane16_swap_b32 v202, v186
    s_nop 0
    v_permlane16_swap_b32 v170, v154
    v_add_f32 v202, v202, v186
    v_add_f32 v170, v170, v154
    v_rcp_f32 v202, v202
    v_rcp_f32 v170, v170
    v_mov_b32 v186, v202
    v_mov_b32 v154, v170
    s_nop 0
    v_permlane16_swap_b32 v202, v186
    v_permlane16_swap_b32 v170, v154
    v_mov_b32 v210, v202
    v_mov_b32 v194, v186
    v_mov_b32 v178, v170
    v_mov_b32 v162, v154
    v_permlane32_swap_b32 v202, v210
    v_permlane32_swap_b32 v186, v194
    v_permlane32_swap_b32 v170, v178
    v_permlane32_swap_b32 v154, v162
    v_pk_mul_f32 v[200:201], v[200:201], v[202:203] op_sel_hi:[1,0]
    v_pk_mul_f32 v[208:209], v[208:209], v[210:211] op_sel_hi:[1,0]
    v_pk_mul_f32 v[184:185], v[184:185], v[186:187] op_sel_hi:[1,0]
    v_pk_mul_f32 v[192:193], v[192:193], v[194:195] op_sel_hi:[1,0]
    v_pk_mul_f32 v[168:169], v[168:169], v[170:171] op_sel_hi:[1,0]
    v_pk_mul_f32 v[176:177], v[176:177], v[178:179] op_sel_hi:[1,0]
    v_pk_mul_f32 v[152:153], v[152:153], v[154:155] op_sel_hi:[1,0]
    v_pk_mul_f32 v[160:161], v[160:161], v[162:163] op_sel_hi:[1,0]
    v_cvt_pk_bf16_f32 v202, v200, v201
    v_cvt_pk_bf16_f32 v210, v208, v209
    v_cvt_pk_bf16_f32 v186, v184, v185
    v_cvt_pk_bf16_f32 v194, v192, v193
    v_cvt_pk_bf16_f32 v170, v168, v169
    v_cvt_pk_bf16_f32 v178, v176, v177
    v_cvt_pk_bf16_f32 v154, v152, v153
    v_cvt_pk_bf16_f32 v162, v160, v161
    v_perm_b32 v204, v202, v202, v244
    v_perm_b32 v205, v202, v202, v245
    v_perm_b32 v206, v202, v202, v246
    v_perm_b32 v207, v202, v202, v247
    v_perm_b32 v212, v210, v210, v244
    v_perm_b32 v213, v210, v210, v245
    v_perm_b32 v214, v210, v210, v246
    v_perm_b32 v215, v210, v210, v247
    v_mfma_f32_16x16x32_bf16 v[12:15], v[98:101], v[204:207], 0
    v_mfma_f32_16x16x32_bf16 v[44:47], v[138:141], v[204:207], 0
    v_perm_b32 v188, v186, v186, v244
    v_perm_b32 v189, v186, v186, v245
    v_perm_b32 v190, v186, v186, v246
    v_perm_b32 v191, v186, v186, v247
    v_mfma_f32_16x16x32_bf16 v[28:31], v[118:121], v[212:215], 0
    v_mfma_f32_16x16x32_bf16 v[64:67], v[138:141], v[212:215], 0
    v_perm_b32 v196, v194, v194, v244
    v_perm_b32 v197, v194, v194, v245
    v_perm_b32 v198, v194, v194, v246
    v_perm_b32 v199, v194, v194, v247
    v_mfma_f32_16x16x32_bf16 v[8:11], v[96:99], v[188:191], 0
    v_mfma_f32_16x16x32_bf16 v[40:43], v[136:139], v[188:191], 0
    v_perm_b32 v172, v170, v170, v244
    v_perm_b32 v173, v170, v170, v245
    v_perm_b32 v174, v170, v170, v246
    v_perm_b32 v175, v170, v170, v247
    v_mfma_f32_16x16x32_bf16 v[24:27], v[116:119], v[196:199], 0
    v_mfma_f32_16x16x32_bf16 v[60:63], v[136:139], v[196:199], 0
    v_perm_b32 v180, v178, v178, v244
    v_perm_b32 v181, v178, v178, v245
    v_perm_b32 v182, v178, v178, v246
    v_perm_b32 v183, v178, v178, v247
    v_mfma_f32_16x16x32_bf16 v[4:7], v[94:97], v[172:175], 0
    v_mfma_f32_16x16x32_bf16 v[36:39], v[134:137], v[172:175], 0
    v_perm_b32 v156, v154, v154, v244
    v_perm_b32 v157, v154, v154, v245
    v_perm_b32 v158, v154, v154, v246
    v_perm_b32 v159, v154, v154, v247
    v_mfma_f32_16x16x32_bf16 v[20:23], v[114:117], v[180:183], 0
    v_mfma_f32_16x16x32_bf16 v[56:59], v[134:137], v[180:183], 0
    v_perm_b32 v164, v162, v162, v244
    v_perm_b32 v165, v162, v162, v245
    v_perm_b32 v166, v162, v162, v246
    v_perm_b32 v167, v162, v162, v247
    v_mfma_f32_16x16x32_bf16 v[0:3], v[92:95], v[156:159], 0
    v_mfma_f32_16x16x32_bf16 v[32:35], v[132:135], v[156:159], 0
    v_mfma_f32_16x16x32_bf16 v[16:19], v[112:115], v[164:167], 0
    v_mfma_f32_16x16x32_bf16 v[52:55], v[132:135], v[164:167], 0
    v_cvt_pk_bf16_f32 v200, v12, v13
    v_cvt_pk_bf16_f32 v201, v14, v15
    v_cvt_pk_bf16_f32 v202, v28, v29
    v_cvt_pk_bf16_f32 v203, v30, v31
    s_add_u32 s68, s66, 61440
    buffer_store_dwordx4 v[200:203], v248, s[40:43], s68 offen sc1
    v_cvt_pk_bf16_f32 v184, v8, v9
    v_cvt_pk_bf16_f32 v185, v10, v11
    v_cvt_pk_bf16_f32 v186, v24, v25
    v_cvt_pk_bf16_f32 v187, v26, v27
    s_add_u32 s68, s66, 40960
    buffer_store_dwordx4 v[184:187], v248, s[40:43], s68 offen sc1
    v_cndmask_b32 v44, v44, v64, s[62:63]
    v_cndmask_b32 v45, v45, v65, s[62:63]
    v_cndmask_b32 v46, v46, v66, s[62:63]
    v_cndmask_b32 v47, v47, v67, s[62:63]
    v_cvt_pk_bf16_f32 v194, v44, v45
    v_cvt_pk_bf16_f32 v195, v46, v47
    v_cndmask_b32 v40, v40, v60, s[62:63]
    v_cndmask_b32 v41, v41, v61, s[62:63]
    v_cndmask_b32 v42, v42, v62, s[62:63]
    v_cndmask_b32 v43, v43, v63, s[62:63]
    v_cvt_pk_bf16_f32 v192, v40, v41
    v_cvt_pk_bf16_f32 v193, v42, v43
    v_cvt_pk_bf16_f32 v168, v4, v5
    v_cvt_pk_bf16_f32 v169, v6, v7
    v_cvt_pk_bf16_f32 v170, v20, v21
    v_cvt_pk_bf16_f32 v171, v22, v23
    s_add_u32 s68, s66, 20480
    buffer_store_dwordx4 v[168:171], v248, s[40:43], s68 offen sc1
    v_cndmask_b32 v36, v36, v56, s[62:63]
    v_cndmask_b32 v37, v37, v57, s[62:63]
    v_cndmask_b32 v38, v38, v58, s[62:63]
    v_cndmask_b32 v39, v39, v59, s[62:63]
    v_cvt_pk_bf16_f32 v162, v36, v37
    v_cvt_pk_bf16_f32 v163, v38, v39
    v_cvt_pk_bf16_f32 v152, v0, v1
    v_cvt_pk_bf16_f32 v153, v2, v3
    v_cvt_pk_bf16_f32 v154, v16, v17
    v_cvt_pk_bf16_f32 v155, v18, v19
    s_add_u32 s68, s66, 0
    buffer_store_dwordx4 v[152:155], v248, s[40:43], s68 offen sc1
    v_cndmask_b32 v32, v32, v52, s[62:63]
    v_cndmask_b32 v33, v33, v53, s[62:63]
    v_cndmask_b32 v34, v34, v54, s[62:63]
    v_cndmask_b32 v35, v35, v55, s[62:63]
    v_cvt_pk_bf16_f32 v160, v32, v33
    v_cvt_pk_bf16_f32 v161, v34, v35
    s_mov_b32 exec_hi, 0
    s_add_u32 s68, s67, 0
    buffer_store_dwordx4 v[160:163], v248, s[40:43], s68 offen sc1
    s_add_u32 s68, s67, 20480
    buffer_store_dwordx4 v[192:195], v248, s[40:43], s68 offen sc1
    s_mov_b32 exec_hi, -1
    s_endpgm
L_attn_th1:
    ds_read_b64_tr_b16 v[152:153], v226 offset:0
    ds_read_b64_tr_b16 v[154:155], v226 offset:3840
    ds_read_b64_tr_b16 v[156:157], v226 offset:40
    ds_read_b64_tr_b16 v[158:159], v226 offset:3880
    ds_read_b64_tr_b16 v[160:161], v226 offset:160
    ds_read_b64_tr_b16 v[162:163], v226 offset:4000
    ds_read_b128 v[184:187], v224 offset:0
    ds_read_b128 v[188:191], v224 offset:10240
    ds_read_b64_tr_b16 v[164:165], v226 offset:200
    ds_read_b64_tr_b16 v[166:167], v226 offset:4040
    ds_read_b128 v[192:195], v224 offset:12288
    ds_read_b128 v[196:199], v224 offset:14336
    ds_read_b64_tr_b16 v[168:169], v227 offset:0
    ds_read_b64_tr_b16 v[170:171], v227 offset:3840
    ds_read_b128 v[200:203], v224 offset:16384
    ds_read_b64_tr_b16 v[172:173], v226 offset:320
    ds_read_b64_tr_b16 v[174:175], v226 offset:4160
    ds_read_b64_tr_b16 v[176:177], v226 offset:360
    ds_read_b64_tr_b16 v[178:179], v226 offset:4200
    s_mov_b32 s52, 0
    s_mov_b32 s53, 0
    s_mov_b32 s51, 4294868992
L_loop_A1:
    s_waitcnt lgkmcnt(4)
    v_mfma_f32_16x16x32_bf16 v[0:3], v[152:155], v[188:191], v[0:3]
    ds_read_b64_tr_b16 v[180:181], v228 offset:0
    v_mfma_f32_16x16x32_bf16 v[4:7], v[152:155], v[192:195], v[4:7]
    ds_read_b64_tr_b16 v[182:183], v228 offset:3840
    v_mfma_f32_16x16x32_bf16 v[8:11], v[152:155], v[196:199], v[8:11]
    ds_read_b128 v[204:207], v225 offset:0
    v_mfma_f32_16x16x32_bf16 v[12:15], v[152:155], v[200:203], v[12:15]
    ds_read_b128 v[208:211], v225 offset:10240
    v_mfma_f32_16x16x32_bf16 v[16:19], v[156:159], v[188:191], v[16:19]
    ds_read_b64_tr_b16 v[152:153], v226 offset:15360
    v_mfma_f32_16x16x32_bf16 v[20:23], v[156:159], v[192:195], v[20:23]
    ds_read_b64_tr_b16 v[154:155], v226 offset:19200
    v_mfma_f32_16x16x32_bf16 v[24:27], v[156:159], v[196:199], v[24:27]
    ds_read_b128 v[212:215], v225 offset:12288
    v_mfma_f32_16x16x32_bf16 v[28:31], v[156:159], v[200:203], v[28:31]
    ds_read_b128 v[216:219], v225 offset:14336
    v_mfma_f32_16x16x32_bf16 v[36:39], v[160:163], v[188:191], v[36:39]
    ds_read_b64_tr_b16 v[156:157], v226 offset:15400
    v_mfma_f32_16x16x32_bf16 v[40:43], v[160:163], v[192:195], v[40:43]
    ds_read_b64_tr_b16 v[158:159], v226 offset:19240
    v_mfma_f32_16x16x32_bf16 v[44:47], v[160:163], v[196:199], v[44:47]
    ds_read_b128 v[220:223], v225 offset:16384
    v_mfma_f32_16x16x32_bf16 v[48:51], v[160:163], v[200:203], v[48:51]
    v_mfma_f32_16x16x32_bf16 v[56:59], v[164:167], v[188:191], v[56:59]
    ds_read_b64_tr_b16 v[160:161], v226 offset:15520
    v_mfma_f32_16x16x32_bf16 v[60:63], v[164:167], v[192:195], v[60:63]
    ds_read_b64_tr_b16 v[162:163], v226 offset:19360
    v_mfma_f32_16x16x32_bf16 v[64:67], v[164:167], v[196:199], v[64:67]
    v_mfma_f32_16x16x32_bf16 v[68:71], v[164:167], v[200:203], v[68:71]
    v_mfma_f32_16x16x32_bf16 v[76:79], v[168:171], v[188:191], v[76:79]
    ds_read_b64_tr_b16 v[164:165], v226 offset:15560
    v_mfma_f32_16x16x32_bf16 v[80:83], v[168:171], v[192:195], v[80:83]
    ds_read_b64_tr_b16 v[166:167], v226 offset:19400
    v_mfma_f32_16x16x32_bf16 v[84:87], v[168:171], v[196:199], v[84:87]
    v_mfma_f32_16x16x32_bf16 v[88:91], v[168:171], v[200:203], v[88:91]
    s_waitcnt lgkmcnt(15)
    v_mfma_f32_16x16x32_bf16 v[92:95], v[184:187], v[172:175], v[92:95]
    ds_read_b64_tr_b16 v[168:169], v227 offset:15360
    v_mfma_f32_16x16x32_bf16 v[96:99], v[188:191], v[172:175], v[96:99]
    ds_read_b64_tr_b16 v[170:171], v227 offset:19200
    v_mfma_f32_16x16x32_bf16 v[100:103], v[192:195], v[172:175], v[100:103]
    v_mfma_f32_16x16x32_bf16 v[104:107], v[196:199], v[172:175], v[104:107]
    v_mfma_f32_16x16x32_bf16 v[108:111], v[200:203], v[172:175], v[108:111]
    v_mfma_f32_16x16x32_bf16 v[112:115], v[184:187], v[176:179], v[112:115]
    ds_read_b64_tr_b16 v[172:173], v226 offset:15680
    v_mfma_f32_16x16x32_bf16 v[116:119], v[188:191], v[176:179], v[116:119]
    ds_read_b64_tr_b16 v[174:175], v226 offset:19520
    v_mfma_f32_16x16x32_bf16 v[120:123], v[192:195], v[176:179], v[120:123]
    v_mfma_f32_16x16x32_bf16 v[124:127], v[196:199], v[176:179], v[124:127]
    v_mfma_f32_16x16x32_bf16 v[128:131], v[200:203], v[176:179], v[128:131]
    s_waitcnt lgkmcnt(15)
    v_mfma_f32_16x16x32_bf16 v[132:135], v[184:187], v[180:183], v[132:135]
    ds_read_b64_tr_b16 v[176:177], v226 offset:15720
    v_mfma_f32_16x16x32_bf16 v[136:139], v[188:191], v[180:183], v[136:139]
    ds_read_b64_tr_b16 v[178:179], v226 offset:19560
    s_add_u32 s53, s53, 49152
    s_cmp_eq_u32 s53, 147456
    v_mfma_f32_16x16x32_bf16 v[140:143], v[192:195], v[180:183], v[140:143]
    s_cselect_b32 s54, s51, 49152
    s_cselect_b32 s53, 0, s53
    v_mfma_f32_16x16x32_bf16 v[144:147], v[196:199], v[180:183], v[144:147]
    v_mfma_f32_16x16x32_bf16 v[148:151], v[200:203], v[180:183], v[148:151]
    s_waitcnt lgkmcnt(10)
    v_mfma_f32_16x16x32_bf16 v[0:3], v[152:155], v[208:211], v[0:3]
    ds_read_b64_tr_b16 v[180:181], v228 offset:15360
    v_mfma_f32_16x16x32_bf16 v[4:7], v[152:155], v[212:215], v[4:7]
    ds_read_b64_tr_b16 v[182:183], v228 offset:19200
    v_mfma_f32_16x16x32_bf16 v[8:11], v[152:155], v[216:219], v[8:11]
    v_add_u32 v226, s54, v226
    v_mfma_f32_16x16x32_bf16 v[12:15], v[152:155], v[220:223], v[12:15]
    v_add_u32 v224, s54, v224
    v_mfma_f32_16x16x32_bf16 v[16:19], v[156:159], v[208:211], v[16:19]
    v_add_u32 v225, s54, v225
    v_mfma_f32_16x16x32_bf16 v[20:23], v[156:159], v[212:215], v[20:23]
    v_add_u32 v227, s54, v227
    v_mfma_f32_16x16x32_bf16 v[24:27], v[156:159], v[216:219], v[24:27]
    v_add_u32 v228, s54, v228
    v_mfma_f32_16x16x32_bf16 v[28:31], v[156:159], v[220:223], v[28:31]
    s_waitcnt lgkmcnt(0)
    s_barrier
    v_mfma_f32_16x16x32_bf16 v[36:39], v[160:163], v[208:211], v[36:39]
    ds_read_b64_tr_b16 v[152:153], v226 offset:0
    v_mfma_f32_16x16x32_bf16 v[40:43], v[160:163], v[212:215], v[40:43]
    ds_read_b64_tr_b16 v[154:155], v226 offset:3840
    v_mfma_f32_16x16x32_bf16 v[44:47], v[160:163], v[216:219], v[44:47]
    ds_read_b64_tr_b16 v[156:157], v226 offset:40
    v_mfma_f32_16x16x32_bf16 v[48:51], v[160:163], v[220:223], v[48:51]
    ds_read_b64_tr_b16 v[158:159], v226 offset:3880
    v_mfma_f32_16x16x32_bf16 v[56:59], v[164:167], v[208:211], v[56:59]
    ds_read_b64_tr_b16 v[160:161], v226 offset:160
    v_mfma_f32_16x16x32_bf16 v[60:63], v[164:167], v[212:215], v[60:63]
    ds_read_b64_tr_b16 v[162:163], v226 offset:4000
    v_mfma_f32_16x16x32_bf16 v[64:67], v[164:167], v[216:219], v[64:67]
    ds_read_b128 v[184:187], v224 offset:0
    v_mfma_f32_16x16x32_bf16 v[68:71], v[164:167], v[220:223], v[68:71]
    ds_read_b128 v[188:191], v224 offset:10240
    v_mfma_f32_16x16x32_bf16 v[76:79], v[168:171], v[208:211], v[76:79]
    ds_read_b64_tr_b16 v[164:165], v226 offset:200
    v_mfma_f32_16x16x32_bf16 v[80:83], v[168:171], v[212:215], v[80:83]
    ds_read_b64_tr_b16 v[166:167], v226 offset:4040
    v_mfma_f32_16x16x32_bf16 v[84:87], v[168:171], v[216:219], v[84:87]
    ds_read_b128 v[192:195], v224 offset:12288
    v_mfma_f32_16x16x32_bf16 v[88:91], v[168:171], v[220:223], v[88:91]
    ds_read_b128 v[196:199], v224 offset:14336
    v_mfma_f32_16x16x32_bf16 v[92:95], v[204:207], v[172:175], v[92:95]
    ds_read_b64_tr_b16 v[168:169], v227 offset:0
    v_mfma_f32_16x16x32_bf16 v[96:99], v[208:211], v[172:175], v[96:99]
    ds_read_b64_tr_b16 v[170:171], v227 offset:3840
    v_mfma_f32_16x16x32_bf16 v[100:103], v[212:215], v[172:175], v[100:103]
    ds_read_b128 v[200:203], v224 offset:16384
    v_mfma_f32_16x16x32_bf16 v[104:107], v[216:219], v[172:175], v[104:107]
    v_mfma_f32_16x16x32_bf16 v[108:111], v[220:223], v[172:175], v[108:111]
    v_mfma_f32_16x16x32_bf16 v[112:115], v[204:207], v[176:179], v[112:115]
    ds_read_b64_tr_b16 v[172:173], v226 offset:320
    v_mfma_f32_16x16x32_bf16 v[116:119], v[208:211], v[176:179], v[116:119]
    ds_read_b64_tr_b16 v[174:175], v226 offset:4160
    v_mfma_f32_16x16x32_bf16 v[120:123], v[212:215], v[176:179], v[120:123]
    v_mfma_f32_16x16x32_bf16 v[124:127], v[216:219], v[176:179], v[124:127]
    v_mfma_f32_16x16x32_bf16 v[128:131], v[220:223], v[176:179], v[128:131]
    v_mfma_f32_16x16x32_bf16 v[132:135], v[204:207], v[180:183], v[132:135]
    ds_read_b64_tr_b16 v[176:177], v226 offset:360
    v_mfma_f32_16x16x32_bf16 v[136:139], v[208:211], v[180:183], v[136:139]
    ds_read_b64_tr_b16 v[178:179], v226 offset:4200
    v_mfma_f32_16x16x32_bf16 v[140:143], v[212:215], v[180:183], v[140:143]
    v_mfma_f32_16x16x32_bf16 v[144:147], v[216:219], v[180:183], v[144:147]
    v_mfma_f32_16x16x32_bf16 v[148:151], v[220:223], v[180:183], v[148:151]
    s_add_u32 s52, s52, 1
    s_cmp_lt_u32 s52, 9
    s_cbranch_scc1 L_loop_A1
    s_waitcnt lgkmcnt(4)
    v_mfma_f32_16x16x32_bf16 v[0:3], v[152:155], v[188:191], v[0:3]
    ds_read_b64_tr_b16 v[180:181], v228 offset:0
    v_mfma_f32_16x16x32_bf16 v[4:7], v[152:155], v[192:195], v[4:7]
    ds_read_b64_tr_b16 v[182:183], v228 offset:3840
    v_mfma_f32_16x16x32_bf16 v[8:11], v[152:155], v[196:199], v[8:11]
    ds_read_b128 v[204:207], v225 offset:0
    v_mfma_f32_16x16x32_bf16 v[12:15], v[152:155], v[200:203], v[12:15]
    ds_read_b128 v[208:211], v225 offset:10240
    v_mfma_f32_16x16x32_bf16 v[16:19], v[156:159], v[188:191], v[16:19]
    ds_read_b64_tr_b16 v[152:153], v226 offset:15360
    v_mfma_f32_16x16x32_bf16 v[20:23], v[156:159], v[192:195], v[20:23]
    ds_read_b64_tr_b16 v[154:155], v226 offset:19200
    v_mfma_f32_16x16x32_bf16 v[24:27], v[156:159], v[196:199], v[24:27]
    ds_read_b128 v[212:215], v225 offset:12288
    v_mfma_f32_16x16x32_bf16 v[28:31], v[156:159], v[200:203], v[28:31]
    ds_read_b128 v[216:219], v225 offset:14336
    v_mfma_f32_16x16x32_bf16 v[36:39], v[160:163], v[188:191], v[36:39]
    ds_read_b64_tr_b16 v[156:157], v226 offset:15400
    v_mfma_f32_16x16x32_bf16 v[40:43], v[160:163], v[192:195], v[40:43]
    ds_read_b64_tr_b16 v[158:159], v226 offset:19240
    v_mfma_f32_16x16x32_bf16 v[44:47], v[160:163], v[196:199], v[44:47]
    ds_read_b128 v[220:223], v225 offset:16384
    v_mfma_f32_16x16x32_bf16 v[48:51], v[160:163], v[200:203], v[48:51]
    v_mfma_f32_16x16x32_bf16 v[56:59], v[164:167], v[188:191], v[56:59]
    ds_read_b64_tr_b16 v[160:161], v226 offset:15520
    v_mfma_f32_16x16x32_bf16 v[60:63], v[164:167], v[192:195], v[60:63]
    ds_read_b64_tr_b16 v[162:163], v226 offset:19360
    v_mfma_f32_16x16x32_bf16 v[64:67], v[164:167], v[196:199], v[64:67]
    v_mfma_f32_16x16x32_bf16 v[68:71], v[164:167], v[200:203], v[68:71]
    v_mfma_f32_16x16x32_bf16 v[76:79], v[168:171], v[188:191], v[76:79]
    ds_read_b64_tr_b16 v[164:165], v226 offset:15560
    v_mfma_f32_16x16x32_bf16 v[80:83], v[168:171], v[192:195], v[80:83]
    ds_read_b64_tr_b16 v[166:167], v226 offset:19400
    v_mfma_f32_16x16x32_bf16 v[84:87], v[168:171], v[196:199], v[84:87]
    v_mfma_f32_16x16x32_bf16 v[88:91], v[168:171], v[200:203], v[88:91]
    s_waitcnt lgkmcnt(15)
    v_mfma_f32_16x16x32_bf16 v[92:95], v[184:187], v[172:175], v[92:95]
    ds_read_b64_tr_b16 v[168:169], v227 offset:15360
    v_mfma_f32_16x16x32_bf16 v[96:99], v[188:191], v[172:175], v[96:99]
    ds_read_b64_tr_b16 v[170:171], v227 offset:19200
    v_mfma_f32_16x16x32_bf16 v[100:103], v[192:195], v[172:175], v[100:103]
    v_mfma_f32_16x16x32_bf16 v[104:107], v[196:199], v[172:175], v[104:107]
    v_mfma_f32_16x16x32_bf16 v[108:111], v[200:203], v[172:175], v[108:111]
    v_mfma_f32_16x16x32_bf16 v[112:115], v[184:187], v[176:179], v[112:115]
    ds_read_b64_tr_b16 v[172:173], v226 offset:15680
    v_mfma_f32_16x16x32_bf16 v[116:119], v[188:191], v[176:179], v[116:119]
    ds_read_b64_tr_b16 v[174:175], v226 offset:19520
    v_mfma_f32_16x16x32_bf16 v[120:123], v[192:195], v[176:179], v[120:123]
    v_mfma_f32_16x16x32_bf16 v[124:127], v[196:199], v[176:179], v[124:127]
    v_mfma_f32_16x16x32_bf16 v[128:131], v[200:203], v[176:179], v[128:131]
    s_waitcnt lgkmcnt(15)
    v_mfma_f32_16x16x32_bf16 v[132:135], v[184:187], v[180:183], v[132:135]
    ds_read_b64_tr_b16 v[176:177], v226 offset:15720
    v_mfma_f32_16x16x32_bf16 v[136:139], v[188:191], v[180:183], v[136:139]
    ds_read_b64_tr_b16 v[178:179], v226 offset:19560
    s_add_u32 s53, s53, 49152
    s_cmp_eq_u32 s53, 147456
    v_mfma_f32_16x16x32_bf16 v[140:143], v[192:195], v[180:183], v[140:143]
    s_cselect_b32 s54, s51, 49152
    s_cselect_b32 s53, 0, s53
    v_mfma_f32_16x16x32_bf16 v[144:147], v[196:199], v[180:183], v[144:147]
    v_mfma_f32_16x16x32_bf16 v[148:151], v[200:203], v[180:183], v[148:151]
    s_waitcnt lgkmcnt(10)
    v_mfma_f32_16x16x32_bf16 v[0:3], v[152:155], v[208:211], v[0:3]
    ds_read_b64_tr_b16 v[180:181], v228 offset:15360
    v_mfma_f32_16x16x32_bf16 v[4:7], v[152:155], v[212:215], v[4:7]
    ds_read_b64_tr_b16 v[182:183], v228 offset:19200
    v_mfma_f32_16x16x32_bf16 v[8:11], v[152:155], v[216:219], v[8:11]
    v_mfma_f32_16x16x32_bf16 v[12:15], v[152:155], v[220:223], v[12:15]
    v_mfma_f32_16x16x32_bf16 v[16:19], v[156:159], v[208:211], v[16:19]
    v_mfma_f32_16x16x32_bf16 v[20:23], v[156:159], v[212:215], v[20:23]
    v_mfma_f32_16x16x32_bf16 v[24:27], v[156:159], v[216:219], v[24:27]
    v_mfma_f32_16x16x32_bf16 v[28:31], v[156:159], v[220:223], v[28:31]
    s_waitcnt lgkmcnt(10)
    v_mfma_f32_16x16x32_bf16 v[36:39], v[160:163], v[208:211], v[36:39]
    v_cvt_pk_bf16_f32 v0, v0, v1
    v_cvt_pk_bf16_f32 v1, v2, v3
    v_mfma_f32_16x16x32_bf16 v[40:43], v[160:163], v[212:215], v[40:43]
    v_cvt_pk_bf16_f32 v4, v4, v5
    v_cvt_pk_bf16_f32 v5, v6, v7
    v_mfma_f32_16x16x32_bf16 v[44:47], v[160:163], v[216:219], v[44:47]
    v_cvt_pk_bf16_f32 v8, v8, v9
    v_cvt_pk_bf16_f32 v9, v10, v11
    v_mfma_f32_16x16x32_bf16 v[48:51], v[160:163], v[220:223], v[48:51]
    v_cvt_pk_bf16_f32 v12, v12, v13
    v_cvt_pk_bf16_f32 v13, v14, v15
    s_waitcnt lgkmcnt(8)
    v_mfma_f32_16x16x32_bf16 v[56:59], v[164:167], v[208:211], v[56:59]
    v_cvt_pk_bf16_f32 v16, v16, v17
    v_cvt_pk_bf16_f32 v17, v18, v19
    v_mfma_f32_16x16x32_bf16 v[60:63], v[164:167], v[212:215], v[60:63]
    v_cvt_pk_bf16_f32 v20, v20, v21
    v_cvt_pk_bf16_f32 v21, v22, v23
    v_mfma_f32_16x16x32_bf16 v[64:67], v[164:167], v[216:219], v[64:67]
    v_cvt_pk_bf16_f32 v24, v24, v25
    v_cvt_pk_bf16_f32 v25, v26, v27
    v_mfma_f32_16x16x32_bf16 v[68:71], v[164:167], v[220:223], v[68:71]
    v_cvt_pk_bf16_f32 v28, v28, v29
    v_cvt_pk_bf16_f32 v29, v30, v31
    s_waitcnt lgkmcnt(6)
    v_mfma_f32_16x16x32_bf16 v[76:79], v[168:171], v[208:211], v[76:79]
    v_cvt_pk_bf16_f32 v36, v36, v37
    v_cvt_pk_bf16_f32 v37, v38, v39
    v_mfma_f32_16x16x32_bf16 v[80:83], v[168:171], v[212:215], v[80:83]
    v_cvt_pk_bf16_f32 v40, v40, v41
    v_cvt_pk_bf16_f32 v41, v42, v43
    v_mfma_f32_16x16x32_bf16 v[84:87], v[168:171], v[216:219], v[84:87]
    v_cvt_pk_bf16_f32 v44, v44, v45
    v_cvt_pk_bf16_f32 v45, v46, v47
    v_mfma_f32_16x16x32_bf16 v[88:91], v[168:171], v[220:223], v[88:91]
    v_cvt_pk_bf16_f32 v48, v48, v49
    v_cvt_pk_bf16_f32 v49, v50, v51
    s_waitcnt lgkmcnt(4)
    v_mfma_f32_16x16x32_bf16 v[92:95], v[204:207], v[172:175], v[92:95]
    v_cvt_pk_bf16_f32 v56, v56, v57
    v_cvt_pk_bf16_f32 v57, v58, v59
    v_mfma_f32_16x16x32_bf16 v[96:99], v[208:211], v[172:175], v[96:99]
    v_cvt_pk_bf16_f32 v60, v60, v61
    v_cvt_pk_bf16_f32 v61, v62, v63
    v_mfma_f32_16x16x32_bf16 v[100:103], v[212:215], v[172:175], v[100:103]
    v_cvt_pk_bf16_f32 v64, v64, v65
    v_cvt_pk_bf16_f32 v65, v66, v67
    v_mfma_f32_16x16x32_bf16 v[104:107], v[216:219], v[172:175], v[104:107]
    v_cvt_pk_bf16_f32 v68, v68, v69
    v_cvt_pk_bf16_f32 v69, v70, v71
    v_mfma_f32_16x16x32_bf16 v[108:111], v[220:223], v[172:175], v[108:111]
    s_waitcnt lgkmcnt(2)
    v_mfma_f32_16x16x32_bf16 v[112:115], v[204:207], v[176:179], v[112:115]
    v_cvt_pk_bf16_f32 v76, v76, v77
    v_cvt_pk_bf16_f32 v77, v78, v79
    v_mfma_f32_16x16x32_bf16 v[116:119], v[208:211], v[176:179], v[116:119]
    v_cvt_pk_bf16_f32 v80, v80, v81
    v_cvt_pk_bf16_f32 v81, v82, v83
    v_mfma_f32_16x16x32_bf16 v[120:123], v[212:215], v[176:179], v[120:123]
    v_cvt_pk_bf16_f32 v84, v84, v85
    v_cvt_pk_bf16_f32 v85, v86, v87
    v_mfma_f32_16x16x32_bf16 v[124:127], v[216:219], v[176:179], v[124:127]
    v_cvt_pk_bf16_f32 v88, v88, v89
    v_cvt_pk_bf16_f32 v89, v90, v91
    v_mfma_f32_16x16x32_bf16 v[128:131], v[220:223], v[176:179], v[128:131]
    v_mov_b32 v38, v76
    v_mov_b32 v39, v77
    s_waitcnt lgkmcnt(0)
    v_mfma_f32_16x16x32_bf16 v[132:135], v[204:207], v[180:183], v[132:135]
    v_mov_b32 v42, v80
    v_mov_b32 v43, v81
    v_mfma_f32_16x16x32_bf16 v[136:139], v[208:211], v[180:183], v[136:139]
    v_mov_b32 v46, v84
    v_mov_b32 v47, v85
    v_mfma_f32_16x16x32_bf16 v[140:143], v[212:215], v[180:183], v[140:143]
    v_mov_b32 v50, v88
    v_mov_b32 v51, v89
    v_mfma_f32_16x16x32_bf16 v[144:147], v[216:219], v[180:183], v[144:147]
    v_mfma_f32_16x16x32_bf16 v[148:151], v[220:223], v[180:183], v[148:151]
    s_waitcnt lgkmcnt(0)
    s_nop 7
    v_cvt_pk_bf16_f32 v92, v92, v93
    v_cvt_pk_bf16_f32 v93, v94, v95
    v_cvt_pk_bf16_f32 v112, v112, v113
    v_cvt_pk_bf16_f32 v113, v114, v115
    v_cvt_pk_bf16_f32 v132, v132, v133
    v_cvt_pk_bf16_f32 v133, v134, v135
    v_cvt_pk_bf16_f32 v94, v96, v97
    v_cvt_pk_bf16_f32 v95, v98, v99
    v_cvt_pk_bf16_f32 v114, v116, v117
    v_cvt_pk_bf16_f32 v115, v118, v119
    v_cvt_pk_bf16_f32 v134, v136, v137
    v_cvt_pk_bf16_f32 v135, v138, v139
    v_cvt_pk_bf16_f32 v96, v100, v101
    v_cvt_pk_bf16_f32 v97, v102, v103
    v_cvt_pk_bf16_f32 v116, v120, v121
    v_cvt_pk_bf16_f32 v117, v122, v123
    v_cvt_pk_bf16_f32 v136, v140, v141
    v_cvt_pk_bf16_f32 v137, v142, v143
    v_cvt_pk_bf16_f32 v98, v104, v105
    v_cvt_pk_bf16_f32 v99, v106, v107
    v_cvt_pk_bf16_f32 v118, v124, v125
    v_cvt_pk_bf16_f32 v119, v126, v127
    v_cvt_pk_bf16_f32 v138, v144, v145
    v_cvt_pk_bf16_f32 v139, v146, v147
    v_cvt_pk_bf16_f32 v100, v108, v109
    v_cvt_pk_bf16_f32 v101, v110, v111
    v_cvt_pk_bf16_f32 v120, v128, v129
    v_cvt_pk_bf16_f32 v121, v130, v131
    v_cvt_pk_bf16_f32 v140, v148, v149
    v_cvt_pk_bf16_f32 v141, v150, v151
    ds_write_b64 v250, v[92:93] offset:4096
    ds_write_b64 v250, v[112:113] offset:4608
    ds_write_b64 v250, v[132:133] offset:5120
    s_waitcnt lgkmcnt(0)
    v_mov_b32 v252, 1
    ds_write_b32 v251, v252 offset:4
    v_permlane32_swap_b32 v76, v38
    v_permlane32_swap_b32 v77, v39
    v_permlane32_swap_b32 v80, v42
    v_permlane32_swap_b32 v81, v43
    v_permlane32_swap_b32 v84, v46
    v_permlane32_swap_b32 v85, v47
    v_permlane32_swap_b32 v88, v50
    v_permlane32_swap_b32 v89, v51
    v_mov_b32 v58, v38
    v_mov_b32 v59, v39
    v_mov_b32 v62, v42
    v_mov_b32 v63, v43
    v_mov_b32 v66, v46
    v_mov_b32 v67, v47
    v_mov_b32 v70, v50
    v_mov_b32 v71, v51
    s_mov_b32 s60, 0x0000ffff
    s_mov_b32 s61, 0
    s_mov_b32 s62, 0xffff0000
    s_mov_b32 s63, 0
    v_cndmask_b32 v2, 0, v76, s[60:61]
    v_cndmask_b32 v3, 0, v77, s[60:61]
    v_cndmask_b32 v18, 0, v76, s[62:63]
    v_cndmask_b32 v19, 0, v77, s[62:63]
    v_cndmask_b32 v6, 0, v80, s[60:61]
    v_cndmask_b32 v7, 0, v81, s[60:61]
    v_cndmask_b32 v22, 0, v80, s[62:63]
    v_cndmask_b32 v23, 0, v81, s[62:63]
    v_cndmask_b32 v10, 0, v84, s[60:61]
    v_cndmask_b32 v11, 0, v85, s[60:61]
    v_cndmask_b32 v26, 0, v84, s[62:63]
    v_cndmask_b32 v27, 0, v85, s[62:63]
    v_cndmask_b32 v14, 0, v88, s[60:61]
    v_cndmask_b32 v15, 0, v89, s[60:61]
    v_cndmask_b32 v30, 0, v88, s[62:63]
    v_cndmask_b32 v31, 0, v89, s[62:63]
    v_mfma_f32_16x16x32_bf16 v[200:203], v[44:47], v[12:15], v[232:235]
    v_mfma_f32_16x16x32_bf16 v[204:207], v[48:51], v[12:15], v[236:239]
    v_mfma_f32_16x16x32_bf16 v[208:211], v[64:67], v[28:31], v[232:235]
    v_mfma_f32_16x16x32_bf16 v[212:215], v[68:71], v[28:31], v[236:239]
    v_mfma_f32_16x16x32_bf16 v[184:187], v[40:43], v[8:11], v[232:235]
    v_mfma_f32_16x16x32_bf16 v[188:191], v[44:47], v[8:11], v[236:239]
    v_mfma_f32_16x16x32_bf16 v[192:195], v[60:63], v[24:27], v[232:235]
    v_mfma_f32_16x16x32_bf16 v[196:199], v[64:67], v[24:27], v[236:239]
    v_mfma_f32_16x16x32_bf16 v[168:171], v[36:39], v[4:7], v[232:235]
    v_mfma_f32_16x16x32_bf16 v[172:175], v[40:43], v[4:7], v[236:239]
    v_mfma_f32_16x16x32_bf16 v[176:179], v[56:59], v[20:23], v[232:235]
    v_mfma_f32_16x16x32_bf16 v[180:183], v[60:63], v[20:23], v[236:239]
L_xspin1:
    ds_read_b32 v252, v251 offset:0
    s_waitcnt lgkmcnt(0)
    v_readfirstlane_b32 s70, v252
    s_nop 3
    s_cmp_eq_u32 s70, 0
    s_cbranch_scc1 L_xspin1
    ds_read_b128 v[32:35], v249
    ds_read_b128 v[52:55], v249 offset:1024
    ds_read_b64 v[92:93], v250 offset:2048
    ds_read_b64 v[112:113], v250 offset:2560
    ds_read_b64 v[132:133], v250 offset:3072
    s_waitcnt lgkmcnt(0)
    v_mfma_f32_16x16x32_bf16 v[152:155], v[32:35], v[0:3], v[240:243]
    v_mfma_f32_16x16x32_bf16 v[156:159], v[36:39], v[0:3], v[236:239]
    v_mfma_f32_16x16x32_bf16 v[160:163], v[52:55], v[16:19], v[240:243]
    v_mfma_f32_16x16x32_bf16 v[164:167], v[56:59], v[16:19], v[236:239]
    s_mov_b32 s64, 0x3ea52b5c
    s_mov_b32 s65, 0x3ea52b5c
    v_max3_f32 v200, v200, v201, v204
    v_max3_f32 v202, v202, v203, v206
    v_max3_f32 v208, v208, v209, v212
    v_max3_f32 v210, v210, v211, v214
    v_max3_f32 v184, v184, v185, v188
    v_max3_f32 v186, v186, v187, v190
    v_max3_f32 v192, v192, v193, v196
    v_max3_f32 v194, v194, v195, v198
    v_max3_f32 v168, v168, v169, v172
    v_max3_f32 v170, v170, v171, v174
    v_max3_f32 v176, v176, v177, v180
    v_max3_f32 v178, v178, v179, v182
    v_max3_f32 v152, v152, v153, v156
    v_max3_f32 v154, v154, v155, v158
    v_max3_f32 v160, v160, v161, v164
    v_max3_f32 v162, v162, v163, v166
    v_max_f32 v200, v200, v205
    v_max_f32 v201, v202, v207
    v_max_f32 v208, v208, v213
    v_max_f32 v209, v210, v215
    v_max_f32 v184, v184, v189
    v_max_f32 v185, v186, v191
    v_max_f32 v192, v192, v197
    v_max_f32 v193, v194, v199
    v_max_f32 v168, v168, v173
    v_max_f32 v169, v170, v175
    v_max_f32 v176, v176, v181
    v_max_f32 v177, v178, v183
    v_max_f32 v152, v152, v157
    v_max_f32 v153, v154, v159
    v_max_f32 v160, v160, v165
    v_max_f32 v161, v162, v167
    v_max_f32 v202, v200, v201
    v_max_f32 v210, v208, v209
    v_max_f32 v186, v184, v185
    v_max_f32 v194, v192, v193
    v_max_f32 v170, v168, v169
    v_max_f32 v178, v176, v177
    v_max_f32 v154, v152, v153
    v_max_f32 v162, v160, v161
    v_permlane32_swap_b32 v202, v210
    v_permlane32_swap_b32 v186, v194
    v_permlane32_swap_b32 v170, v178
    v_permlane32_swap_b32 v154, v162
    v_max_f32 v202, v202, v210
    v_max_f32 v186, v186, v194
    v_max_f32 v170, v170, v178
    v_max_f32 v154, v154, v162
    v_permlane16_swap_b32 v202, v186
    s_nop 0
    v_permlane16_swap_b32 v170, v154
    v_max_f32 v202, v202, v186
    v_max_f32 v170, v170, v154
    v_mul_f32 v202, s64, v202
    v_mul_f32 v170, s64, v170
    v_mov_b32 v186, v202
    v_mov_b32 v154, v170
    s_nop 0
    v_permlane16_swap_b32 v202, v186
    v_permlane16_swap_b32 v170, v154
    v_mov_b32 v210, v202
    v_mov_b32 v194, v186
    v_mov_b32 v178, v170
    v_mov_b32 v162, v154
    v_permlane32_swap_b32 v202, v210
    v_permlane32_swap_b32 v186, v194
    v_permlane32_swap_b32 v170, v178
    v_permlane32_swap_b32 v154, v162
    v_pk_fma_f32 v[200:201], v[200:201], s[64:65], v[202:203] op_sel_hi:[1,1,0] neg_lo:[0,0,1] neg_hi:[0,0,1]
    v_pk_fma_f32 v[208:209], v[208:209], s[64:65], v[210:211] op_sel_hi:[1,1,0] neg_lo:[0,0,1] neg_hi:[0,0,1]
    v_pk_fma_f32 v[184:185], v[184:185], s[64:65], v[186:187] op_sel_hi:[1,1,0] neg_lo:[0,0,1] neg_hi:[0,0,1]
    v_pk_fma_f32 v[192:193], v[192:193], s[64:65], v[194:195] op_sel_hi:[1,1,0] neg_lo:[0,0,1] neg_hi:[0,0,1]
    v_pk_fma_f32 v[168:169], v[168:169], s[64:65], v[170:171] op_sel_hi:[1,1,0] neg_lo:[0,0,1] neg_hi:[0,0,1]
    v_pk_fma_f32 v[176:177], v[176:177], s[64:65], v[178:179] op_sel_hi:[1,1,0] neg_lo:[0,0,1] neg_hi:[0,0,1]
    v_pk_fma_f32 v[152:153], v[152:153], s[64:65], v[154:155] op_sel_hi:[1,1,0] neg_lo:[0,0,1] neg_hi:[0,0,1]
    v_pk_fma_f32 v[160:161], v[160:161], s[64:65], v[162:163] op_sel_hi:[1,1,0] neg_lo:[0,0,1] neg_hi:[0,0,1]
    v_exp_f32 v200, v200
    v_exp_f32 v201, v201
    v_exp_f32 v208, v208
    v_exp_f32 v209, v209
    v_exp_f32 v184, v184
    v_exp_f32 v185, v185
    v_exp_f32 v192, v192
    v_exp_f32 v193, v193
    v_exp_f32 v168, v168
    v_exp_f32 v169, v169
    v_exp_f32 v176, v176
    v_exp_f32 v177, v177
    v_exp_f32 v152, v152
    v_exp_f32 v153, v153
    v_exp_f32 v160, v160
    v_exp_f32 v161, v161
    v_add_f32 v202, v200, v201
    v_add_f32 v210, v208, v209
    v_add_f32 v186, v184, v185
    v_add_f32 v194, v192, v193
    v_add_f32 v170, v168, v169
    v_add_f32 v178, v176, v177
    v_add_f32 v154, v152, v153
    v_add_f32 v162, v160, v161
    v_permlane32_swap_b32 v202, v210
    v_permlane32_swap_b32 v186, v194
    v_permlane32_swap_b32 v170, v178
    v_permlane32_swap_b32 v154, v162
    v_add_f32 v202, v202, v210
    v_add_f32 v186, v186, v194
    v_add_f32 v170, v170, v178
    v_add_f32 v154, v154, v162
    v_permlane16_swap_b32 v202, v186
    s_nop 0
    v_permlane16_swap_b32 v170, v154
    v_add_f32 v202, v202, v186
    v_add_f32 v170, v170, v154
    v_rcp_f32 v202, v202
    v_rcp_f32 v170, v170
    v_mov_b32 v186, v202
    v_mov_b32 v154, v170
    s_nop 0
    v_permlane16_swap_b32 v202, v186
    v_permlane16_swap_b32 v170, v154
    v_mov_b32 v210, v202
    v_mov_b32 v194, v186
    v_mov_b32 v178, v170
    v_mov_b32 v162, v154
    v_permlane32_swap_b32 v202, v210
    v_permlane32_swap_b32 v186, v194
    v_permlane32_swap_b32 v170, v178
    v_permlane32_swap_b32 v154, v162
    v_pk_mul_f32 v[200:201], v[200:201], v[202:203] op_sel_hi:[1,0]
    v_pk_mul_f32 v[208:209], v[208:209], v[210:211] op_sel_hi:[1,0]
    v_pk_mul_f32 v[184:185], v[184:185], v[186:187] op_sel_hi:[1,0]
    v_pk_mul_f32 v[192:193], v[192:193], v[194:195] op_sel_hi:[1,0]
    v_pk_mul_f32 v[168:169], v[168:169], v[170:171] op_sel_hi:[1,0]
    v_pk_mul_f32 v[176:177], v[176:177], v[178:179] op_sel_hi:[1,0]
    v_pk_mul_f32 v[152:153], v[152:153], v[154:155] op_sel_hi:[1,0]
    v_pk_mul_f32 v[160:161], v[160:161], v[162:163] op_sel_hi:[1,0]
    v_cvt_pk_bf16_f32 v202, v200, v201
    v_cvt_pk_bf16_f32 v210, v208, v209
    v_cvt_pk_bf16_f32 v186, v184, v185
    v_cvt_pk_bf16_f32 v194, v192, v193
    v_cvt_pk_bf16_f32 v170, v168, v169
    v_cvt_pk_bf16_f32 v178, v176, v177
    v_cvt_pk_bf16_f32 v154, v152, v153
    v_cvt_pk_bf16_f32 v162, v160, v161
    v_perm_b32 v204, v202, v202, v244
    v_perm_b32 v205, v202, v202, v245
    v_perm_b32 v206, v202, v202, v246
    v_perm_b32 v207, v202, v202, v247
    v_perm_b32 v212, v210, v210, v244
    v_perm_b32 v213, v210, v210, v245
    v_perm_b32 v214, v210, v210, v246
    v_perm_b32 v215, v210, v210, v247
    v_mfma_f32_16x16x32_bf16 v[12:15], v[98:101], v[204:207], 0
    v_mfma_f32_16x16x32_bf16 v[44:47], v[138:141], v[204:207], 0
    v_perm_b32 v188, v186, v186, v244
    v_perm_b32 v189, v186, v186, v245
    v_perm_b32 v190, v186, v186, v246
    v_perm_b32 v191, v186, v186, v247
    v_mfma_f32_16x16x32_bf16 v[28:31], v[118:121], v[212:215], 0
    v_mfma_f32_16x16x32_bf16 v[64:67], v[138:141], v[212:215], 0
    v_perm_b32 v196, v194, v194, v244
    v_perm_b32 v197, v194, v194, v245
    v_perm_b32 v198, v194, v194, v246
    v_perm_b32 v199, v194, v194, v247
    v_mfma_f32_16x16x32_bf16 v[8:11], v[96:99], v[188:191], 0
    v_mfma_f32_16x16x32_bf16 v[40:43], v[136:139], v[188:191], 0
    v_perm_b32 v172, v170, v170, v244
    v_perm_b32 v173, v170, v170, v245
    v_perm_b32 v174, v170, v170, v246
    v_perm_b32 v175, v170, v170, v247
    v_mfma_f32_16x16x32_bf16 v[24:27], v[116:119], v[196:199], 0
    v_mfma_f32_16x16x32_bf16 v[60:63], v[136:139], v[196:199], 0
    v_perm_b32 v180, v178, v178, v244
    v_perm_b32 v181, v178, v178, v245
    v_perm_b32 v182, v178, v178, v246
    v_perm_b32 v183, v178, v178, v247
    v_mfma_f32_16x16x32_bf16 v[4:7], v[94:97], v[172:175], 0
    v_mfma_f32_16x16x32_bf16 v[36:39], v[134:137], v[172:175], 0
    v_perm_b32 v156, v154, v154, v244
    v_perm_b32 v157, v154, v154, v245
    v_perm_b32 v158, v154, v154, v246
    v_perm_b32 v159, v154, v154, v247
    v_mfma_f32_16x16x32_bf16 v[20:23], v[114:117], v[180:183], 0
    v_mfma_f32_16x16x32_bf16 v[56:59], v[134:137], v[180:183], 0
    v_perm_b32 v164, v162, v162, v244
    v_perm_b32 v165, v162, v162, v245
    v_perm_b32 v166, v162, v162, v246
    v_perm_b32 v167, v162, v162, v247
    v_mfma_f32_16x16x32_bf16 v[0:3], v[92:95], v[156:159], 0
    v_mfma_f32_16x16x32_bf16 v[32:35], v[132:135], v[156:159], 0
    v_mfma_f32_16x16x32_bf16 v[16:19], v[112:115], v[164:167], 0
    v_mfma_f32_16x16x32_bf16 v[52:55], v[132:135], v[164:167], 0
    v_cvt_pk_bf16_f32 v200, v12, v13
    v_cvt_pk_bf16_f32 v201, v14, v15
    v_cvt_pk_bf16_f32 v202, v28, v29
    v_cvt_pk_bf16_f32 v203, v30, v31
    s_add_u32 s68, s66, 61440
    buffer_store_dwordx4 v[200:203], v248, s[40:43], s68 offen sc1
    v_cvt_pk_bf16_f32 v184, v8, v9
    v_cvt_pk_bf16_f32 v185, v10, v11
    v_cvt_pk_bf16_f32 v186, v24, v25
    v_cvt_pk_bf16_f32 v187, v26, v27
    s_add_u32 s68, s66, 40960
    buffer_store_dwordx4 v[184:187], v248, s[40:43], s68 offen sc1
    v_cndmask_b32 v44, v44, v64, s[62:63]
    v_cndmask_b32 v45, v45, v65, s[62:63]
    v_cndmask_b32 v46, v46, v66, s[62:63]
    v_cndmask_b32 v47, v47, v67, s[62:63]
    v_cvt_pk_bf16_f32 v194, v44, v45
    v_cvt_pk_bf16_f32 v195, v46, v47
    v_cndmask_b32 v40, v40, v60, s[62:63]
    v_cndmask_b32 v41, v41, v61, s[62:63]
    v_cndmask_b32 v42, v42, v62, s[62:63]
    v_cndmask_b32 v43, v43, v63, s[62:63]
    v_cvt_pk_bf16_f32 v192, v40, v41
    v_cvt_pk_bf16_f32 v193, v42, v43
    v_cvt_pk_bf16_f32 v168, v4, v5
    v_cvt_pk_bf16_f32 v169, v6, v7
    v_cvt_pk_bf16_f32 v170, v20, v21
    v_cvt_pk_bf16_f32 v171, v22, v23
    s_add_u32 s68, s66, 20480
    buffer_store_dwordx4 v[168:171], v248, s[40:43], s68 offen sc1
    v_cndmask_b32 v36, v36, v56, s[62:63]
    v_cndmask_b32 v37, v37, v57, s[62:63]
    v_cndmask_b32 v38, v38, v58, s[62:63]
    v_cndmask_b32 v39, v39, v59, s[62:63]
    v_cvt_pk_bf16_f32 v162, v36, v37
    v_cvt_pk_bf16_f32 v163, v38, v39
    v_cvt_pk_bf16_f32 v152, v0, v1
    v_cvt_pk_bf16_f32 v153, v2, v3
    v_cvt_pk_bf16_f32 v154, v16, v17
    v_cvt_pk_bf16_f32 v155, v18, v19
    s_add_u32 s68, s66, 0
    buffer_store_dwordx4 v[152:155], v248, s[40:43], s68 offen sc1
    v_cndmask_b32 v32, v32, v52, s[62:63]
    v_cndmask_b32 v33, v33, v53, s[62:63]
    v_cndmask_b32 v34, v34, v54, s[62:63]
    v_cndmask_b32 v35, v35, v55, s[62:63]
    v_cvt_pk_bf16_f32 v160, v32, v33
    v_cvt_pk_bf16_f32 v161, v34, v35
    s_mov_b32 exec_hi, 0
    s_add_u32 s68, s67, 0
    buffer_store_dwordx4 v[160:163], v248, s[40:43], s68 offen sc1
    s_add_u32 s68, s67, 20480
    buffer_store_dwordx4 v[192:195], v248, s[40:43], s68 offen sc1
    s_mov_b32 exec_hi, -1
    s_endpgm
L_cons_F:
    s_and_b32 s55, s24, 1
    s_lshr_b32 s56, s24, 1
    v_and_b32 v3, 15, v2
    v_lshrrev_b32 v4, 4, v2
    v_lshrrev_b32 v5, 1, v3
    v_xor_b32 v5, v5, v4
    v_lshlrev_b32 v5, 4, v5
    v_lshl_add_u32 v5, v3, 7, v5
    s_lshl_b32 s57, s56, 13
    v_add_u32 v224, s57, v5
    v_xor_b32 v225, 64, v224
    v_lshrrev_b32 v5, 5, v2
    v_lshlrev_b32 v5, 4, v5
    v_bfe_u32 v6, v2, 4, 1
    v_lshl_add_u32 v5, v6, 2, v5
    v_bfe_u32 v6, v2, 2, 2
    v_add_u32 v5, v5, v6
    v_mul_u32_u24 v5, 480, v5
    v_add_u32 v5, 18432, v5
    v_and_b32 v6, 3, v2
    v_lshl_add_u32 v5, v6, 3, v5
    s_lshl_b32 s57, s55, 8
    v_add_u32 v226, s57, v5
    s_lshl_b32 s57, s55, 5
    s_add_u32 s57, s57, 192
    v_add_u32 v227, s57, v5
    s_mul_i32 s57, s27, 448
    v_lshlrev_b32 v5, 3, v4
    v_add_u32 v5, s57, v5
    s_lshl_b32 s57, s55, 8
    v_add_u32 v6, s57, v5
    s_lshl_b32 s57, s55, 5
    s_add_u32 s57, s57, 192
    v_add_u32 v7, s57, v5
    v_lshlrev_b32 v248, 4, v2
    s_waitcnt lgkmcnt(0)
    s_mov_b32 s44, s14
    s_mov_b32 s45, s15
    s_mov_b32 s46, 3456
    s_mov_b32 s47, 0x20000
    buffer_load_dwordx2 v[200:201], v6, s[44:47], 0 offen offset:0
    buffer_load_dwordx2 v[202:203], v6, s[44:47], 0 offen offset:32
    buffer_load_dwordx2 v[204:205], v6, s[44:47], 0 offen offset:64
    buffer_load_dwordx2 v[206:207], v6, s[44:47], 0 offen offset:96
    buffer_load_dwordx2 v[208:209], v6, s[44:47], 0 offen offset:128
    buffer_load_dwordx2 v[210:211], v6, s[44:47], 0 offen offset:160
    buffer_load_dwordx2 v[212:213], v7, s[44:47], 0 offen
    s_mov_b32 s58, 0xffff0000
    s_waitcnt vmcnt(0)
    v_lshlrev_b32 v0, 16, v200
    v_and_b32 v1, s58, v200
    v_lshlrev_b32 v2, 16, v201
    v_and_b32 v3, s58, v201
    v_lshlrev_b32 v4, 16, v200
    v_and_b32 v5, s58, v200
    v_lshlrev_b32 v6, 16, v201
    v_and_b32 v7, s58, v201
    v_lshlrev_b32 v8, 16, v200
    v_and_b32 v9, s58, v200
    v_lshlrev_b32 v10, 16, v201
    v_and_b32 v11, s58, v201
    v_lshlrev_b32 v12, 16, v200
    v_and_b32 v13, s58, v200
    v_lshlrev_b32 v14, 16, v201
    v_and_b32 v15, s58, v201
    v_lshlrev_b32 v16, 16, v202
    v_and_b32 v17, s58, v202
    v_lshlrev_b32 v18, 16, v203
    v_and_b32 v19, s58, v203
    v_lshlrev_b32 v20, 16, v202
    v_and_b32 v21, s58, v202
    v_lshlrev_b32 v22, 16, v203
    v_and_b32 v23, s58, v203
    v_lshlrev_b32 v24, 16, v202
    v_and_b32 v25, s58, v202
    v_lshlrev_b32 v26, 16, v203
    v_and_b32 v27, s58, v203
    v_lshlrev_b32 v28, 16, v202
    v_and_b32 v29, s58, v202
    v_lshlrev_b32 v30, 16, v203
    v_and_b32 v31, s58, v203
    v_lshlrev_b32 v32, 16, v204
    v_and_b32 v33, s58, v204
    v_lshlrev_b32 v34, 16, v205
    v_and_b32 v35, s58, v205
    v_lshlrev_b32 v36, 16, v204
    v_and_b32 v37, s58, v204
    v_lshlrev_b32 v38, 16, v205
    v_and_b32 v39, s58, v205
    v_lshlrev_b32 v40, 16, v204
    v_and_b32 v41, s58, v204
    v_lshlrev_b32 v42, 16, v205
    v_and_b32 v43, s58, v205
    v_lshlrev_b32 v44, 16, v204
    v_and_b32 v45, s58, v204
    v_lshlrev_b32 v46, 16, v205
    v_and_b32 v47, s58, v205
    v_lshlrev_b32 v48, 16, v206
    v_and_b32 v49, s58, v206
    v_lshlrev_b32 v50, 16, v207
    v_and_b32 v51, s58, v207
    v_lshlrev_b32 v52, 16, v206
    v_and_b32 v53, s58, v206
    v_lshlrev_b32 v54, 16, v207
    v_and_b32 v55, s58, v207
    v_lshlrev_b32 v56, 16, v206
    v_and_b32 v57, s58, v206
    v_lshlrev_b32 v58, 16, v207
    v_and_b32 v59, s58, v207
    v_lshlrev_b32 v60, 16, v206
    v_and_b32 v61, s58, v206
    v_lshlrev_b32 v62, 16, v207
    v_and_b32 v63, s58, v207
    v_lshlrev_b32 v64, 16, v208
    v_and_b32 v65, s58, v208
    v_lshlrev_b32 v66, 16, v209
    v_and_b32 v67, s58, v209
    v_lshlrev_b32 v68, 16, v208
    v_and_b32 v69, s58, v208
    v_lshlrev_b32 v70, 16, v209
    v_and_b32 v71, s58, v209
    v_lshlrev_b32 v72, 16, v208
    v_and_b32 v73, s58, v208
    v_lshlrev_b32 v74, 16, v209
    v_and_b32 v75, s58, v209
    v_lshlrev_b32 v76, 16, v208
    v_and_b32 v77, s58, v208
    v_lshlrev_b32 v78, 16, v209
    v_and_b32 v79, s58, v209
    v_lshlrev_b32 v80, 16, v210
    v_and_b32 v81, s58, v210
    v_lshlrev_b32 v82, 16, v211
    v_and_b32 v83, s58, v211
    v_lshlrev_b32 v84, 16, v210
    v_and_b32 v85, s58, v210
    v_lshlrev_b32 v86, 16, v211
    v_and_b32 v87, s58, v211
    v_lshlrev_b32 v88, 16, v210
    v_and_b32 v89, s58, v210
    v_lshlrev_b32 v90, 16, v211
    v_and_b32 v91, s58, v211
    v_lshlrev_b32 v92, 16, v210
    v_and_b32 v93, s58, v210
    v_lshlrev_b32 v94, 16, v211
    v_and_b32 v95, s58, v211
    v_lshlrev_b32 v96, 16, v212
    v_and_b32 v97, s58, v212
    v_lshlrev_b32 v98, 16, v213
    v_and_b32 v99, s58, v213
    v_lshlrev_b32 v100, 16, v212
    v_and_b32 v101, s58, v212
    v_lshlrev_b32 v102, 16, v213
    v_and_b32 v103, s58, v213
    v_lshlrev_b32 v104, 16, v212
    v_and_b32 v105, s58, v212
    v_lshlrev_b32 v106, 16, v213
    v_and_b32 v107, s58, v213
    v_lshlrev_b32 v108, 16, v212
    v_and_b32 v109, s58, v212
    v_lshlrev_b32 v110, 16, v213
    v_and_b32 v111, s58, v213
    s_mov_b32 s40, s22
    s_mov_b32 s41, s23
    s_mov_b32 s42, 12750848
    s_mov_b32 s43, 0x20000
    s_mov_b32 s28, s4
    s_mov_b32 s29, s5
    s_mov_b32 s30, 2621440
    s_mov_b32 s31, 0x20000
    s_mov_b32 s32, s12
    s_mov_b32 s33, s13
    s_mov_b32 s34, 2211840
    s_mov_b32 s35, 0x20000
    s_waitcnt lgkmcnt(0)
    s_barrier
    ds_read_b64_tr_b16 v[152:153], v226 offset:0
    ds_read_b64_tr_b16 v[154:155], v226 offset:3840
    ds_read_b64_tr_b16 v[156:157], v226 offset:32
    ds_read_b64_tr_b16 v[158:159], v226 offset:3872
    ds_read_b64_tr_b16 v[160:161], v226 offset:64
    ds_read_b64_tr_b16 v[162:163], v226 offset:3904
    ds_read_b128 v[184:187], v224 offset:0
    ds_read_b128 v[188:191], v224 offset:2048
    ds_read_b64_tr_b16 v[164:165], v226 offset:96
    ds_read_b64_tr_b16 v[166:167], v226 offset:3936
    ds_read_b128 v[192:195], v224 offset:4096
    ds_read_b128 v[196:199], v224 offset:6144
    ds_read_b64_tr_b16 v[168:169], v226 offset:128
    ds_read_b64_tr_b16 v[170:171], v226 offset:3968
    ds_read_b64_tr_b16 v[172:173], v226 offset:160
    ds_read_b64_tr_b16 v[174:175], v226 offset:4000
    s_mov_b32 s52, 0
    s_mov_b32 s53, 0
    s_mov_b32 s51, 4294868992
L_loop_F:
    s_waitcnt lgkmcnt(4)
    v_mfma_f32_16x16x32_bf16 v[0:3], v[152:155], v[184:187], v[0:3]
    ds_read_b64_tr_b16 v[176:177], v227 offset:0
    v_mfma_f32_16x16x32_bf16 v[4:7], v[152:155], v[188:191], v[4:7]
    ds_read_b64_tr_b16 v[178:179], v227 offset:3840
    v_mfma_f32_16x16x32_bf16 v[8:11], v[152:155], v[192:195], v[8:11]
    ds_read_b128 v[204:207], v225 offset:0
    v_mfma_f32_16x16x32_bf16 v[12:15], v[152:155], v[196:199], v[12:15]
    ds_read_b128 v[208:211], v225 offset:2048
    v_mfma_f32_16x16x32_bf16 v[16:19], v[156:159], v[184:187], v[16:19]
    ds_read_b64_tr_b16 v[152:153], v226 offset:15360
    v_mfma_f32_16x16x32_bf16 v[20:23], v[156:159], v[188:191], v[20:23]
    ds_read_b64_tr_b16 v[154:155], v226 offset:19200
    v_mfma_f32_16x16x32_bf16 v[24:27], v[156:159], v[192:195], v[24:27]
    ds_read_b128 v[212:215], v225 offset:4096
    v_mfma_f32_16x16x32_bf16 v[28:31], v[156:159], v[196:199], v[28:31]
    ds_read_b128 v[216:219], v225 offset:6144
    v_mfma_f32_16x16x32_bf16 v[32:35], v[160:163], v[184:187], v[32:35]
    ds_read_b64_tr_b16 v[156:157], v226 offset:15392
    v_mfma_f32_16x16x32_bf16 v[36:39], v[160:163], v[188:191], v[36:39]
    ds_read_b64_tr_b16 v[158:159], v226 offset:19232
    v_mfma_f32_16x16x32_bf16 v[40:43], v[160:163], v[192:195], v[40:43]
    v_mfma_f32_16x16x32_bf16 v[44:47], v[160:163], v[196:199], v[44:47]
    v_mfma_f32_16x16x32_bf16 v[48:51], v[164:167], v[184:187], v[48:51]
    ds_read_b64_tr_b16 v[160:161], v226 offset:15424
    v_mfma_f32_16x16x32_bf16 v[52:55], v[164:167], v[188:191], v[52:55]
    ds_read_b64_tr_b16 v[162:163], v226 offset:19264
    v_mfma_f32_16x16x32_bf16 v[56:59], v[164:167], v[192:195], v[56:59]
    v_mfma_f32_16x16x32_bf16 v[60:63], v[164:167], v[196:199], v[60:63]
    s_waitcnt lgkmcnt(14)
    v_mfma_f32_16x16x32_bf16 v[64:67], v[168:171], v[184:187], v[64:67]
    ds_read_b64_tr_b16 v[164:165], v226 offset:15456
    v_mfma_f32_16x16x32_bf16 v[68:71], v[168:171], v[188:191], v[68:71]
    ds_read_b64_tr_b16 v[166:167], v226 offset:19296
    v_mfma_f32_16x16x32_bf16 v[72:75], v[168:171], v[192:195], v[72:75]
    v_mfma_f32_16x16x32_bf16 v[76:79], v[168:171], v[196:199], v[76:79]
    s_waitcnt lgkmcnt(14)
    v_mfma_f32_16x16x32_bf16 v[80:83], v[172:175], v[184:187], v[80:83]
    ds_read_b64_tr_b16 v[168:169], v226 offset:15488
    v_mfma_f32_16x16x32_bf16 v[84:87], v[172:175], v[188:191], v[84:87]
    ds_read_b64_tr_b16 v[170:171], v226 offset:19328
    v_mfma_f32_16x16x32_bf16 v[88:91], v[172:175], v[192:195], v[88:91]
    v_mfma_f32_16x16x32_bf16 v[92:95], v[172:175], v[196:199], v[92:95]
    s_waitcnt lgkmcnt(14)
    v_mfma_f32_16x16x32_bf16 v[96:99], v[176:179], v[184:187], v[96:99]
    ds_read_b64_tr_b16 v[172:173], v226 offset:15520
    v_mfma_f32_16x16x32_bf16 v[100:103], v[176:179], v[188:191], v[100:103]
    ds_read_b64_tr_b16 v[174:175], v226 offset:19360
    s_add_u32 s53, s53, 49152
    s_cmp_eq_u32 s53, 147456
    v_mfma_f32_16x16x32_bf16 v[104:107], v[176:179], v[192:195], v[104:107]
    s_cselect_b32 s54, s51, 49152
    s_cselect_b32 s53, 0, s53
    v_mfma_f32_16x16x32_bf16 v[108:111], v[176:179], v[196:199], v[108:111]
    s_waitcnt lgkmcnt(10)
    v_mfma_f32_16x16x32_bf16 v[0:3], v[152:155], v[204:207], v[0:3]
    ds_read_b64_tr_b16 v[176:177], v227 offset:15360
    v_mfma_f32_16x16x32_bf16 v[4:7], v[152:155], v[208:211], v[4:7]
    ds_read_b64_tr_b16 v[178:179], v227 offset:19200
    v_mfma_f32_16x16x32_bf16 v[8:11], v[152:155], v[212:215], v[8:11]
    v_add_u32 v226, s54, v226
    v_mfma_f32_16x16x32_bf16 v[12:15], v[152:155], v[216:219], v[12:15]
    v_add_u32 v224, s54, v224
    s_waitcnt lgkmcnt(10)
    v_mfma_f32_16x16x32_bf16 v[16:19], v[156:159], v[204:207], v[16:19]
    v_add_u32 v225, s54, v225
    v_mfma_f32_16x16x32_bf16 v[20:23], v[156:159], v[208:211], v[20:23]
    v_add_u32 v227, s54, v227
    v_mfma_f32_16x16x32_bf16 v[24:27], v[156:159], v[212:215], v[24:27]
    v_mfma_f32_16x16x32_bf16 v[28:31], v[156:159], v[216:219], v[28:31]
    s_waitcnt lgkmcnt(0)
    s_barrier
    v_mfma_f32_16x16x32_bf16 v[32:35], v[160:163], v[204:207], v[32:35]
    ds_read_b64_tr_b16 v[152:153], v226 offset:0
    v_mfma_f32_16x16x32_bf16 v[36:39], v[160:163], v[208:211], v[36:39]
    ds_read_b64_tr_b16 v[154:155], v226 offset:3840
    v_mfma_f32_16x16x32_bf16 v[40:43], v[160:163], v[212:215], v[40:43]
    ds_read_b64_tr_b16 v[156:157], v226 offset:32
    v_mfma_f32_16x16x32_bf16 v[44:47], v[160:163], v[216:219], v[44:47]
    ds_read_b64_tr_b16 v[158:159], v226 offset:3872
    v_mfma_f32_16x16x32_bf16 v[48:51], v[164:167], v[204:207], v[48:51]
    ds_read_b64_tr_b16 v[160:161], v226 offset:64
    v_mfma_f32_16x16x32_bf16 v[52:55], v[164:167], v[208:211], v[52:55]
    ds_read_b64_tr_b16 v[162:163], v226 offset:3904
    v_mfma_f32_16x16x32_bf16 v[56:59], v[164:167], v[212:215], v[56:59]
    ds_read_b128 v[184:187], v224 offset:0
    v_mfma_f32_16x16x32_bf16 v[60:63], v[164:167], v[216:219], v[60:63]
    ds_read_b128 v[188:191], v224 offset:2048
    v_mfma_f32_16x16x32_bf16 v[64:67], v[168:171], v[204:207], v[64:67]
    ds_read_b64_tr_b16 v[164:165], v226 offset:96
    v_mfma_f32_16x16x32_bf16 v[68:71], v[168:171], v[208:211], v[68:71]
    ds_read_b64_tr_b16 v[166:167], v226 offset:3936
    v_mfma_f32_16x16x32_bf16 v[72:75], v[168:171], v[212:215], v[72:75]
    ds_read_b128 v[192:195], v224 offset:4096
    v_mfma_f32_16x16x32_bf16 v[76:79], v[168:171], v[216:219], v[76:79]
    ds_read_b128 v[196:199], v224 offset:6144
    v_mfma_f32_16x16x32_bf16 v[80:83], v[172:175], v[204:207], v[80:83]
    ds_read_b64_tr_b16 v[168:169], v226 offset:128
    v_mfma_f32_16x16x32_bf16 v[84:87], v[172:175], v[208:211], v[84:87]
    ds_read_b64_tr_b16 v[170:171], v226 offset:3968
    v_mfma_f32_16x16x32_bf16 v[88:91], v[172:175], v[212:215], v[88:91]
    v_mfma_f32_16x16x32_bf16 v[92:95], v[172:175], v[216:219], v[92:95]
    v_mfma_f32_16x16x32_bf16 v[96:99], v[176:179], v[204:207], v[96:99]
    ds_read_b64_tr_b16 v[172:173], v226 offset:160
    v_mfma_f32_16x16x32_bf16 v[100:103], v[176:179], v[208:211], v[100:103]
    ds_read_b64_tr_b16 v[174:175], v226 offset:4000
    v_mfma_f32_16x16x32_bf16 v[104:107], v[176:179], v[212:215], v[104:107]
    v_mfma_f32_16x16x32_bf16 v[108:111], v[176:179], v[216:219], v[108:111]
    s_add_u32 s52, s52, 1
    s_cmp_lt_u32 s52, 9
    s_cbranch_scc1 L_loop_F
    s_waitcnt lgkmcnt(4)
    v_mfma_f32_16x16x32_bf16 v[0:3], v[152:155], v[184:187], v[0:3]
    ds_read_b64_tr_b16 v[176:177], v227 offset:0
    v_mfma_f32_16x16x32_bf16 v[4:7], v[152:155], v[188:191], v[4:7]
    ds_read_b64_tr_b16 v[178:179], v227 offset:3840
    v_mfma_f32_16x16x32_bf16 v[8:11], v[152:155], v[192:195], v[8:11]
    ds_read_b128 v[204:207], v225 offset:0
    v_mfma_f32_16x16x32_bf16 v[12:15], v[152:155], v[196:199], v[12:15]
    ds_read_b128 v[208:211], v225 offset:2048
    v_mfma_f32_16x16x32_bf16 v[16:19], v[156:159], v[184:187], v[16:19]
    ds_read_b64_tr_b16 v[152:153], v226 offset:15360
    v_mfma_f32_16x16x32_bf16 v[20:23], v[156:159], v[188:191], v[20:23]
    ds_read_b64_tr_b16 v[154:155], v226 offset:19200
    v_mfma_f32_16x16x32_bf16 v[24:27], v[156:159], v[192:195], v[24:27]
    ds_read_b128 v[212:215], v225 offset:4096
    v_mfma_f32_16x16x32_bf16 v[28:31], v[156:159], v[196:199], v[28:31]
    ds_read_b128 v[216:219], v225 offset:6144
    v_mfma_f32_16x16x32_bf16 v[32:35], v[160:163], v[184:187], v[32:35]
    ds_read_b64_tr_b16 v[156:157], v226 offset:15392
    v_mfma_f32_16x16x32_bf16 v[36:39], v[160:163], v[188:191], v[36:39]
    ds_read_b64_tr_b16 v[158:159], v226 offset:19232
    v_mfma_f32_16x16x32_bf16 v[40:43], v[160:163], v[192:195], v[40:43]
    v_mfma_f32_16x16x32_bf16 v[44:47], v[160:163], v[196:199], v[44:47]
    v_mfma_f32_16x16x32_bf16 v[48:51], v[164:167], v[184:187], v[48:51]
    ds_read_b64_tr_b16 v[160:161], v226 offset:15424
    v_mfma_f32_16x16x32_bf16 v[52:55], v[164:167], v[188:191], v[52:55]
    ds_read_b64_tr_b16 v[162:163], v226 offset:19264
    v_mfma_f32_16x16x32_bf16 v[56:59], v[164:167], v[192:195], v[56:59]
    v_mfma_f32_16x16x32_bf16 v[60:63], v[164:167], v[196:199], v[60:63]
    s_waitcnt lgkmcnt(14)
    v_mfma_f32_16x16x32_bf16 v[64:67], v[168:171], v[184:187], v[64:67]
    ds_read_b64_tr_b16 v[164:165], v226 offset:15456
    v_mfma_f32_16x16x32_bf16 v[68:71], v[168:171], v[188:191], v[68:71]
    ds_read_b64_tr_b16 v[166:167], v226 offset:19296
    v_mfma_f32_16x16x32_bf16 v[72:75], v[168:171], v[192:195], v[72:75]
    v_mfma_f32_16x16x32_bf16 v[76:79], v[168:171], v[196:199], v[76:79]
    s_waitcnt lgkmcnt(14)
    v_mfma_f32_16x16x32_bf16 v[80:83], v[172:175], v[184:187], v[80:83]
    ds_read_b64_tr_b16 v[168:169], v226 offset:15488
    v_mfma_f32_16x16x32_bf16 v[84:87], v[172:175], v[188:191], v[84:87]
    ds_read_b64_tr_b16 v[170:171], v226 offset:19328
    v_mfma_f32_16x16x32_bf16 v[88:91], v[172:175], v[192:195], v[88:91]
    v_mfma_f32_16x16x32_bf16 v[92:95], v[172:175], v[196:199], v[92:95]
    s_waitcnt lgkmcnt(14)
    v_mfma_f32_16x16x32_bf16 v[96:99], v[176:179], v[184:187], v[96:99]
    ds_read_b64_tr_b16 v[172:173], v226 offset:15520
    v_mfma_f32_16x16x32_bf16 v[100:103], v[176:179], v[188:191], v[100:103]
    ds_read_b64_tr_b16 v[174:175], v226 offset:19360
    s_add_u32 s53, s53, 49152
    s_cmp_eq_u32 s53, 147456
    v_mfma_f32_16x16x32_bf16 v[104:107], v[176:179], v[192:195], v[104:107]
    s_cselect_b32 s54, s51, 49152
    s_cselect_b32 s53, 0, s53
    v_mfma_f32_16x16x32_bf16 v[108:111], v[176:179], v[196:199], v[108:111]
    s_waitcnt lgkmcnt(10)
    v_mfma_f32_16x16x32_bf16 v[0:3], v[152:155], v[204:207], v[0:3]
    ds_read_b64_tr_b16 v[176:177], v227 offset:15360
    v_mfma_f32_16x16x32_bf16 v[4:7], v[152:155], v[208:211], v[4:7]
    ds_read_b64_tr_b16 v[178:179], v227 offset:19200
    v_mfma_f32_16x16x32_bf16 v[8:11], v[152:155], v[212:215], v[8:11]
    v_mfma_f32_16x16x32_bf16 v[12:15], v[152:155], v[216:219], v[12:15]
    s_waitcnt lgkmcnt(10)
    v_mfma_f32_16x16x32_bf16 v[16:19], v[156:159], v[204:207], v[16:19]
    v_mfma_f32_16x16x32_bf16 v[20:23], v[156:159], v[208:211], v[20:23]
    v_mfma_f32_16x16x32_bf16 v[24:27], v[156:159], v[212:215], v[24:27]
    v_mfma_f32_16x16x32_bf16 v[28:31], v[156:159], v[216:219], v[28:31]
    s_waitcnt lgkmcnt(8)
    v_mfma_f32_16x16x32_bf16 v[32:35], v[160:163], v[204:207], v[32:35]
    v_mfma_f32_16x16x32_bf16 v[36:39], v[160:163], v[208:211], v[36:39]
    v_mfma_f32_16x16x32_bf16 v[40:43], v[160:163], v[212:215], v[40:43]
    v_mfma_f32_16x16x32_bf16 v[44:47], v[160:163], v[216:219], v[44:47]
    s_waitcnt lgkmcnt(6)
    v_mfma_f32_16x16x32_bf16 v[48:51], v[164:167], v[204:207], v[48:51]
    v_mfma_f32_16x16x32_bf16 v[52:55], v[164:167], v[208:211], v[52:55]
    v_mfma_f32_16x16x32_bf16 v[56:59], v[164:167], v[212:215], v[56:59]
    v_mfma_f32_16x16x32_bf16 v[60:63], v[164:167], v[216:219], v[60:63]
    s_waitcnt lgkmcnt(4)
    v_mfma_f32_16x16x32_bf16 v[64:67], v[168:171], v[204:207], v[64:67]
    v_mfma_f32_16x16x32_bf16 v[68:71], v[168:171], v[208:211], v[68:71]
    v_mfma_f32_16x16x32_bf16 v[72:75], v[168:171], v[212:215], v[72:75]
    v_mfma_f32_16x16x32_bf16 v[76:79], v[168:171], v[216:219], v[76:79]
    s_waitcnt lgkmcnt(2)
    v_mfma_f32_16x16x32_bf16 v[80:83], v[172:175], v[204:207], v[80:83]
    v_mfma_f32_16x16x32_bf16 v[84:87], v[172:175], v[208:211], v[84:87]
    v_mfma_f32_16x16x32_bf16 v[88:91], v[172:175], v[212:215], v[88:91]
    v_mfma_f32_16x16x32_bf16 v[92:95], v[172:175], v[216:219], v[92:95]
    s_waitcnt lgkmcnt(0)
    v_mfma_f32_16x16x32_bf16 v[96:99], v[176:179], v[204:207], v[96:99]
    v_mfma_f32_16x16x32_bf16 v[100:103], v[176:179], v[208:211], v[100:103]
    v_mfma_f32_16x16x32_bf16 v[104:107], v[176:179], v[212:215], v[104:107]
    v_mfma_f32_16x16x32_bf16 v[108:111], v[176:179], v[216:219], v[108:111]
    s_waitcnt lgkmcnt(0)
    v_mov_b32 v240, 0xc0135761
    v_mov_b32 v242, 0xbdd2d3e8
    v_mov_b32 v244, 1.0
    v_mov_b32 v241, 0xc0135761
    v_mov_b32 v243, 0xbdd2d3e8
    v_mov_b32 v245, 1.0
    s_nop 5
    s_lshl_b32 s65, s26, 3
    s_lshl_b32 s66, s56, 2
    s_add_u32 s65, s65, s66
    s_mul_i32 s65, s65, 54
    s_mul_i32 s66, s27, 7
    s_add_u32 s67, s66, 3
    s_lshl_b32 s68, s55, 2
    s_add_u32 s66, s66, s68
    s_add_u32 s69, s65, s67
    s_lshl_b32 s69, s69, 10
    s_lshl_b32 s68, s55, 3
    s_add_u32 s69, s69, s68
    s_add_u32 s68, s65, s66
    s_lshl_b32 s68, s68, 10
    s_add_u32 s70, s66, 0
    s_cmp_ge_u32 s70, 54
    s_cbranch_scc1 L_skip_pair0
    v_pk_mul_f32 v[152:153], v[0:1], v[0:1]
    v_pk_mul_f32 v[156:157], v[2:3], v[2:3]
    v_pk_mul_f32 v[160:161], v[16:17], v[16:17]
    v_pk_mul_f32 v[164:165], v[18:19], v[18:19]
    v_pk_fma_f32 v[152:153], v[152:153], v[242:243], v[240:241]
    v_pk_fma_f32 v[156:157], v[156:157], v[242:243], v[240:241]
    v_pk_fma_f32 v[160:161], v[160:161], v[242:243], v[240:241]
    v_pk_fma_f32 v[164:165], v[164:165], v[242:243], v[240:241]
    v_pk_mul_f32 v[152:153], v[152:153], v[0:1]
    v_pk_mul_f32 v[156:157], v[156:157], v[2:3]
    v_pk_mul_f32 v[160:161], v[160:161], v[16:17]
    v_pk_mul_f32 v[164:165], v[164:165], v[18:19]
    v_exp_f32 v152, v152
    v_exp_f32 v153, v153
    v_exp_f32 v156, v156
    v_exp_f32 v157, v157
    v_exp_f32 v160, v160
    v_exp_f32 v161, v161
    v_exp_f32 v164, v164
    v_exp_f32 v165, v165
    v_pk_add_f32 v[152:153], v[152:153], v[244:245]
    v_pk_add_f32 v[156:157], v[156:157], v[244:245]
    v_pk_add_f32 v[160:161], v[160:161], v[244:245]
    v_pk_add_f32 v[164:165], v[164:165], v[244:245]
    v_rcp_f32 v152, v152
    v_rcp_f32 v153, v153
    v_rcp_f32 v156, v156
    v_rcp_f32 v157, v157
    v_rcp_f32 v160, v160
    v_rcp_f32 v161, v161
    v_rcp_f32 v164, v164
    v_rcp_f32 v165, v165
    v_pk_mul_f32 v[0:1], v[152:153], v[0:1]
    v_pk_mul_f32 v[2:3], v[156:157], v[2:3]
    v_pk_mul_f32 v[16:17], v[160:161], v[16:17]
    v_pk_mul_f32 v[18:19], v[164:165], v[18:19]
    v_cvt_pk_bf16_f32 v184, v0, v1
    v_cvt_pk_bf16_f32 v185, v2, v3
    v_cvt_pk_bf16_f32 v186, v16, v17
    v_cvt_pk_bf16_f32 v187, v18, v19
    s_add_u32 s70, s68, 0
    buffer_store_dwordx4 v[184:187], v248, s[40:43], s70 offen sc1
    v_pk_mul_f32 v[152:153], v[4:5], v[4:5]
    v_pk_mul_f32 v[156:157], v[6:7], v[6:7]
    v_pk_mul_f32 v[160:161], v[20:21], v[20:21]
    v_pk_mul_f32 v[164:165], v[22:23], v[22:23]
    v_pk_fma_f32 v[152:153], v[152:153], v[242:243], v[240:241]
    v_pk_fma_f32 v[156:157], v[156:157], v[242:243], v[240:241]
    v_pk_fma_f32 v[160:161], v[160:161], v[242:243], v[240:241]
    v_pk_fma_f32 v[164:165], v[164:165], v[242:243], v[240:241]
    v_pk_mul_f32 v[152:153], v[152:153], v[4:5]
    v_pk_mul_f32 v[156:157], v[156:157], v[6:7]
    v_pk_mul_f32 v[160:161], v[160:161], v[20:21]
    v_pk_mul_f32 v[164:165], v[164:165], v[22:23]
    v_exp_f32 v152, v152
    v_exp_f32 v153, v153
    v_exp_f32 v156, v156
    v_exp_f32 v157, v157
    v_exp_f32 v160, v160
    v_exp_f32 v161, v161
    v_exp_f32 v164, v164
    v_exp_f32 v165, v165
    v_pk_add_f32 v[152:153], v[152:153], v[244:245]
    v_pk_add_f32 v[156:157], v[156:157], v[244:245]
    v_pk_add_f32 v[160:161], v[160:161], v[244:245]
    v_pk_add_f32 v[164:165], v[164:165], v[244:245]
    v_rcp_f32 v152, v152
    v_rcp_f32 v153, v153
    v_rcp_f32 v156, v156
    v_rcp_f32 v157, v157
    v_rcp_f32 v160, v160
    v_rcp_f32 v161, v161
    v_rcp_f32 v164, v164
    v_rcp_f32 v165, v165
    v_pk_mul_f32 v[4:5], v[152:153], v[4:5]
    v_pk_mul_f32 v[6:7], v[156:157], v[6:7]
    v_pk_mul_f32 v[20:21], v[160:161], v[20:21]
    v_pk_mul_f32 v[22:23], v[164:165], v[22:23]
    v_cvt_pk_bf16_f32 v188, v4, v5
    v_cvt_pk_bf16_f32 v189, v6, v7
    v_cvt_pk_bf16_f32 v190, v20, v21
    v_cvt_pk_bf16_f32 v191, v22, v23
    s_add_u32 s70, s68, 55296
    buffer_store_dwordx4 v[188:191], v248, s[40:43], s70 offen sc1
    v_pk_mul_f32 v[152:153], v[8:9], v[8:9]
    v_pk_mul_f32 v[156:157], v[10:11], v[10:11]
    v_pk_mul_f32 v[160:161], v[24:25], v[24:25]
    v_pk_mul_f32 v[164:165], v[26:27], v[26:27]
    v_pk_fma_f32 v[152:153], v[152:153], v[242:243], v[240:241]
    v_pk_fma_f32 v[156:157], v[156:157], v[242:243], v[240:241]
    v_pk_fma_f32 v[160:161], v[160:161], v[242:243], v[240:241]
    v_pk_fma_f32 v[164:165], v[164:165], v[242:243], v[240:241]
    v_pk_mul_f32 v[152:153], v[152:153], v[8:9]
    v_pk_mul_f32 v[156:157], v[156:157], v[10:11]
    v_pk_mul_f32 v[160:161], v[160:161], v[24:25]
    v_pk_mul_f32 v[164:165], v[164:165], v[26:27]
    v_exp_f32 v152, v152
    v_exp_f32 v153, v153
    v_exp_f32 v156, v156
    v_exp_f32 v157, v157
    v_exp_f32 v160, v160
    v_exp_f32 v161, v161
    v_exp_f32 v164, v164
    v_exp_f32 v165, v165
    v_pk_add_f32 v[152:153], v[152:153], v[244:245]
    v_pk_add_f32 v[156:157], v[156:157], v[244:245]
    v_pk_add_f32 v[160:161], v[160:161], v[244:245]
    v_pk_add_f32 v[164:165], v[164:165], v[244:245]
    v_rcp_f32 v152, v152
    v_rcp_f32 v153, v153
    v_rcp_f32 v156, v156
    v_rcp_f32 v157, v157
    v_rcp_f32 v160, v160
    v_rcp_f32 v161, v161
    v_rcp_f32 v164, v164
    v_rcp_f32 v165, v165
    v_pk_mul_f32 v[8:9], v[152:153], v[8:9]
    v_pk_mul_f32 v[10:11], v[156:157], v[10:11]
    v_pk_mul_f32 v[24:25], v[160:161], v[24:25]
    v_pk_mul_f32 v[26:27], v[164:165], v[26:27]
    v_cvt_pk_bf16_f32 v192, v8, v9
    v_cvt_pk_bf16_f32 v193, v10, v11
    v_cvt_pk_bf16_f32 v194, v24, v25
    v_cvt_pk_bf16_f32 v195, v26, v27
    s_add_u32 s70, s68, 110592
    buffer_store_dwordx4 v[192:195], v248, s[40:43], s70 offen sc1
    v_pk_mul_f32 v[152:153], v[12:13], v[12:13]
    v_pk_mul_f32 v[156:157], v[14:15], v[14:15]
    v_pk_mul_f32 v[160:161], v[28:29], v[28:29]
    v_pk_mul_f32 v[164:165], v[30:31], v[30:31]
    v_pk_fma_f32 v[152:153], v[152:153], v[242:243], v[240:241]
    v_pk_fma_f32 v[156:157], v[156:157], v[242:243], v[240:241]
    v_pk_fma_f32 v[160:161], v[160:161], v[242:243], v[240:241]
    v_pk_fma_f32 v[164:165], v[164:165], v[242:243], v[240:241]
    v_pk_mul_f32 v[152:153], v[152:153], v[12:13]
    v_pk_mul_f32 v[156:157], v[156:157], v[14:15]
    v_pk_mul_f32 v[160:161], v[160:161], v[28:29]
    v_pk_mul_f32 v[164:165], v[164:165], v[30:31]
    v_exp_f32 v152, v152
    v_exp_f32 v153, v153
    v_exp_f32 v156, v156
    v_exp_f32 v157, v157
    v_exp_f32 v160, v160
    v_exp_f32 v161, v161
    v_exp_f32 v164, v164
    v_exp_f32 v165, v165
    v_pk_add_f32 v[152:153], v[152:153], v[244:245]
    v_pk_add_f32 v[156:157], v[156:157], v[244:245]
    v_pk_add_f32 v[160:161], v[160:161], v[244:245]
    v_pk_add_f32 v[164:165], v[164:165], v[244:245]
    v_rcp_f32 v152, v152
    v_rcp_f32 v153, v153
    v_rcp_f32 v156, v156
    v_rcp_f32 v157, v157
    v_rcp_f32 v160, v160
    v_rcp_f32 v161, v161
    v_rcp_f32 v164, v164
    v_rcp_f32 v165, v165
    v_pk_mul_f32 v[12:13], v[152:153], v[12:13]
    v_pk_mul_f32 v[14:15], v[156:157], v[14:15]
    v_pk_mul_f32 v[28:29], v[160:161], v[28:29]
    v_pk_mul_f32 v[30:31], v[164:165], v[30:31]
    v_cvt_pk_bf16_f32 v196, v12, v13
    v_cvt_pk_bf16_f32 v197, v14, v15
    v_cvt_pk_bf16_f32 v198, v28, v29
    v_cvt_pk_bf16_f32 v199, v30, v31
    s_add_u32 s70, s68, 165888
    buffer_store_dwordx4 v[196:199], v248, s[40:43], s70 offen sc1
L_skip_pair0:
    s_add_u32 s70, s66, 1
    s_cmp_ge_u32 s70, 54
    s_cbranch_scc1 L_skip_pair1
    v_pk_mul_f32 v[152:153], v[32:33], v[32:33]
    v_pk_mul_f32 v[156:157], v[34:35], v[34:35]
    v_pk_mul_f32 v[160:161], v[48:49], v[48:49]
    v_pk_mul_f32 v[164:165], v[50:51], v[50:51]
    v_pk_fma_f32 v[152:153], v[152:153], v[242:243], v[240:241]
    v_pk_fma_f32 v[156:157], v[156:157], v[242:243], v[240:241]
    v_pk_fma_f32 v[160:161], v[160:161], v[242:243], v[240:241]
    v_pk_fma_f32 v[164:165], v[164:165], v[242:243], v[240:241]
    v_pk_mul_f32 v[152:153], v[152:153], v[32:33]
    v_pk_mul_f32 v[156:157], v[156:157], v[34:35]
    v_pk_mul_f32 v[160:161], v[160:161], v[48:49]
    v_pk_mul_f32 v[164:165], v[164:165], v[50:51]
    v_exp_f32 v152, v152
    v_exp_f32 v153, v153
    v_exp_f32 v156, v156
    v_exp_f32 v157, v157
    v_exp_f32 v160, v160
    v_exp_f32 v161, v161
    v_exp_f32 v164, v164
    v_exp_f32 v165, v165
    v_pk_add_f32 v[152:153], v[152:153], v[244:245]
    v_pk_add_f32 v[156:157], v[156:157], v[244:245]
    v_pk_add_f32 v[160:161], v[160:161], v[244:245]
    v_pk_add_f32 v[164:165], v[164:165], v[244:245]
    v_rcp_f32 v152, v152
    v_rcp_f32 v153, v153
    v_rcp_f32 v156, v156
    v_rcp_f32 v157, v157
    v_rcp_f32 v160, v160
    v_rcp_f32 v161, v161
    v_rcp_f32 v164, v164
    v_rcp_f32 v165, v165
    v_pk_mul_f32 v[32:33], v[152:153], v[32:33]
    v_pk_mul_f32 v[34:35], v[156:157], v[34:35]
    v_pk_mul_f32 v[48:49], v[160:161], v[48:49]
    v_pk_mul_f32 v[50:51], v[164:165], v[50:51]
    v_cvt_pk_bf16_f32 v184, v32, v33
    v_cvt_pk_bf16_f32 v185, v34, v35
    v_cvt_pk_bf16_f32 v186, v48, v49
    v_cvt_pk_bf16_f32 v187, v50, v51
    s_add_u32 s70, s68, 1024
    buffer_store_dwordx4 v[184:187], v248, s[40:43], s70 offen sc1
    v_pk_mul_f32 v[152:153], v[36:37], v[36:37]
    v_pk_mul_f32 v[156:157], v[38:39], v[38:39]
    v_pk_mul_f32 v[160:161], v[52:53], v[52:53]
    v_pk_mul_f32 v[164:165], v[54:55], v[54:55]
    v_pk_fma_f32 v[152:153], v[152:153], v[242:243], v[240:241]
    v_pk_fma_f32 v[156:157], v[156:157], v[242:243], v[240:241]
    v_pk_fma_f32 v[160:161], v[160:161], v[242:243], v[240:241]
    v_pk_fma_f32 v[164:165], v[164:165], v[242:243], v[240:241]
    v_pk_mul_f32 v[152:153], v[152:153], v[36:37]
    v_pk_mul_f32 v[156:157], v[156:157], v[38:39]
    v_pk_mul_f32 v[160:161], v[160:161], v[52:53]
    v_pk_mul_f32 v[164:165], v[164:165], v[54:55]
    v_exp_f32 v152, v152
    v_exp_f32 v153, v153
    v_exp_f32 v156, v156
    v_exp_f32 v157, v157
    v_exp_f32 v160, v160
    v_exp_f32 v161, v161
    v_exp_f32 v164, v164
    v_exp_f32 v165, v165
    v_pk_add_f32 v[152:153], v[152:153], v[244:245]
    v_pk_add_f32 v[156:157], v[156:157], v[244:245]
    v_pk_add_f32 v[160:161], v[160:161], v[244:245]
    v_pk_add_f32 v[164:165], v[164:165], v[244:245]
    v_rcp_f32 v152, v152
    v_rcp_f32 v153, v153
    v_rcp_f32 v156, v156
    v_rcp_f32 v157, v157
    v_rcp_f32 v160, v160
    v_rcp_f32 v161, v161
    v_rcp_f32 v164, v164
    v_rcp_f32 v165, v165
    v_pk_mul_f32 v[36:37], v[152:153], v[36:37]
    v_pk_mul_f32 v[38:39], v[156:157], v[38:39]
    v_pk_mul_f32 v[52:53], v[160:161], v[52:53]
    v_pk_mul_f32 v[54:55], v[164:165], v[54:55]
    v_cvt_pk_bf16_f32 v188, v36, v37
    v_cvt_pk_bf16_f32 v189, v38, v39
    v_cvt_pk_bf16_f32 v190, v52, v53
    v_cvt_pk_bf16_f32 v191, v54, v55
    s_add_u32 s70, s68, 56320
    buffer_store_dwordx4 v[188:191], v248, s[40:43], s70 offen sc1
    v_pk_mul_f32 v[152:153], v[40:41], v[40:41]
    v_pk_mul_f32 v[156:157], v[42:43], v[42:43]
    v_pk_mul_f32 v[160:161], v[56:57], v[56:57]
    v_pk_mul_f32 v[164:165], v[58:59], v[58:59]
    v_pk_fma_f32 v[152:153], v[152:153], v[242:243], v[240:241]
    v_pk_fma_f32 v[156:157], v[156:157], v[242:243], v[240:241]
    v_pk_fma_f32 v[160:161], v[160:161], v[242:243], v[240:241]
    v_pk_fma_f32 v[164:165], v[164:165], v[242:243], v[240:241]
    v_pk_mul_f32 v[152:153], v[152:153], v[40:41]
    v_pk_mul_f32 v[156:157], v[156:157], v[42:43]
    v_pk_mul_f32 v[160:161], v[160:161], v[56:57]
    v_pk_mul_f32 v[164:165], v[164:165], v[58:59]
    v_exp_f32 v152, v152
    v_exp_f32 v153, v153
    v_exp_f32 v156, v156
    v_exp_f32 v157, v157
    v_exp_f32 v160, v160
    v_exp_f32 v161, v161
    v_exp_f32 v164, v164
    v_exp_f32 v165, v165
    v_pk_add_f32 v[152:153], v[152:153], v[244:245]
    v_pk_add_f32 v[156:157], v[156:157], v[244:245]
    v_pk_add_f32 v[160:161], v[160:161], v[244:245]
    v_pk_add_f32 v[164:165], v[164:165], v[244:245]
    v_rcp_f32 v152, v152
    v_rcp_f32 v153, v153
    v_rcp_f32 v156, v156
    v_rcp_f32 v157, v157
    v_rcp_f32 v160, v160
    v_rcp_f32 v161, v161
    v_rcp_f32 v164, v164
    v_rcp_f32 v165, v165
    v_pk_mul_f32 v[40:41], v[152:153], v[40:41]
    v_pk_mul_f32 v[42:43], v[156:157], v[42:43]
    v_pk_mul_f32 v[56:57], v[160:161], v[56:57]
    v_pk_mul_f32 v[58:59], v[164:165], v[58:59]
    v_cvt_pk_bf16_f32 v192, v40, v41
    v_cvt_pk_bf16_f32 v193, v42, v43
    v_cvt_pk_bf16_f32 v194, v56, v57
    v_cvt_pk_bf16_f32 v195, v58, v59
    s_add_u32 s70, s68, 111616
    buffer_store_dwordx4 v[192:195], v248, s[40:43], s70 offen sc1
    v_pk_mul_f32 v[152:153], v[44:45], v[44:45]
    v_pk_mul_f32 v[156:157], v[46:47], v[46:47]
    v_pk_mul_f32 v[160:161], v[60:61], v[60:61]
    v_pk_mul_f32 v[164:165], v[62:63], v[62:63]
    v_pk_fma_f32 v[152:153], v[152:153], v[242:243], v[240:241]
    v_pk_fma_f32 v[156:157], v[156:157], v[242:243], v[240:241]
    v_pk_fma_f32 v[160:161], v[160:161], v[242:243], v[240:241]
    v_pk_fma_f32 v[164:165], v[164:165], v[242:243], v[240:241]
    v_pk_mul_f32 v[152:153], v[152:153], v[44:45]
    v_pk_mul_f32 v[156:157], v[156:157], v[46:47]
    v_pk_mul_f32 v[160:161], v[160:161], v[60:61]
    v_pk_mul_f32 v[164:165], v[164:165], v[62:63]
    v_exp_f32 v152, v152
    v_exp_f32 v153, v153
    v_exp_f32 v156, v156
    v_exp_f32 v157, v157
    v_exp_f32 v160, v160
    v_exp_f32 v161, v161
    v_exp_f32 v164, v164
    v_exp_f32 v165, v165
    v_pk_add_f32 v[152:153], v[152:153], v[244:245]
    v_pk_add_f32 v[156:157], v[156:157], v[244:245]
    v_pk_add_f32 v[160:161], v[160:161], v[244:245]
    v_pk_add_f32 v[164:165], v[164:165], v[244:245]
    v_rcp_f32 v152, v152
    v_rcp_f32 v153, v153
    v_rcp_f32 v156, v156
    v_rcp_f32 v157, v157
    v_rcp_f32 v160, v160
    v_rcp_f32 v161, v161
    v_rcp_f32 v164, v164
    v_rcp_f32 v165, v165
    v_pk_mul_f32 v[44:45], v[152:153], v[44:45]
    v_pk_mul_f32 v[46:47], v[156:157], v[46:47]
    v_pk_mul_f32 v[60:61], v[160:161], v[60:61]
    v_pk_mul_f32 v[62:63], v[164:165], v[62:63]
    v_cvt_pk_bf16_f32 v196, v44, v45
    v_cvt_pk_bf16_f32 v197, v46, v47
    v_cvt_pk_bf16_f32 v198, v60, v61
    v_cvt_pk_bf16_f32 v199, v62, v63
    s_add_u32 s70, s68, 166912
    buffer_store_dwordx4 v[196:199], v248, s[40:43], s70 offen sc1
L_skip_pair1:
    s_add_u32 s70, s66, 2
    s_cmp_ge_u32 s70, 54
    s_cbranch_scc1 L_skip_pair2
    v_pk_mul_f32 v[152:153], v[64:65], v[64:65]
    v_pk_mul_f32 v[156:157], v[66:67], v[66:67]
    v_pk_mul_f32 v[160:161], v[80:81], v[80:81]
    v_pk_mul_f32 v[164:165], v[82:83], v[82:83]
    v_pk_fma_f32 v[152:153], v[152:153], v[242:243], v[240:241]
    v_pk_fma_f32 v[156:157], v[156:157], v[242:243], v[240:241]
    v_pk_fma_f32 v[160:161], v[160:161], v[242:243], v[240:241]
    v_pk_fma_f32 v[164:165], v[164:165], v[242:243], v[240:241]
    v_pk_mul_f32 v[152:153], v[152:153], v[64:65]
    v_pk_mul_f32 v[156:157], v[156:157], v[66:67]
    v_pk_mul_f32 v[160:161], v[160:161], v[80:81]
    v_pk_mul_f32 v[164:165], v[164:165], v[82:83]
    v_exp_f32 v152, v152
    v_exp_f32 v153, v153
    v_exp_f32 v156, v156
    v_exp_f32 v157, v157
    v_exp_f32 v160, v160
    v_exp_f32 v161, v161
    v_exp_f32 v164, v164
    v_exp_f32 v165, v165
    v_pk_add_f32 v[152:153], v[152:153], v[244:245]
    v_pk_add_f32 v[156:157], v[156:157], v[244:245]
    v_pk_add_f32 v[160:161], v[160:161], v[244:245]
    v_pk_add_f32 v[164:165], v[164:165], v[244:245]
    v_rcp_f32 v152, v152
    v_rcp_f32 v153, v153
    v_rcp_f32 v156, v156
    v_rcp_f32 v157, v157
    v_rcp_f32 v160, v160
    v_rcp_f32 v161, v161
    v_rcp_f32 v164, v164
    v_rcp_f32 v165, v165
    v_pk_mul_f32 v[64:65], v[152:153], v[64:65]
    v_pk_mul_f32 v[66:67], v[156:157], v[66:67]
    v_pk_mul_f32 v[80:81], v[160:161], v[80:81]
    v_pk_mul_f32 v[82:83], v[164:165], v[82:83]
    v_cvt_pk_bf16_f32 v184, v64, v65
    v_cvt_pk_bf16_f32 v185, v66, v67
    v_cvt_pk_bf16_f32 v186, v80, v81
    v_cvt_pk_bf16_f32 v187, v82, v83
    s_add_u32 s70, s68, 2048
    buffer_store_dwordx4 v[184:187], v248, s[40:43], s70 offen sc1
    v_pk_mul_f32 v[152:153], v[68:69], v[68:69]
    v_pk_mul_f32 v[156:157], v[70:71], v[70:71]
    v_pk_mul_f32 v[160:161], v[84:85], v[84:85]
    v_pk_mul_f32 v[164:165], v[86:87], v[86:87]
    v_pk_fma_f32 v[152:153], v[152:153], v[242:243], v[240:241]
    v_pk_fma_f32 v[156:157], v[156:157], v[242:243], v[240:241]
    v_pk_fma_f32 v[160:161], v[160:161], v[242:243], v[240:241]
    v_pk_fma_f32 v[164:165], v[164:165], v[242:243], v[240:241]
    v_pk_mul_f32 v[152:153], v[152:153], v[68:69]
    v_pk_mul_f32 v[156:157], v[156:157], v[70:71]
    v_pk_mul_f32 v[160:161], v[160:161], v[84:85]
    v_pk_mul_f32 v[164:165], v[164:165], v[86:87]
    v_exp_f32 v152, v152
    v_exp_f32 v153, v153
    v_exp_f32 v156, v156
    v_exp_f32 v157, v157
    v_exp_f32 v160, v160
    v_exp_f32 v161, v161
    v_exp_f32 v164, v164
    v_exp_f32 v165, v165
    v_pk_add_f32 v[152:153], v[152:153], v[244:245]
    v_pk_add_f32 v[156:157], v[156:157], v[244:245]
    v_pk_add_f32 v[160:161], v[160:161], v[244:245]
    v_pk_add_f32 v[164:165], v[164:165], v[244:245]
    v_rcp_f32 v152, v152
    v_rcp_f32 v153, v153
    v_rcp_f32 v156, v156
    v_rcp_f32 v157, v157
    v_rcp_f32 v160, v160
    v_rcp_f32 v161, v161
    v_rcp_f32 v164, v164
    v_rcp_f32 v165, v165
    v_pk_mul_f32 v[68:69], v[152:153], v[68:69]
    v_pk_mul_f32 v[70:71], v[156:157], v[70:71]
    v_pk_mul_f32 v[84:85], v[160:161], v[84:85]
    v_pk_mul_f32 v[86:87], v[164:165], v[86:87]
    v_cvt_pk_bf16_f32 v188, v68, v69
    v_cvt_pk_bf16_f32 v189, v70, v71
    v_cvt_pk_bf16_f32 v190, v84, v85
    v_cvt_pk_bf16_f32 v191, v86, v87
    s_add_u32 s70, s68, 57344
    buffer_store_dwordx4 v[188:191], v248, s[40:43], s70 offen sc1
    v_pk_mul_f32 v[152:153], v[72:73], v[72:73]
    v_pk_mul_f32 v[156:157], v[74:75], v[74:75]
    v_pk_mul_f32 v[160:161], v[88:89], v[88:89]
    v_pk_mul_f32 v[164:165], v[90:91], v[90:91]
    v_pk_fma_f32 v[152:153], v[152:153], v[242:243], v[240:241]
    v_pk_fma_f32 v[156:157], v[156:157], v[242:243], v[240:241]
    v_pk_fma_f32 v[160:161], v[160:161], v[242:243], v[240:241]
    v_pk_fma_f32 v[164:165], v[164:165], v[242:243], v[240:241]
    v_pk_mul_f32 v[152:153], v[152:153], v[72:73]
    v_pk_mul_f32 v[156:157], v[156:157], v[74:75]
    v_pk_mul_f32 v[160:161], v[160:161], v[88:89]
    v_pk_mul_f32 v[164:165], v[164:165], v[90:91]
    v_exp_f32 v152, v152
    v_exp_f32 v153, v153
    v_exp_f32 v156, v156
    v_exp_f32 v157, v157
    v_exp_f32 v160, v160
    v_exp_f32 v161, v161
    v_exp_f32 v164, v164
    v_exp_f32 v165, v165
    v_pk_add_f32 v[152:153], v[152:153], v[244:245]
    v_pk_add_f32 v[156:157], v[156:157], v[244:245]
    v_pk_add_f32 v[160:161], v[160:161], v[244:245]
    v_pk_add_f32 v[164:165], v[164:165], v[244:245]
    v_rcp_f32 v152, v152
    v_rcp_f32 v153, v153
    v_rcp_f32 v156, v156
    v_rcp_f32 v157, v157
    v_rcp_f32 v160, v160
    v_rcp_f32 v161, v161
    v_rcp_f32 v164, v164
    v_rcp_f32 v165, v165
    v_pk_mul_f32 v[72:73], v[152:153], v[72:73]
    v_pk_mul_f32 v[74:75], v[156:157], v[74:75]
    v_pk_mul_f32 v[88:89], v[160:161], v[88:89]
    v_pk_mul_f32 v[90:91], v[164:165], v[90:91]
    v_cvt_pk_bf16_f32 v192, v72, v73
    v_cvt_pk_bf16_f32 v193, v74, v75
    v_cvt_pk_bf16_f32 v194, v88, v89
    v_cvt_pk_bf16_f32 v195, v90, v91
    s_add_u32 s70, s68, 112640
    buffer_store_dwordx4 v[192:195], v248, s[40:43], s70 offen sc1
    v_pk_mul_f32 v[152:153], v[76:77], v[76:77]
    v_pk_mul_f32 v[156:157], v[78:79], v[78:79]
    v_pk_mul_f32 v[160:161], v[92:93], v[92:93]
    v_pk_mul_f32 v[164:165], v[94:95], v[94:95]
    v_pk_fma_f32 v[152:153], v[152:153], v[242:243], v[240:241]
    v_pk_fma_f32 v[156:157], v[156:157], v[242:243], v[240:241]
    v_pk_fma_f32 v[160:161], v[160:161], v[242:243], v[240:241]
    v_pk_fma_f32 v[164:165], v[164:165], v[242:243], v[240:241]
    v_pk_mul_f32 v[152:153], v[152:153], v[76:77]
    v_pk_mul_f32 v[156:157], v[156:157], v[78:79]
    v_pk_mul_f32 v[160:161], v[160:161], v[92:93]
    v_pk_mul_f32 v[164:165], v[164:165], v[94:95]
    v_exp_f32 v152, v152
    v_exp_f32 v153, v153
    v_exp_f32 v156, v156
    v_exp_f32 v157, v157
    v_exp_f32 v160, v160
    v_exp_f32 v161, v161
    v_exp_f32 v164, v164
    v_exp_f32 v165, v165
    v_pk_add_f32 v[152:153], v[152:153], v[244:245]
    v_pk_add_f32 v[156:157], v[156:157], v[244:245]
    v_pk_add_f32 v[160:161], v[160:161], v[244:245]
    v_pk_add_f32 v[164:165], v[164:165], v[244:245]
    v_rcp_f32 v152, v152
    v_rcp_f32 v153, v153
    v_rcp_f32 v156, v156
    v_rcp_f32 v157, v157
    v_rcp_f32 v160, v160
    v_rcp_f32 v161, v161
    v_rcp_f32 v164, v164
    v_rcp_f32 v165, v165
    v_pk_mul_f32 v[76:77], v[152:153], v[76:77]
    v_pk_mul_f32 v[78:79], v[156:157], v[78:79]
    v_pk_mul_f32 v[92:93], v[160:161], v[92:93]
    v_pk_mul_f32 v[94:95], v[164:165], v[94:95]
    v_cvt_pk_bf16_f32 v196, v76, v77
    v_cvt_pk_bf16_f32 v197, v78, v79
    v_cvt_pk_bf16_f32 v198, v92, v93
    v_cvt_pk_bf16_f32 v199, v94, v95
    s_add_u32 s70, s68, 167936
    buffer_store_dwordx4 v[196:199], v248, s[40:43], s70 offen sc1
L_skip_pair2:
    v_pk_mul_f32 v[152:153], v[96:97], v[96:97]
    v_pk_mul_f32 v[156:157], v[98:99], v[98:99]
    v_pk_mul_f32 v[160:161], v[100:101], v[100:101]
    v_pk_mul_f32 v[164:165], v[102:103], v[102:103]
    v_pk_fma_f32 v[152:153], v[152:153], v[242:243], v[240:241]
    v_pk_fma_f32 v[156:157], v[156:157], v[242:243], v[240:241]
    v_pk_fma_f32 v[160:161], v[160:161], v[242:243], v[240:241]
    v_pk_fma_f32 v[164:165], v[164:165], v[242:243], v[240:241]
    v_pk_mul_f32 v[152:153], v[152:153], v[96:97]
    v_pk_mul_f32 v[156:157], v[156:157], v[98:99]
    v_pk_mul_f32 v[160:161], v[160:161], v[100:101]
    v_pk_mul_f32 v[164:165], v[164:165], v[102:103]
    v_exp_f32 v152, v152
    v_exp_f32 v153, v153
    v_exp_f32 v156, v156
    v_exp_f32 v157, v157
    v_exp_f32 v160, v160
    v_exp_f32 v161, v161
    v_exp_f32 v164, v164
    v_exp_f32 v165, v165
    v_pk_add_f32 v[152:153], v[152:153], v[244:245]
    v_pk_add_f32 v[156:157], v[156:157], v[244:245]
    v_pk_add_f32 v[160:161], v[160:161], v[244:245]
    v_pk_add_f32 v[164:165], v[164:165], v[244:245]
    v_rcp_f32 v152, v152
    v_rcp_f32 v153, v153
    v_rcp_f32 v156, v156
    v_rcp_f32 v157, v157
    v_rcp_f32 v160, v160
    v_rcp_f32 v161, v161
    v_rcp_f32 v164, v164
    v_rcp_f32 v165, v165
    v_pk_mul_f32 v[96:97], v[152:153], v[96:97]
    v_pk_mul_f32 v[98:99], v[156:157], v[98:99]
    v_pk_mul_f32 v[100:101], v[160:161], v[100:101]
    v_pk_mul_f32 v[102:103], v[164:165], v[102:103]
    v_cvt_pk_bf16_f32 v200, v96, v97
    v_cvt_pk_bf16_f32 v201, v98, v99
    s_add_u32 s70, s69, 0
    buffer_store_dwordx2 v[200:201], v248, s[40:43], s70 offen sc1
    v_cvt_pk_bf16_f32 v202, v100, v101
    v_cvt_pk_bf16_f32 v203, v102, v103
    s_add_u32 s70, s69, 55296
    buffer_store_dwordx2 v[202:203], v248, s[40:43], s70 offen sc1
    v_pk_mul_f32 v[152:153], v[104:105], v[104:105]
    v_pk_mul_f32 v[156:157], v[106:107], v[106:107]
    v_pk_mul_f32 v[160:161], v[108:109], v[108:109]
    v_pk_mul_f32 v[164:165], v[110:111], v[110:111]
    v_pk_fma_f32 v[152:153], v[152:153], v[242:243], v[240:241]
    v_pk_fma_f32 v[156:157], v[156:157], v[242:243], v[240:241]
    v_pk_fma_f32 v[160:161], v[160:161], v[242:243], v[240:241]
    v_pk_fma_f32 v[164:165], v[164:165], v[242:243], v[240:241]
    v_pk_mul_f32 v[152:153], v[152:153], v[104:105]
    v_pk_mul_f32 v[156:157], v[156:157], v[106:107]
    v_pk_mul_f32 v[160:161], v[160:161], v[108:109]
    v_pk_mul_f32 v[164:165], v[164:165], v[110:111]
    v_exp_f32 v152, v152
    v_exp_f32 v153, v153
    v_exp_f32 v156, v156
    v_exp_f32 v157, v157
    v_exp_f32 v160, v160
    v_exp_f32 v161, v161
    v_exp_f32 v164, v164
    v_exp_f32 v165, v165
    v_pk_add_f32 v[152:153], v[152:153], v[244:245]
    v_pk_add_f32 v[156:157], v[156:157], v[244:245]
    v_pk_add_f32 v[160:161], v[160:161], v[244:245]
    v_pk_add_f32 v[164:165], v[164:165], v[244:245]
    v_rcp_f32 v152, v152
    v_rcp_f32 v153, v153
    v_rcp_f32 v156, v156
    v_rcp_f32 v157, v157
    v_rcp_f32 v160, v160
    v_rcp_f32 v161, v161
    v_rcp_f32 v164, v164
    v_rcp_f32 v165, v165
    v_pk_mul_f32 v[104:105], v[152:153], v[104:105]
    v_pk_mul_f32 v[106:107], v[156:157], v[106:107]
    v_pk_mul_f32 v[108:109], v[160:161], v[108:109]
    v_pk_mul_f32 v[110:111], v[164:165], v[110:111]
    v_cvt_pk_bf16_f32 v200, v104, v105
    v_cvt_pk_bf16_f32 v201, v106, v107
    s_add_u32 s70, s69, 110592
    buffer_store_dwordx2 v[200:201], v248, s[40:43], s70 offen sc1
    v_cvt_pk_bf16_f32 v202, v108, v109
    v_cvt_pk_bf16_f32 v203, v110, v111
    s_add_u32 s70, s69, 165888
    buffer_store_dwordx2 v[202:203], v248, s[40:43], s70 offen sc1
    s_endpgm
L_loader_F:
    s_sub_u32 s57, s24, 4
    v_lshrrev_b32 v3, 3, v2
    s_lshl_b32 s58, s57, 3
    v_add_u32 v3, s58, v3
    s_lshl_b32 s59, s26, 7
    v_add_u32 v3, s59, v3
    s_and_b32 s58, s57, 1
    s_lshl_b32 s58, s58, 2
    v_lshrrev_b32 v4, 4, v2
    v_add_u32 v4, s58, v4
    v_and_b32 v5, 7, v2
    v_xor_b32 v4, v4, v5
    v_lshlrev_b32 v4, 4, v4
    s_movk_i32 s58, 1280
    s_movk_i32 s59, 2047
    v_add_u32 v5, 0, v3
    v_mul_u32_u24 v5, s58, v5
    v_add_u32 v10, v5, v4
    v_add_u32 v5, 32, v3
    v_mul_u32_u24 v5, s58, v5
    v_add_u32 v11, v5, v4
    v_add_u32 v5, 64, v3
    v_mul_u32_u24 v5, s58, v5
    v_add_u32 v12, v5, v4
    v_add_u32 v5, 96, v3
    v_mul_u32_u24 v5, s58, v5
    v_add_u32 v13, v5, v4
    v_add_u32 v5, 128, v3
    v_min_u32 v5, s59, v5
    v_mul_u32_u24 v5, s58, v5
    v_mov_b32 v6, v10
    s_lshl_b32 s58, s57, 6
    v_add_u32 v7, s58, v2
    s_mov_b32 s60, 3456
    v_mov_b32 v9, 0x7ffffff0
    s_mul_i32 s61, s27, 448
    s_waitcnt lgkmcnt(0)
    s_mov_b32 s28, s4
    s_mov_b32 s29, s5
    s_mov_b32 s30, 2621440
    s_mov_b32 s31, 0x20000
    s_mov_b32 s32, s12
    s_mov_b32 s33, s13
    s_mov_b32 s34, 2211840
    s_mov_b32 s35, 0x20000
    s_cmp_lt_u32 s57, 2
    s_cselect_b32 s36, s28, s32
    s_cselect_b32 s37, s29, s33
    s_cselect_b32 s38, s30, s34
    s_mov_b32 s39, 0x20000
    s_movk_i32 s73, 128
    s_cselect_b32 s73, s73, 221184
    s_and_b32 s79, s26, 7
    s_lshr_b32 s79, s79, 1
    s_mul_i32 s79, s79, 5
    s_lshr_b32 s79, s79, 1
    s_and_b32 s80, s27, 1
    s_lshl_b32 s81, s25, 1
    s_add_u32 s80, s80, s81
    s_mul_i32 s80, s80, 5
    s_lshr_b32 s80, s80, 1
    s_add_u32 s79, s79, s80
    s_cmp_ge_u32 s79, 10
    s_cselect_b32 s80, 10, 0
    s_sub_u32 s79, s79, s80
    s_lshl_b32 s74, s79, 7
    s_mul_i32 s75, s79, 221184
    s_mul_i32 s76, s79, s73
    s_lshl_b32 s77, s57, 10
    s_add_u32 m0, s77, 0
    s_nop 0
    buffer_load_dwordx4 v10, s[28:31], s74 offen  lds
    s_add_u32 m0, s77, 4096
    s_nop 0
    buffer_load_dwordx4 v11, s[28:31], s74 offen  lds
    s_add_u32 m0, s77, 8192
    s_nop 0
    buffer_load_dwordx4 v12, s[28:31], s74 offen  lds
    s_add_u32 m0, s77, 12288
    s_nop 0
    buffer_load_dwordx4 v13, s[28:31], s74 offen  lds
    v_subrev_u32 v3, 128, v7
    v_max_i32 v3, 0, v3
    v_mul_u32_u24 v4, 2185, v3
    v_lshrrev_b32 v4, 16, v4
    v_mul_u32_u24 v5, 30, v4
    v_sub_u32 v5, v3, v5
    v_lshrrev_b32 v3, 1, v4
    v_xor_b32 v3, v3, v4
    v_and_b32 v3, 4, v3
    v_mul_u32_u24 v3, 3, v3
    v_xor_b32 v4, v3, v4
    v_mul_u32_u24 v4, s60, v4
    v_min_u32 v5, 27, v5
    v_lshlrev_b32 v5, 4, v5
    v_add_u32 v5, s61, v5
    v_cmp_lt_u32 vcc, 3440, v5
    v_add_u32 v8, v4, v5
    s_nop 0
    v_cndmask_b32 v8, v8, v9, vcc
    s_cmp_lt_u32 s57, 2
    s_cselect_b64 vcc, -1, 0
    v_cndmask_b32 v14, v8, v6, vcc
    s_add_u32 m0, s77, 16384
    s_nop 0
    buffer_load_dwordx4 v14, s[36:39], s76 offen  lds
    v_add_u32 v3, 128, v7
    v_mul_u32_u24 v4, 2185, v3
    v_lshrrev_b32 v4, 16, v4
    v_mul_u32_u24 v5, 30, v4
    v_sub_u32 v5, v3, v5
    v_lshrrev_b32 v3, 1, v4
    v_xor_b32 v3, v3, v4
    v_and_b32 v3, 4, v3
    v_mul_u32_u24 v3, 3, v3
    v_xor_b32 v4, v3, v4
    v_mul_u32_u24 v4, s60, v4
    v_min_u32 v5, 27, v5
    v_lshlrev_b32 v5, 4, v5
    v_add_u32 v5, s61, v5
    v_cmp_lt_u32 vcc, 3440, v5
    v_add_u32 v15, v4, v5
    s_nop 0
    v_cndmask_b32 v15, v15, v9, vcc
    s_add_u32 m0, s77, 20480
    s_nop 0
    buffer_load_dwordx4 v15, s[32:35], s75 offen  lds
    v_add_u32 v3, 384, v7
    v_mul_u32_u24 v4, 2185, v3
    v_lshrrev_b32 v4, 16, v4
    v_mul_u32_u24 v5, 30, v4
    v_sub_u32 v5, v3, v5
    v_lshrrev_b32 v3, 1, v4
    v_xor_b32 v3, v3, v4
    v_and_b32 v3, 4, v3
    v_mul_u32_u24 v3, 3, v3
    v_xor_b32 v4, v3, v4
    v_mul_u32_u24 v4, s60, v4
    v_min_u32 v5, 27, v5
    v_lshlrev_b32 v5, 4, v5
    v_add_u32 v5, s61, v5
    v_cmp_lt_u32 vcc, 3440, v5
    v_add_u32 v16, v4, v5
    s_nop 0
    v_cndmask_b32 v16, v16, v9, vcc
    s_add_u32 m0, s77, 24576
    s_nop 0
    buffer_load_dwordx4 v16, s[32:35], s75 offen  lds
    v_add_u32 v3, 640, v7
    v_mul_u32_u24 v4, 2185, v3
    v_lshrrev_b32 v4, 16, v4
    v_mul_u32_u24 v5, 30, v4
    v_sub_u32 v5, v3, v5
    v_lshrrev_b32 v3, 1, v4
    v_xor_b32 v3, v3, v4
    v_and_b32 v3, 4, v3
    v_mul_u32_u24 v3, 3, v3
    v_xor_b32 v4, v3, v4
    v_mul_u32_u24 v4, s60, v4
    v_min_u32 v5, 27, v5
    v_lshlrev_b32 v5, 4, v5
    v_add_u32 v5, s61, v5
    v_cmp_lt_u32 vcc, 3440, v5
    v_add_u32 v17, v4, v5
    s_nop 0
    v_cndmask_b32 v17, v17, v9, vcc
    s_add_u32 m0, s77, 28672
    s_nop 0
    buffer_load_dwordx4 v17, s[32:35], s75 offen  lds
    v_add_u32 v3, 896, v7
    v_mul_u32_u24 v4, 2185, v3
    v_lshrrev_b32 v4, 16, v4
    v_mul_u32_u24 v5, 30, v4
    v_sub_u32 v5, v3, v5
    v_lshrrev_b32 v3, 1, v4
    v_xor_b32 v3, v3, v4
    v_and_b32 v3, 4, v3
    v_mul_u32_u24 v3, 3, v3
    v_xor_b32 v4, v3, v4
    v_mul_u32_u24 v4, s60, v4
    v_min_u32 v5, 27, v5
    v_lshlrev_b32 v5, 4, v5
    v_add_u32 v5, s61, v5
    v_cmp_lt_u32 vcc, 3440, v5
    v_add_u32 v18, v4, v5
    s_nop 0
    v_cndmask_b32 v18, v18, v9, vcc
    s_add_u32 m0, s77, 32768
    s_nop 0
    buffer_load_dwordx4 v18, s[32:35], s75 offen  lds
    v_add_u32 v3, 1152, v7
    v_mul_u32_u24 v4, 2185, v3
    v_lshrrev_b32 v4, 16, v4
    v_mul_u32_u24 v5, 30, v4
    v_sub_u32 v5, v3, v5
    v_lshrrev_b32 v3, 1, v4
    v_xor_b32 v3, v3, v4
    v_and_b32 v3, 4, v3
    v_mul_u32_u24 v3, 3, v3
    v_xor_b32 v4, v3, v4
    v_mul_u32_u24 v4, s60, v4
    v_min_u32 v5, 27, v5
    v_lshlrev_b32 v5, 4, v5
    v_add_u32 v5, s61, v5
    v_cmp_lt_u32 vcc, 3440, v5
    v_add_u32 v19, v4, v5
    s_nop 0
    v_cndmask_b32 v19, v19, v9, vcc
    s_add_u32 m0, s77, 36864
    s_nop 0
    buffer_load_dwordx4 v19, s[32:35], s75 offen  lds
    v_add_u32 v3, 1408, v7
    v_mul_u32_u24 v4, 2185, v3
    v_lshrrev_b32 v4, 16, v4
    v_mul_u32_u24 v5, 30, v4
    v_sub_u32 v5, v3, v5
    v_lshrrev_b32 v3, 1, v4
    v_xor_b32 v3, v3, v4
    v_and_b32 v3, 4, v3
    v_mul_u32_u24 v3, 3, v3
    v_xor_b32 v4, v3, v4
    v_mul_u32_u24 v4, s60, v4
    v_min_u32 v5, 27, v5
    v_lshlrev_b32 v5, 4, v5
    v_add_u32 v5, s61, v5
    v_cmp_lt_u32 vcc, 3440, v5
    v_add_u32 v20, v4, v5
    s_nop 0
    v_cndmask_b32 v20, v20, v9, vcc
    s_add_u32 m0, s77, 40960
    s_nop 0
    buffer_load_dwordx4 v20, s[32:35], s75 offen  lds
    v_add_u32 v3, 1664, v7
    v_mul_u32_u24 v4, 2185, v3
    v_lshrrev_b32 v4, 16, v4
    v_mul_u32_u24 v5, 30, v4
    v_sub_u32 v5, v3, v5
    v_lshrrev_b32 v3, 1, v4
    v_xor_b32 v3, v3, v4
    v_and_b32 v3, 4, v3
    v_mul_u32_u24 v3, 3, v3
    v_xor_b32 v4, v3, v4
    v_mul_u32_u24 v4, s60, v4
    v_min_u32 v5, 27, v5
    v_lshlrev_b32 v5, 4, v5
    v_add_u32 v5, s61, v5
    v_cmp_lt_u32 vcc, 3440, v5
    v_add_u32 v21, v4, v5
    s_nop 0
    v_cndmask_b32 v21, v21, v9, vcc
    s_add_u32 m0, s77, 45056
    s_nop 0
    buffer_load_dwordx4 v21, s[32:35], s75 offen  lds
    s_add_u32 s74, s74, 128
    s_add_u32 s75, s75, 221184
    s_add_u32 s76, s76, s73
    s_add_u32 s79, s79, 1
    s_cmp_eq_u32 s79, 10
    s_cselect_b32 s79, 0, s79
    s_cselect_b32 s74, 0, s74
    s_cselect_b32 s75, 0, s75
    s_cselect_b32 s76, 0, s76
    s_add_u32 m0, s77, 49152
    s_nop 0
    buffer_load_dwordx4 v10, s[28:31], s74 offen  lds
    s_add_u32 m0, s77, 53248
    s_nop 0
    buffer_load_dwordx4 v11, s[28:31], s74 offen  lds
    s_add_u32 m0, s77, 57344
    s_nop 0
    buffer_load_dwordx4 v12, s[28:31], s74 offen  lds
    s_add_u32 m0, s77, 61440
    s_nop 0
    buffer_load_dwordx4 v13, s[28:31], s74 offen  lds
    s_add_u32 m0, s77, 65536
    s_nop 0
    buffer_load_dwordx4 v14, s[36:39], s76 offen  lds
    s_add_u32 m0, s77, 69632
    s_nop 0
    buffer_load_dwordx4 v15, s[32:35], s75 offen  lds
    s_add_u32 m0, s77, 73728
    s_nop 0
    buffer_load_dwordx4 v16, s[32:35], s75 offen  lds
    s_add_u32 m0, s77, 77824
    s_nop 0
    buffer_load_dwordx4 v17, s[32:35], s75 offen  lds
    s_add_u32 m0, s77, 81920
    s_nop 0
    buffer_load_dwordx4 v18, s[32:35], s75 offen  lds
    s_add_u32 m0, s77, 86016
    s_nop 0
    buffer_load_dwordx4 v19, s[32:35], s75 offen  lds
    s_add_u32 m0, s77, 90112
    s_nop 0
    buffer_load_dwordx4 v20, s[32:35], s75 offen  lds
    s_add_u32 m0, s77, 94208
    s_nop 0
    buffer_load_dwordx4 v21, s[32:35], s75 offen  lds
    s_add_u32 s74, s74, 128
    s_add_u32 s75, s75, 221184
    s_add_u32 s76, s76, s73
    s_add_u32 s79, s79, 1
    s_cmp_eq_u32 s79, 10
    s_cselect_b32 s79, 0, s79
    s_cselect_b32 s74, 0, s74
    s_cselect_b32 s75, 0, s75
    s_cselect_b32 s76, 0, s76
    s_lshl_b32 s62, s26, 3
    s_add_u32 s62, s62, s27
    s_lshl_b32 s63, s57, 7
    s_add_u32 s62, s62, s63
    s_cmp_lt_u32 s57, 3
    s_cselect_b32 s63, 1, 0
    s_and_b32 s64, s62, 7
    s_lshr_b32 s65, s62, 3
    s_lshl_b32 s66, s65, 5
    s_mov_b32 s67, 16
    s_mov_b32 s68, 4
    s_mul_i32 s69, s64, 54
    s_add_u32 s69, s69, s65
    s_mul_i32 s69, s69, 5120
    s_add_u32 s69, s69, 9699328
    s_mov_b32 s70, 0
    s_cmp_lt_u32 s65, 54
    s_cbranch_scc1 L_unit_done_F
    s_sub_u32 s65, s65, 54
    s_mov_b32 s70, 1
    s_mul_i32 s69, s64, 20
    s_add_u32 s69, s69, s65
    s_mul_i32 s69, s69, 5120
    s_add_u32 s69, s69, 11911168
    s_mul_i32 s66, s65, 40
    s_mov_b32 s67, 20
    s_cmp_lt_u32 s65, 16
    s_cbranch_scc1 L_unit_done_F
    s_sub_u32 s65, s65, 16
    s_mul_i32 s66, s65, 160
    s_add_u32 s66, s66, 16
    s_mov_b32 s67, 80
    s_mov_b32 s68, 20
L_unit_done_F:
    s_mul_i32 s71, s64, 160
    s_movk_i32 s58, 1280
    v_add_u32 v3, 0, v2
    v_mul_u32_u24 v4, 6554, v3
    v_lshrrev_b32 v4, 16, v4
    v_mul_u32_u24 v5, 10, v4
    v_sub_u32 v5, v3, v5
    v_lshlrev_b32 v5, 4, v5
    v_add_u32 v5, s71, v5
    v_lshrrev_b32 v3, 4, v4
    v_mul_u32_u24 v3, s67, v3
    v_bfe_u32 v6, v4, 2, 2
    v_mul_u32_u24 v6, s68, v6
    v_and_b32 v4, 3, v4
    v_add3_u32 v3, v3, v6, v4
    v_add_u32 v3, s66, v3
    v_mul_u32_u24 v3, s58, v3
    v_add_u32 v22, v3, v5
    v_add_u32 v3, 64, v2
    v_mul_u32_u24 v4, 6554, v3
    v_lshrrev_b32 v4, 16, v4
    v_mul_u32_u24 v5, 10, v4
    v_sub_u32 v5, v3, v5
    v_lshlrev_b32 v5, 4, v5
    v_add_u32 v5, s71, v5
    v_lshrrev_b32 v3, 4, v4
    v_mul_u32_u24 v3, s67, v3
    v_bfe_u32 v6, v4, 2, 2
    v_mul_u32_u24 v6, s68, v6
    v_and_b32 v4, 3, v4
    v_add3_u32 v3, v3, v6, v4
    v_add_u32 v3, s66, v3
    v_mul_u32_u24 v3, s58, v3
    v_add_u32 v23, v3, v5
    v_add_u32 v3, 128, v2
    v_mul_u32_u24 v4, 6554, v3
    v_lshrrev_b32 v4, 16, v4
    v_mul_u32_u24 v5, 10, v4
    v_sub_u32 v5, v3, v5
    v_lshlrev_b32 v5, 4, v5
    v_add_u32 v5, s71, v5
    v_lshrrev_b32 v3, 4, v4
    v_mul_u32_u24 v3, s67, v3
    v_bfe_u32 v6, v4, 2, 2
    v_mul_u32_u24 v6, s68, v6
    v_and_b32 v4, 3, v4
    v_add3_u32 v3, v3, v6, v4
    v_add_u32 v3, s66, v3
    v_mul_u32_u24 v3, s58, v3
    v_add_u32 v24, v3, v5
    v_add_u32 v3, 192, v2
    v_mul_u32_u24 v4, 6554, v3
    v_lshrrev_b32 v4, 16, v4
    v_mul_u32_u24 v5, 10, v4
    v_sub_u32 v5, v3, v5
    v_lshlrev_b32 v5, 4, v5
    v_add_u32 v5, s71, v5
    v_lshrrev_b32 v3, 4, v4
    v_mul_u32_u24 v3, s67, v3
    v_bfe_u32 v6, v4, 2, 2
    v_mul_u32_u24 v6, s68, v6
    v_and_b32 v4, 3, v4
    v_add3_u32 v3, v3, v6, v4
    v_add_u32 v3, s66, v3
    v_mul_u32_u24 v3, s58, v3
    v_add_u32 v25, v3, v5
    v_add_u32 v3, 256, v2
    v_mul_u32_u24 v4, 6554, v3
    v_lshrrev_b32 v4, 16, v4
    v_mul_u32_u24 v5, 10, v4
    v_sub_u32 v5, v3, v5
    v_lshlrev_b32 v5, 4, v5
    v_add_u32 v5, s71, v5
    v_lshrrev_b32 v3, 4, v4
    v_mul_u32_u24 v3, s67, v3
    v_bfe_u32 v6, v4, 2, 2
    v_mul_u32_u24 v6, s68, v6
    v_and_b32 v4, 3, v4
    v_add3_u32 v3, v3, v6, v4
    v_add_u32 v3, s66, v3
    v_mul_u32_u24 v3, s58, v3
    v_add_u32 v26, v3, v5
    v_lshrrev_b32 v3, 2, v2
    v_mul_u32_u24 v3, 160, v3
    s_mul_i32 s72, s57, 5120
    s_add_u32 s72, s72, 49152
    v_add_u32 v3, s72, v3
    v_and_b32 v4, 3, v2
    v_lshl_add_u32 v27, v4, 4, v3
    v_lshl_add_u32 v28, v4, 3, v3
    v_lshlrev_b32 v29, 4, v2
    v_add_u32 v30, 4096, v29
    s_lshl_b32 s58, s26, 3
    s_add_u32 s58, s58, s27
    s_lshl_b32 s58, s58, 4
    s_lshl_b32 s59, s57, 2
    s_add_u32 s58, s58, s59
    v_lshrrev_b32 v3, 4, v2
    v_add_u32 v31, s58, v3
    s_movk_i32 s58, 1280
    v_mul_u32_u24 v3, s58, v31
    v_and_b32 v4, 15, v2
    v_lshlrev_b32 v33, 4, v4
    v_add_u32 v32, v3, v33
    s_mov_b32 s40, s22
    s_mov_b32 s41, s23
    s_mov_b32 s42, 12750848
    s_mov_b32 s43, 0x20000
    s_cmp_eq_u32 s70, 0
    s_cselect_b32 s44, s16, s8
    s_cselect_b32 s45, s17, s9
    s_mov_b32 s46, 2211840
    s_cselect_b32 s46, s46, 819200
    s_mov_b32 s47, 0x20000
    s_mov_b32 s48, s20
    s_mov_b32 s49, s21
    s_mov_b32 s50, 1280
    s_mov_b32 s51, 0x20000
    s_waitcnt vmcnt(12)
    s_barrier
    s_add_u32 m0, s77, 98304
    s_nop 0
    buffer_load_dwordx4 v10, s[28:31], s74 offen  lds
    s_add_u32 m0, s77, 102400
    s_nop 0
    buffer_load_dwordx4 v11, s[28:31], s74 offen  lds
    s_add_u32 m0, s77, 106496
    s_nop 0
    buffer_load_dwordx4 v12, s[28:31], s74 offen  lds
    s_add_u32 m0, s77, 110592
    s_nop 0
    buffer_load_dwordx4 v13, s[28:31], s74 offen  lds
    s_add_u32 m0, s77, 114688
    s_nop 0
    buffer_load_dwordx4 v14, s[36:39], s76 offen  lds
    s_add_u32 m0, s77, 118784
    s_nop 0
    buffer_load_dwordx4 v15, s[32:35], s75 offen  lds
    s_add_u32 m0, s77, 122880
    s_nop 0
    buffer_load_dwordx4 v16, s[32:35], s75 offen  lds
    s_add_u32 m0, s77, 126976
    s_nop 0
    buffer_load_dwordx4 v17, s[32:35], s75 offen  lds
    s_add_u32 m0, s77, 131072
    s_nop 0
    buffer_load_dwordx4 v18, s[32:35], s75 offen  lds
    s_add_u32 m0, s77, 135168
    s_nop 0
    buffer_load_dwordx4 v19, s[32:35], s75 offen  lds
    s_add_u32 m0, s77, 139264
    s_nop 0
    buffer_load_dwordx4 v20, s[32:35], s75 offen  lds
    s_add_u32 m0, s77, 143360
    s_nop 0
    buffer_load_dwordx4 v21, s[32:35], s75 offen  lds
    s_add_u32 s74, s74, 128
    s_add_u32 s75, s75, 221184
    s_add_u32 s76, s76, s73
    s_add_u32 s79, s79, 1
    s_cmp_eq_u32 s79, 10
    s_cselect_b32 s79, 0, s79
    s_cselect_b32 s74, 0, s74
    s_cselect_b32 s75, 0, s75
    s_cselect_b32 s76, 0, s76
    s_waitcnt vmcnt(12)
    s_barrier
    s_add_u32 m0, s77, 0
    s_nop 0
    buffer_load_dwordx4 v10, s[28:31], s74 offen  lds
    s_add_u32 m0, s77, 4096
    s_nop 0
    buffer_load_dwordx4 v11, s[28:31], s74 offen  lds
    s_add_u32 m0, s77, 8192
    s_nop 0
    buffer_load_dwordx4 v12, s[28:31], s74 offen  lds
    s_add_u32 m0, s77, 12288
    s_nop 0
    buffer_load_dwordx4 v13, s[28:31], s74 offen  lds
    s_add_u32 m0, s77, 16384
    s_nop 0
    buffer_load_dwordx4 v14, s[36:39], s76 offen  lds
    s_add_u32 m0, s77, 20480
    s_nop 0
    buffer_load_dwordx4 v15, s[32:35], s75 offen  lds
    s_add_u32 m0, s77, 24576
    s_nop 0
    buffer_load_dwordx4 v16, s[32:35], s75 offen  lds
    s_add_u32 m0, s77, 28672
    s_nop 0
    buffer_load_dwordx4 v17, s[32:35], s75 offen  lds
    s_add_u32 m0, s77, 32768
    s_nop 0
    buffer_load_dwordx4 v18, s[32:35], s75 offen  lds
    s_add_u32 m0, s77, 36864
    s_nop 0
    buffer_load_dwordx4 v19, s[32:35], s75 offen  lds
    s_add_u32 m0, s77, 40960
    s_nop 0
    buffer_load_dwordx4 v20, s[32:35], s75 offen  lds
    s_add_u32 m0, s77, 45056
    s_nop 0
    buffer_load_dwordx4 v21, s[32:35], s75 offen  lds
    s_add_u32 s74, s74, 128
    s_add_u32 s75, s75, 221184
    s_add_u32 s76, s76, s73
    s_add_u32 s79, s79, 1
    s_cmp_eq_u32 s79, 10
    s_cselect_b32 s79, 0, s79
    s_cselect_b32 s74, 0, s74
    s_cselect_b32 s75, 0, s75
    s_cselect_b32 s76, 0, s76
    s_waitcnt vmcnt(12)
    s_barrier
    s_add_u32 m0, s77, 49152
    s_nop 0
    buffer_load_dwordx4 v10, s[28:31], s74 offen  lds
    s_add_u32 m0, s77, 53248
    s_nop 0
    buffer_load_dwordx4 v11, s[28:31], s74 offen  lds
    s_add_u32 m0, s77, 57344
    s_nop 0
    buffer_load_dwordx4 v12, s[28:31], s74 offen  lds
    s_add_u32 m0, s77, 61440
    s_nop 0
    buffer_load_dwordx4 v13, s[28:31], s74 offen  lds
    s_add_u32 m0, s77, 65536
    s_nop 0
    buffer_load_dwordx4 v14, s[36:39], s76 offen  lds
    s_add_u32 m0, s77, 69632
    s_nop 0
    buffer_load_dwordx4 v15, s[32:35], s75 offen  lds
    s_add_u32 m0, s77, 73728
    s_nop 0
    buffer_load_dwordx4 v16, s[32:35], s75 offen  lds
    s_add_u32 m0, s77, 77824
    s_nop 0
    buffer_load_dwordx4 v17, s[32:35], s75 offen  lds
    s_add_u32 m0, s77, 81920
    s_nop 0
    buffer_load_dwordx4 v18, s[32:35], s75 offen  lds
    s_add_u32 m0, s77, 86016
    s_nop 0
    buffer_load_dwordx4 v19, s[32:35], s75 offen  lds
    s_add_u32 m0, s77, 90112
    s_nop 0
    buffer_load_dwordx4 v20, s[32:35], s75 offen  lds
    s_add_u32 m0, s77, 94208
    s_nop 0
    buffer_load_dwordx4 v21, s[32:35], s75 offen  lds
    s_add_u32 s74, s74, 128
    s_add_u32 s75, s75, 221184
    s_add_u32 s76, s76, s73
    s_add_u32 s79, s79, 1
    s_cmp_eq_u32 s79, 10
    s_cselect_b32 s79, 0, s79
    s_cselect_b32 s74, 0, s74
    s_cselect_b32 s75, 0, s75
    s_cselect_b32 s76, 0, s76
    s_waitcnt vmcnt(12)
    s_barrier
    s_add_u32 m0, s77, 98304
    s_nop 0
    buffer_load_dwordx4 v10, s[28:31], s74 offen  lds
    s_add_u32 m0, s77, 102400
    s_nop 0
    buffer_load_dwordx4 v11, s[28:31], s74 offen  lds
    s_add_u32 m0, s77, 106496
    s_nop 0
    buffer_load_dwordx4 v12, s[28:31], s74 offen  lds
    s_add_u32 m0, s77, 110592
    s_nop 0
    buffer_load_dwordx4 v13, s[28:31], s74 offen  lds
    s_add_u32 m0, s77, 114688
    s_nop 0
    buffer_load_dwordx4 v14, s[36:39], s76 offen  lds
    s_add_u32 m0, s77, 118784
    s_nop 0
    buffer_load_dwordx4 v15, s[32:35], s75 offen  lds
    s_add_u32 m0, s77, 122880
    s_nop 0
    buffer_load_dwordx4 v16, s[32:35], s75 offen  lds
    s_add_u32 m0, s77, 126976
    s_nop 0
    buffer_load_dwordx4 v17, s[32:35], s75 offen  lds
    s_add_u32 m0, s77, 131072
    s_nop 0
    buffer_load_dwordx4 v18, s[32:35], s75 offen  lds
    s_add_u32 m0, s77, 135168
    s_nop 0
    buffer_load_dwordx4 v19, s[32:35], s75 offen  lds
    s_add_u32 m0, s77, 139264
    s_nop 0
    buffer_load_dwordx4 v20, s[32:35], s75 offen  lds
    s_add_u32 m0, s77, 143360
    s_nop 0
    buffer_load_dwordx4 v21, s[32:35], s75 offen  lds
    s_add_u32 s74, s74, 128
    s_add_u32 s75, s75, 221184
    s_add_u32 s76, s76, s73
    s_add_u32 s79, s79, 1
    s_cmp_eq_u32 s79, 10
    s_cselect_b32 s79, 0, s79
    s_cselect_b32 s74, 0, s74
    s_cselect_b32 s75, 0, s75
    s_cselect_b32 s76, 0, s76
    s_waitcnt vmcnt(12)
    s_barrier
    s_add_u32 m0, s77, 0
    s_nop 0
    buffer_load_dwordx4 v10, s[28:31], s74 offen  lds
    s_add_u32 m0, s77, 4096
    s_nop 0
    buffer_load_dwordx4 v11, s[28:31], s74 offen  lds
    s_add_u32 m0, s77, 8192
    s_nop 0
    buffer_load_dwordx4 v12, s[28:31], s74 offen  lds
    s_add_u32 m0, s77, 12288
    s_nop 0
    buffer_load_dwordx4 v13, s[28:31], s74 offen  lds
    s_add_u32 m0, s77, 16384
    s_nop 0
    buffer_load_dwordx4 v14, s[36:39], s76 offen  lds
    s_add_u32 m0, s77, 20480
    s_nop 0
    buffer_load_dwordx4 v15, s[32:35], s75 offen  lds
    s_add_u32 m0, s77, 24576
    s_nop 0
    buffer_load_dwordx4 v16, s[32:35], s75 offen  lds
    s_add_u32 m0, s77, 28672
    s_nop 0
    buffer_load_dwordx4 v17, s[32:35], s75 offen  lds
    s_add_u32 m0, s77, 32768
    s_nop 0
    buffer_load_dwordx4 v18, s[32:35], s75 offen  lds
    s_add_u32 m0, s77, 36864
    s_nop 0
    buffer_load_dwordx4 v19, s[32:35], s75 offen  lds
    s_add_u32 m0, s77, 40960
    s_nop 0
    buffer_load_dwordx4 v20, s[32:35], s75 offen  lds
    s_add_u32 m0, s77, 45056
    s_nop 0
    buffer_load_dwordx4 v21, s[32:35], s75 offen  lds
    s_add_u32 s74, s74, 128
    s_add_u32 s75, s75, 221184
    s_add_u32 s76, s76, s73
    s_add_u32 s79, s79, 1
    s_cmp_eq_u32 s79, 10
    s_cselect_b32 s79, 0, s79
    s_cselect_b32 s74, 0, s74
    s_cselect_b32 s75, 0, s75
    s_cselect_b32 s76, 0, s76
    s_waitcnt vmcnt(12)
    s_barrier
    s_add_u32 m0, s77, 49152
    s_nop 0
    buffer_load_dwordx4 v10, s[28:31], s74 offen  lds
    s_add_u32 m0, s77, 53248
    s_nop 0
    buffer_load_dwordx4 v11, s[28:31], s74 offen  lds
    s_add_u32 m0, s77, 57344
    s_nop 0
    buffer_load_dwordx4 v12, s[28:31], s74 offen  lds
    s_add_u32 m0, s77, 61440
    s_nop 0
    buffer_load_dwordx4 v13, s[28:31], s74 offen  lds
    s_add_u32 m0, s77, 65536
    s_nop 0
    buffer_load_dwordx4 v14, s[36:39], s76 offen  lds
    s_add_u32 m0, s77, 69632
    s_nop 0
    buffer_load_dwordx4 v15, s[32:35], s75 offen  lds
    s_add_u32 m0, s77, 73728
    s_nop 0
    buffer_load_dwordx4 v16, s[32:35], s75 offen  lds
    s_add_u32 m0, s77, 77824
    s_nop 0
    buffer_load_dwordx4 v17, s[32:35], s75 offen  lds
    s_add_u32 m0, s77, 81920
    s_nop 0
    buffer_load_dwordx4 v18, s[32:35], s75 offen  lds
    s_add_u32 m0, s77, 86016
    s_nop 0
    buffer_load_dwordx4 v19, s[32:35], s75 offen  lds
    s_add_u32 m0, s77, 90112
    s_nop 0
    buffer_load_dwordx4 v20, s[32:35], s75 offen  lds
    s_add_u32 m0, s77, 94208
    s_nop 0
    buffer_load_dwordx4 v21, s[32:35], s75 offen  lds
    s_add_u32 s74, s74, 128
    s_add_u32 s75, s75, 221184
    s_add_u32 s76, s76, s73
    s_add_u32 s79, s79, 1
    s_cmp_eq_u32 s79, 10
    s_cselect_b32 s79, 0, s79
    s_cselect_b32 s74, 0, s74
    s_cselect_b32 s75, 0, s75
    s_cselect_b32 s76, 0, s76
    s_waitcnt vmcnt(12)
    s_barrier
    s_add_u32 m0, s77, 98304
    s_nop 0
    buffer_load_dwordx4 v10, s[28:31], s74 offen  lds
    s_add_u32 m0, s77, 102400
    s_nop 0
    buffer_load_dwordx4 v11, s[28:31], s74 offen  lds
    s_add_u32 m0, s77, 106496
    s_nop 0
    buffer_load_dwordx4 v12, s[28:31], s74 offen  lds
    s_add_u32 m0, s77, 110592
    s_nop 0
    buffer_load_dwordx4 v13, s[28:31], s74 offen  lds
    s_add_u32 m0, s77, 114688
    s_nop 0
    buffer_load_dwordx4 v14, s[36:39], s76 offen  lds
    s_add_u32 m0, s77, 118784
    s_nop 0
    buffer_load_dwordx4 v15, s[32:35], s75 offen  lds
    s_add_u32 m0, s77, 122880
    s_nop 0
    buffer_load_dwordx4 v16, s[32:35], s75 offen  lds
    s_add_u32 m0, s77, 126976
    s_nop 0
    buffer_load_dwordx4 v17, s[32:35], s75 offen  lds
    s_add_u32 m0, s77, 131072
    s_nop 0
    buffer_load_dwordx4 v18, s[32:35], s75 offen  lds
    s_add_u32 m0, s77, 135168
    s_nop 0
    buffer_load_dwordx4 v19, s[32:35], s75 offen  lds
    s_add_u32 m0, s77, 139264
    s_nop 0
    buffer_load_dwordx4 v20, s[32:35], s75 offen  lds
    s_add_u32 m0, s77, 143360
    s_nop 0
    buffer_load_dwordx4 v21, s[32:35], s75 offen  lds
    s_add_u32 s74, s74, 128
    s_add_u32 s75, s75, 221184
    s_add_u32 s76, s76, s73
    s_add_u32 s79, s79, 1
    s_cmp_eq_u32 s79, 10
    s_cselect_b32 s79, 0, s79
    s_cselect_b32 s74, 0, s74
    s_cselect_b32 s75, 0, s75
    s_cselect_b32 s76, 0, s76
    s_waitcnt vmcnt(12)
    s_barrier
    s_add_u32 m0, s77, 0
    s_nop 0
    buffer_load_dwordx4 v10, s[28:31], s74 offen  lds
    s_add_u32 m0, s77, 4096
    s_nop 0
    buffer_load_dwordx4 v11, s[28:31], s74 offen  lds
    s_add_u32 m0, s77, 8192
    s_nop 0
    buffer_load_dwordx4 v12, s[28:31], s74 offen  lds
    s_add_u32 m0, s77, 12288
    s_nop 0
    buffer_load_dwordx4 v13, s[28:31], s74 offen  lds
    s_add_u32 m0, s77, 16384
    s_nop 0
    buffer_load_dwordx4 v14, s[36:39], s76 offen  lds
    s_add_u32 m0, s77, 20480
    s_nop 0
    buffer_load_dwordx4 v15, s[32:35], s75 offen  lds
    s_add_u32 m0, s77, 24576
    s_nop 0
    buffer_load_dwordx4 v16, s[32:35], s75 offen  lds
    s_add_u32 m0, s77, 28672
    s_nop 0
    buffer_load_dwordx4 v17, s[32:35], s75 offen  lds
    s_add_u32 m0, s77, 32768
    s_nop 0
    buffer_load_dwordx4 v18, s[32:35], s75 offen  lds
    s_add_u32 m0, s77, 36864
    s_nop 0
    buffer_load_dwordx4 v19, s[32:35], s75 offen  lds
    s_add_u32 m0, s77, 40960
    s_nop 0
    buffer_load_dwordx4 v20, s[32:35], s75 offen  lds
    s_add_u32 m0, s77, 45056
    s_nop 0
    buffer_load_dwordx4 v21, s[32:35], s75 offen  lds
    s_add_u32 s74, s74, 128
    s_add_u32 s75, s75, 221184
    s_add_u32 s76, s76, s73
    s_add_u32 s79, s79, 1
    s_cmp_eq_u32 s79, 10
    s_cselect_b32 s79, 0, s79
    s_cselect_b32 s74, 0, s74
    s_cselect_b32 s75, 0, s75
    s_cselect_b32 s76, 0, s76
    s_waitcnt vmcnt(12)
    s_barrier
    s_cmp_eq_u32 s63, 0
    s_cbranch_scc1 L_nounit_ld_F
    s_add_u32 m0, s72, 0
    s_nop 0
    buffer_load_dwordx4 v22, s[44:47], 0 offen nt lds
    s_add_u32 m0, s72, 1024
    s_nop 0
    buffer_load_dwordx4 v23, s[44:47], 0 offen nt lds
    s_add_u32 m0, s72, 2048
    s_nop 0
    buffer_load_dwordx4 v24, s[44:47], 0 offen nt lds
    s_add_u32 m0, s72, 3072
    s_nop 0
    buffer_load_dwordx4 v25, s[44:47], 0 offen nt lds
    s_add_u32 m0, s72, 4096
    s_nop 0
    buffer_load_dwordx4 v26, s[44:47], 0 offen nt lds
L_nounit_ld_F:
    buffer_load_dwordx4 v[40:43], v32, s[28:31], 0 offen offset:0
    buffer_load_dwordx4 v[60:63], v33, s[48:51], 0 offen offset:0
    buffer_load_dwordx4 v[44:47], v32, s[28:31], 0 offen offset:256
    buffer_load_dwordx4 v[64:67], v33, s[48:51], 0 offen offset:256
    buffer_load_dwordx4 v[48:51], v32, s[28:31], 0 offen offset:512
    buffer_load_dwordx4 v[68:71], v33, s[48:51], 0 offen offset:512
    buffer_load_dwordx4 v[52:55], v32, s[28:31], 0 offen offset:768
    buffer_load_dwordx4 v[72:75], v33, s[48:51], 0 offen offset:768
    buffer_load_dwordx4 v[56:59], v32, s[28:31], 0 offen offset:1024
    buffer_load_dwordx4 v[76:79], v33, s[48:51], 0 offen offset:1024
    s_cmp_eq_u32 s63, 0
    s_cbranch_scc1 L_w8a_F
    s_waitcnt vmcnt(15)
    s_branch L_w8b_F
L_w8a_F:
    s_waitcnt vmcnt(10)
L_w8b_F:
    s_barrier
    s_cmp_eq_u32 s57, 3
    s_cbranch_scc0 L_nok2pf_F
    v_mov_b32 v34, v2
    s_getpc_b64 s[84:85]
L_pc_k2pfF:
    s_add_u32 s84, s84, gm_k2_kernel-L_pc_k2pfF
    s_addc_u32 s85, s85, 0
    s_lshr_b32 s86, s2, 3
    s_cmp_lt_u32 s86, 2
    s_cbranch_scc0 L_pfskip_k2pfF
    s_lshl_b32 s86, s86, 13
    v_lshlrev_b32 v34, 7, v34
    v_add_u32 v34, s86, v34
    v_min_u32 v34, L_k2_end-gm_k2_kernel, v34
    global_load_dword v255, v34, s[84:85]
L_pfskip_k2pfF:
L_nok2pf_F:
    s_waitcnt vmcnt(0) lgkmcnt(0)
    s_cmp_eq_u32 s63, 0
    s_cbranch_scc1 L_nounit_F
    ds_read_b64_tr_b16 v[84:85], v27 offset:0
    ds_read_b64_tr_b16 v[86:87], v27 offset:2560
    ds_read_b64_tr_b16 v[88:89], v27 offset:8
    ds_read_b64_tr_b16 v[90:91], v27 offset:2568
    ds_read_b64_tr_b16 v[92:93], v27 offset:64
    ds_read_b64_tr_b16 v[94:95], v27 offset:2624
    ds_read_b64_tr_b16 v[96:97], v27 offset:72
    ds_read_b64_tr_b16 v[98:99], v27 offset:2632
    ds_read_b64_tr_b16 v[100:101], v28 offset:128
    ds_read_b64_tr_b16 v[102:103], v28 offset:2688
    s_waitcnt lgkmcnt(8)
    buffer_store_dwordx4 v[84:87], v29, s[40:43], s69 offen offset:0 sc1
    s_waitcnt lgkmcnt(6)
    buffer_store_dwordx4 v[88:91], v29, s[40:43], s69 offen offset:1024 sc1
    s_waitcnt lgkmcnt(4)
    buffer_store_dwordx4 v[92:95], v29, s[40:43], s69 offen offset:2048 sc1
    s_waitcnt lgkmcnt(2)
    buffer_store_dwordx4 v[96:99], v29, s[40:43], s69 offen offset:3072 sc1
    s_waitcnt lgkmcnt(0)
    buffer_store_dwordx4 v[100:103], v30, s[40:43], s69 offen sc1
L_nounit_F:
    v_mov_b32 v34, 0
    v_mov_b32 v35, 0
    v_mov_b32 v36, 0x3f803f80
    s_mov_b32 s78, 0xffff0000
    v_lshlrev_b32 v104, 16, v40
    v_and_b32 v105, s78, v40
    v_lshlrev_b32 v106, 16, v60
    v_and_b32 v107, s78, v60
    v_pk_mul_f32 v[104:105], v[104:105], v[106:107]
    v_cvt_pk_bf16_f32 v108, v104, v105
    v_dot2_f32_bf16 v34, v108, v36, v34
    v_lshlrev_b32 v110, 16, v41
    v_and_b32 v111, s78, v41
    v_lshlrev_b32 v112, 16, v61
    v_and_b32 v113, s78, v61
    v_pk_mul_f32 v[110:111], v[110:111], v[112:113]
    v_cvt_pk_bf16_f32 v114, v110, v111
    v_dot2_f32_bf16 v35, v114, v36, v35
    v_lshlrev_b32 v104, 16, v42
    v_and_b32 v105, s78, v42
    v_lshlrev_b32 v106, 16, v62
    v_and_b32 v107, s78, v62
    v_pk_mul_f32 v[104:105], v[104:105], v[106:107]
    v_cvt_pk_bf16_f32 v108, v104, v105
    v_dot2_f32_bf16 v34, v108, v36, v34
    v_lshlrev_b32 v110, 16, v43
    v_and_b32 v111, s78, v43
    v_lshlrev_b32 v112, 16, v63
    v_and_b32 v113, s78, v63
    v_pk_mul_f32 v[110:111], v[110:111], v[112:113]
    v_cvt_pk_bf16_f32 v114, v110, v111
    v_dot2_f32_bf16 v35, v114, v36, v35
    v_lshlrev_b32 v104, 16, v44
    v_and_b32 v105, s78, v44
    v_lshlrev_b32 v106, 16, v64
    v_and_b32 v107, s78, v64
    v_pk_mul_f32 v[104:105], v[104:105], v[106:107]
    v_cvt_pk_bf16_f32 v108, v104, v105
    v_dot2_f32_bf16 v34, v108, v36, v34
    v_lshlrev_b32 v110, 16, v45
    v_and_b32 v111, s78, v45
    v_lshlrev_b32 v112, 16, v65
    v_and_b32 v113, s78, v65
    v_pk_mul_f32 v[110:111], v[110:111], v[112:113]
    v_cvt_pk_bf16_f32 v114, v110, v111
    v_dot2_f32_bf16 v35, v114, v36, v35
    v_lshlrev_b32 v104, 16, v46
    v_and_b32 v105, s78, v46
    v_lshlrev_b32 v106, 16, v66
    v_and_b32 v107, s78, v66
    v_pk_mul_f32 v[104:105], v[104:105], v[106:107]
    v_cvt_pk_bf16_f32 v108, v104, v105
    v_dot2_f32_bf16 v34, v108, v36, v34
    v_lshlrev_b32 v110, 16, v47
    v_and_b32 v111, s78, v47
    v_lshlrev_b32 v112, 16, v67
    v_and_b32 v113, s78, v67
    v_pk_mul_f32 v[110:111], v[110:111], v[112:113]
    v_cvt_pk_bf16_f32 v114, v110, v111
    v_dot2_f32_bf16 v35, v114, v36, v35
    v_lshlrev_b32 v104, 16, v48
    v_and_b32 v105, s78, v48
    v_lshlrev_b32 v106, 16, v68
    v_and_b32 v107, s78, v68
    v_pk_mul_f32 v[104:105], v[104:105], v[106:107]
    v_cvt_pk_bf16_f32 v108, v104, v105
    v_dot2_f32_bf16 v34, v108, v36, v34
    v_lshlrev_b32 v110, 16, v49
    v_and_b32 v111, s78, v49
    v_lshlrev_b32 v112, 16, v69
    v_and_b32 v113, s78, v69
    v_pk_mul_f32 v[110:111], v[110:111], v[112:113]
    v_cvt_pk_bf16_f32 v114, v110, v111
    v_dot2_f32_bf16 v35, v114, v36, v35
    v_lshlrev_b32 v104, 16, v50
    v_and_b32 v105, s78, v50
    v_lshlrev_b32 v106, 16, v70
    v_and_b32 v107, s78, v70
    v_pk_mul_f32 v[104:105], v[104:105], v[106:107]
    v_cvt_pk_bf16_f32 v108, v104, v105
    v_dot2_f32_bf16 v34, v108, v36, v34
    v_lshlrev_b32 v110, 16, v51
    v_and_b32 v111, s78, v51
    v_lshlrev_b32 v112, 16, v71
    v_and_b32 v113, s78, v71
    v_pk_mul_f32 v[110:111], v[110:111], v[112:113]
    v_cvt_pk_bf16_f32 v114, v110, v111
    v_dot2_f32_bf16 v35, v114, v36, v35
    v_lshlrev_b32 v104, 16, v52
    v_and_b32 v105, s78, v52
    v_lshlrev_b32 v106, 16, v72
    v_and_b32 v107, s78, v72
    v_pk_mul_f32 v[104:105], v[104:105], v[106:107]
    v_cvt_pk_bf16_f32 v108, v104, v105
    v_dot2_f32_bf16 v34, v108, v36, v34
    v_lshlrev_b32 v110, 16, v53
    v_and_b32 v111, s78, v53
    v_lshlrev_b32 v112, 16, v73
    v_and_b32 v113, s78, v73
    v_pk_mul_f32 v[110:111], v[110:111], v[112:113]
    v_cvt_pk_bf16_f32 v114, v110, v111
    v_dot2_f32_bf16 v35, v114, v36, v35
    v_lshlrev_b32 v104, 16, v54
    v_and_b32 v105, s78, v54
    v_lshlrev_b32 v106, 16, v74
    v_and_b32 v107, s78, v74
    v_pk_mul_f32 v[104:105], v[104:105], v[106:107]
    v_cvt_pk_bf16_f32 v108, v104, v105
    v_dot2_f32_bf16 v34, v108, v36, v34
    v_lshlrev_b32 v110, 16, v55
    v_and_b32 v111, s78, v55
    v_lshlrev_b32 v112, 16, v75
    v_and_b32 v113, s78, v75
    v_pk_mul_f32 v[110:111], v[110:111], v[112:113]
    v_cvt_pk_bf16_f32 v114, v110, v111
    v_dot2_f32_bf16 v35, v114, v36, v35
    v_lshlrev_b32 v104, 16, v56
    v_and_b32 v105, s78, v56
    v_lshlrev_b32 v106, 16, v76
    v_and_b32 v107, s78, v76
    v_pk_mul_f32 v[104:105], v[104:105], v[106:107]
    v_cvt_pk_bf16_f32 v108, v104, v105
    v_dot2_f32_bf16 v34, v108, v36, v34
    v_lshlrev_b32 v110, 16, v57
    v_and_b32 v111, s78, v57
    v_lshlrev_b32 v112, 16, v77
    v_and_b32 v113, s78, v77
    v_pk_mul_f32 v[110:111], v[110:111], v[112:113]
    v_cvt_pk_bf16_f32 v114, v110, v111
    v_dot2_f32_bf16 v35, v114, v36, v35
    v_lshlrev_b32 v104, 16, v58
    v_and_b32 v105, s78, v58
    v_lshlrev_b32 v106, 16, v78
    v_and_b32 v107, s78, v78
    v_pk_mul_f32 v[104:105], v[104:105], v[106:107]
    v_cvt_pk_bf16_f32 v108, v104, v105
    v_dot2_f32_bf16 v34, v108, v36, v34
    v_lshlrev_b32 v110, 16, v59
    v_and_b32 v111, s78, v59
    v_lshlrev_b32 v112, 16, v79
    v_and_b32 v113, s78, v79
    v_pk_mul_f32 v[110:111], v[110:111], v[112:113]
    v_cvt_pk_bf16_f32 v114, v110, v111
    v_dot2_f32_bf16 v35, v114, v36, v35
    s_nop 2
    v_add_f32 v34, v34, v35
    s_nop 1
    v_add_f32_dpp v34, v34, v34 row_ror:8 row_mask:0xf bank_mask:0xf
    s_nop 1
    v_add_f32_dpp v34, v34, v34 row_ror:4 row_mask:0xf bank_mask:0xf
    s_nop 1
    v_add_f32_dpp v34, v34, v34 row_ror:2 row_mask:0xf bank_mask:0xf
    s_nop 1
    v_add_f32_dpp v34, v34, v34 row_ror:1 row_mask:0xf bank_mask:0xf
    v_cvt_pk_bf16_f32 v35, v34, v34
    v_lshlrev_b32 v35, 16, v35
    v_mul_f32 v35, 0xbfb8aa3b, v35
    v_exp_f32 v35, v35
    s_nop 0
    v_add_f32 v35, 1.0, v35
    v_rcp_f32 v35, v35
    s_nop 0
    v_cvt_pk_bf16_f32 v35, v35, v35
    v_lshlrev_b32 v38, 16, v35
    v_sub_f32 v39, 1.0, v38
    v_cvt_pk_bf16_f32 v39, v39, v39
    v_lshlrev_b32 v39, 16, v39
    v_lshlrev_b32 v37, 3, v31
    v_add_u32 v37, 12730368, v37
    buffer_store_dwordx2 v[38:39], v37, s[40:43], 0 offen sc1
    s_endpgm
L_k1_end:
    s_endpgm
.globl gm_k2_kernel
.p2align 8
.type gm_k2_kernel,@function
gm_k2_kernel:
    s_cmp_ge_u32 s2, 256
    s_cbranch_scc1 L_k2_end
    s_load_dwordx2 s[4:5], s[0:1], 88
    s_load_dwordx2 s[6:7], s[0:1], 72
    s_load_dwordx2 s[8:9], s[0:1], 56
    v_lshrrev_b32 v1, 6, v0
    v_and_b32 v2, 63, v0
    v_readfirstlane_b32 s24, v1
    s_and_b32 s52, s2, 7
    s_lshr_b32 s53, s2, 3
    s_lshr_b32 s54, s52, 1
    s_lshl_b32 s54, s54, 3
    s_lshr_b32 s55, s53, 2
    s_add_u32 s26, s54, s55
    s_and_b32 s54, s52, 1
    s_lshl_b32 s54, s54, 2
    s_and_b32 s55, s53, 3
    s_add_u32 s27, s54, s55
    s_cmp_eq_u32 s24, 0
    s_cbranch_scc0 L_k2_nopf
    v_mov_b32 v10, v2
    s_getpc_b64 s[84:85]
L_pc_k2:
    s_add_u32 s84, s84, L_k2_body-L_pc_k2
    s_addc_u32 s85, s85, 0
    s_lshr_b32 s86, s2, 3
    s_cmp_lt_u32 s86, 2
    s_cbranch_scc0 L_pfskip_k2
    s_lshl_b32 s86, s86, 13
    v_lshlrev_b32 v10, 7, v10
    v_add_u32 v10, s86, v10
    v_min_u32 v10, L_k2_end-L_k2_body, v10
    global_load_dword v255, v10, s[84:85]
L_pfskip_k2:
L_k2_nopf:
L_k2_body:
    v_lshlrev_b32 v224, 4, v2
    v_add_u32 v225, 4096, v224
    s_cmp_eq_u32 s24, 0
    s_mov_b32 s56, 20480
    s_cselect_b32 s56, s56, 55296
    s_mov_b32 s57, 7077888
    s_cselect_b32 s57, s57, 0
    s_mov_b32 s58, 11911168
    s_cselect_b32 s58, s58, 9699328
    s_cselect_b32 s59, 20, 54
    s_mul_i32 s60, s24, 18
    s_cselect_b32 s60, 18, s60
    s_sub_u32 s60, s60, 18
    s_lshl_b32 s61, s26, 2
    s_mul_i32 s61, s61, s56
    s_add_u32 s61, s61, s57
    s_lshl_b32 s62, s60, 10
    s_add_u32 s20, s61, s62
    s_mul_i32 s61, s27, s59
    s_add_u32 s61, s61, s60
    s_mul_i32 s61, s61, 5120
    s_add_u32 s21, s61, s58
    s_mul_i32 s62, s56, 0
    v_add_u32 v226, s62, v224
    s_mul_i32 s62, s56, 1
    v_add_u32 v227, s62, v224
    s_mul_i32 s62, s56, 2
    v_add_u32 v228, s62, v224
    s_mul_i32 s62, s56, 3
    v_add_u32 v229, s62, v224
    v_and_b32 v3, 15, v2
    v_lshrrev_b32 v4, 4, v2
    s_lshl_b32 s62, s26, 6
    s_lshl_b32 s63, s24, 4
    s_add_u32 s62, s62, s63
    v_add_u32 v5, s62, v3
    v_lshlrev_b32 v6, 3, v5
    v_add_u32 v6, 12730368, v6
    s_mul_i32 s63, s27, 160
    v_lshlrev_b32 v7, 4, v4
    v_add_u32 v7, s63, v7
    v_lshlrev_b32 v8, 3, v4
    v_add_u32 v8, s63, v8
    s_movk_i32 s63, 1280
    v_mul_u32_u24 v5, s63, v5
    v_add_u32 v242, v5, v7
    v_add_u32 v243, v5, v8
    v_mov_b32 v214, 0
    v_mov_b32 v215, 0
    v_mov_b32 v216, 0
    v_mov_b32 v217, 0
    v_mov_b32 v219, 81920
    ds_write_b128 v219, v[214:217]
    ds_write_b128 v219, v[214:217] offset:16
    s_waitcnt lgkmcnt(0)
    s_barrier
    s_mov_b32 s12, s4
    s_mov_b32 s13, s5
    s_mov_b32 s14, 12750848
    s_mov_b32 s15, 0x20000
    s_mov_b32 s16, s8
    s_mov_b32 s17, s9
    s_mov_b32 s18, 1280
    s_mov_b32 s19, 0x20000
    s_mov_b32 s28, s6
    s_mov_b32 s29, s7
    s_mov_b32 s30, 2621440
    s_mov_b32 s31, 0x20000
    s_lshl_b32 s62, s26, 6
    v_add_u32 v9, s62, v3
    v_lshlrev_b32 v9, 3, v9
    v_add_u32 v9, 12730368, v9
    buffer_load_dwordx2 v[244:245], v9, s[12:15], 0 offen
    buffer_load_dwordx2 v[230:231], v6, s[12:15], 0 offen
    buffer_load_dwordx4 v[232:235], v7, s[16:19], 0 offen
    buffer_load_dwordx4 v[236:239], v7, s[16:19], 0 offen offset:64
    buffer_load_dwordx2 v[240:241], v8, s[16:19], 0 offen offset:128
    s_cmp_eq_u32 s24, 0
    s_cbranch_scc0 L_k2_b
    buffer_load_dwordx4 v[16:19], v224, s[12:15], s21 offen offset:0
    buffer_load_dwordx4 v[20:23], v224, s[12:15], s21 offen offset:1024
    buffer_load_dwordx4 v[24:27], v224, s[12:15], s21 offen offset:2048
    buffer_load_dwordx4 v[28:31], v224, s[12:15], s21 offen offset:3072
    buffer_load_dwordx4 v[32:35], v225, s[12:15], s21 offen
    buffer_load_dwordx4 v[0:3], v226, s[12:15], s20 offen
    buffer_load_dwordx4 v[4:7], v227, s[12:15], s20 offen
    buffer_load_dwordx4 v[8:11], v228, s[12:15], s20 offen
    buffer_load_dwordx4 v[12:15], v229, s[12:15], s20 offen
    s_add_u32 s20, s20, 1024
    s_add_u32 s21, s21, 5120
    buffer_load_dwordx4 v[52:55], v224, s[12:15], s21 offen offset:0
    buffer_load_dwordx4 v[56:59], v224, s[12:15], s21 offen offset:1024
    buffer_load_dwordx4 v[60:63], v224, s[12:15], s21 offen offset:2048
    buffer_load_dwordx4 v[64:67], v224, s[12:15], s21 offen offset:3072
    buffer_load_dwordx4 v[68:71], v225, s[12:15], s21 offen
    buffer_load_dwordx4 v[36:39], v226, s[12:15], s20 offen
    buffer_load_dwordx4 v[40:43], v227, s[12:15], s20 offen
    buffer_load_dwordx4 v[44:47], v228, s[12:15], s20 offen
    buffer_load_dwordx4 v[48:51], v229, s[12:15], s20 offen
    s_add_u32 s20, s20, 1024
    s_add_u32 s21, s21, 5120
    buffer_load_dwordx4 v[88:91], v224, s[12:15], s21 offen offset:0
    buffer_load_dwordx4 v[92:95], v224, s[12:15], s21 offen offset:1024
    buffer_load_dwordx4 v[96:99], v224, s[12:15], s21 offen offset:2048
    buffer_load_dwordx4 v[100:103], v224, s[12:15], s21 offen offset:3072
    buffer_load_dwordx4 v[104:107], v225, s[12:15], s21 offen
    buffer_load_dwordx4 v[72:75], v226, s[12:15], s20 offen
    buffer_load_dwordx4 v[76:79], v227, s[12:15], s20 offen
    buffer_load_dwordx4 v[80:83], v228, s[12:15], s20 offen
    buffer_load_dwordx4 v[84:87], v229, s[12:15], s20 offen
    s_add_u32 s20, s20, 1024
    s_add_u32 s21, s21, 5120
    v_mov_b32 v108, 0
    v_mov_b32 v109, 0
    v_mov_b32 v110, 0
    v_mov_b32 v111, 0
    v_mov_b32 v112, 0
    v_mov_b32 v113, 0
    v_mov_b32 v114, 0
    v_mov_b32 v115, 0
    v_mov_b32 v116, 0
    v_mov_b32 v117, 0
    v_mov_b32 v118, 0
    v_mov_b32 v119, 0
    v_mov_b32 v120, 0
    v_mov_b32 v121, 0
    v_mov_b32 v122, 0
    v_mov_b32 v123, 0
    v_mov_b32 v124, 0
    v_mov_b32 v125, 0
    v_mov_b32 v126, 0
    v_mov_b32 v127, 0
    v_mov_b32 v128, 0
    v_mov_b32 v129, 0
    v_mov_b32 v130, 0
    v_mov_b32 v131, 0
    v_mov_b32 v132, 0
    v_mov_b32 v133, 0
    v_mov_b32 v134, 0
    v_mov_b32 v135, 0
    v_mov_b32 v136, 0
    v_mov_b32 v137, 0
    v_mov_b32 v138, 0
    v_mov_b32 v139, 0
    v_mov_b32 v140, 0
    v_mov_b32 v141, 0
    v_mov_b32 v142, 0
    v_mov_b32 v143, 0
    v_mov_b32 v144, 0
    v_mov_b32 v145, 0
    v_mov_b32 v146, 0
    v_mov_b32 v147, 0
    v_mov_b32 v148, 0
    v_mov_b32 v149, 0
    v_mov_b32 v150, 0
    v_mov_b32 v151, 0
    v_mov_b32 v152, 0
    v_mov_b32 v153, 0
    v_mov_b32 v154, 0
    v_mov_b32 v155, 0
    v_mov_b32 v156, 0
    v_mov_b32 v157, 0
    v_mov_b32 v158, 0
    v_mov_b32 v159, 0
    v_mov_b32 v160, 0
    v_mov_b32 v161, 0
    v_mov_b32 v162, 0
    v_mov_b32 v163, 0
    v_mov_b32 v164, 0
    v_mov_b32 v165, 0
    v_mov_b32 v166, 0
    v_mov_b32 v167, 0
    v_mov_b32 v168, 0
    v_mov_b32 v169, 0
    v_mov_b32 v170, 0
    v_mov_b32 v171, 0
    v_mov_b32 v172, 0
    v_mov_b32 v173, 0
    v_mov_b32 v174, 0
    v_mov_b32 v175, 0
    v_mov_b32 v176, 0
    v_mov_b32 v177, 0
    v_mov_b32 v178, 0
    v_mov_b32 v179, 0
    v_mov_b32 v180, 0
    v_mov_b32 v181, 0
    v_mov_b32 v182, 0
    v_mov_b32 v183, 0
    v_mov_b32 v184, 0
    v_mov_b32 v185, 0
    v_mov_b32 v186, 0
    v_mov_b32 v187, 0
    s_waitcnt vmcnt(18)
    v_mfma_f32_16x16x32_bf16 v[108:111], v[16:19], v[0:3], v[108:111]
    v_mfma_f32_16x16x32_bf16 v[128:131], v[16:19], v[4:7], v[128:131]
    v_mfma_f32_16x16x32_bf16 v[148:151], v[16:19], v[8:11], v[148:151]
    v_mfma_f32_16x16x32_bf16 v[168:171], v[16:19], v[12:15], v[168:171]
    buffer_load_dwordx4 v[16:19], v224, s[12:15], s21 offen offset:0
    v_mfma_f32_16x16x32_bf16 v[112:115], v[20:23], v[0:3], v[112:115]
    v_mfma_f32_16x16x32_bf16 v[132:135], v[20:23], v[4:7], v[132:135]
    v_mfma_f32_16x16x32_bf16 v[152:155], v[20:23], v[8:11], v[152:155]
    v_mfma_f32_16x16x32_bf16 v[172:175], v[20:23], v[12:15], v[172:175]
    buffer_load_dwordx4 v[20:23], v224, s[12:15], s21 offen offset:1024
    v_mfma_f32_16x16x32_bf16 v[116:119], v[24:27], v[0:3], v[116:119]
    v_mfma_f32_16x16x32_bf16 v[136:139], v[24:27], v[4:7], v[136:139]
    v_mfma_f32_16x16x32_bf16 v[156:159], v[24:27], v[8:11], v[156:159]
    v_mfma_f32_16x16x32_bf16 v[176:179], v[24:27], v[12:15], v[176:179]
    buffer_load_dwordx4 v[24:27], v224, s[12:15], s21 offen offset:2048
    v_mfma_f32_16x16x32_bf16 v[120:123], v[28:31], v[0:3], v[120:123]
    v_mfma_f32_16x16x32_bf16 v[140:143], v[28:31], v[4:7], v[140:143]
    v_mfma_f32_16x16x32_bf16 v[160:163], v[28:31], v[8:11], v[160:163]
    v_mfma_f32_16x16x32_bf16 v[180:183], v[28:31], v[12:15], v[180:183]
    buffer_load_dwordx4 v[28:31], v224, s[12:15], s21 offen offset:3072
    v_mfma_f32_16x16x32_bf16 v[124:127], v[32:35], v[0:3], v[124:127]
    v_mfma_f32_16x16x32_bf16 v[144:147], v[32:35], v[4:7], v[144:147]
    v_mfma_f32_16x16x32_bf16 v[164:167], v[32:35], v[8:11], v[164:167]
    v_mfma_f32_16x16x32_bf16 v[184:187], v[32:35], v[12:15], v[184:187]
    buffer_load_dwordx4 v[32:35], v225, s[12:15], s21 offen
    buffer_load_dwordx4 v[0:3], v226, s[12:15], s20 offen
    buffer_load_dwordx4 v[4:7], v227, s[12:15], s20 offen
    buffer_load_dwordx4 v[8:11], v228, s[12:15], s20 offen
    buffer_load_dwordx4 v[12:15], v229, s[12:15], s20 offen
    s_add_u32 s20, s20, 1024
    s_add_u32 s21, s21, 5120
    s_waitcnt vmcnt(18)
    v_mfma_f32_16x16x32_bf16 v[108:111], v[52:55], v[36:39], v[108:111]
    v_mfma_f32_16x16x32_bf16 v[128:131], v[52:55], v[40:43], v[128:131]
    v_mfma_f32_16x16x32_bf16 v[148:151], v[52:55], v[44:47], v[148:151]
    v_mfma_f32_16x16x32_bf16 v[168:171], v[52:55], v[48:51], v[168:171]
    buffer_load_dwordx4 v[52:55], v224, s[12:15], s21 offen offset:0
    v_mfma_f32_16x16x32_bf16 v[112:115], v[56:59], v[36:39], v[112:115]
    v_mfma_f32_16x16x32_bf16 v[132:135], v[56:59], v[40:43], v[132:135]
    v_mfma_f32_16x16x32_bf16 v[152:155], v[56:59], v[44:47], v[152:155]
    v_mfma_f32_16x16x32_bf16 v[172:175], v[56:59], v[48:51], v[172:175]
    buffer_load_dwordx4 v[56:59], v224, s[12:15], s21 offen offset:1024
    v_mfma_f32_16x16x32_bf16 v[116:119], v[60:63], v[36:39], v[116:119]
    v_mfma_f32_16x16x32_bf16 v[136:139], v[60:63], v[40:43], v[136:139]
    v_mfma_f32_16x16x32_bf16 v[156:159], v[60:63], v[44:47], v[156:159]
    v_mfma_f32_16x16x32_bf16 v[176:179], v[60:63], v[48:51], v[176:179]
    buffer_load_dwordx4 v[60:63], v224, s[12:15], s21 offen offset:2048
    v_mfma_f32_16x16x32_bf16 v[120:123], v[64:67], v[36:39], v[120:123]
    v_mfma_f32_16x16x32_bf16 v[140:143], v[64:67], v[40:43], v[140:143]
    v_mfma_f32_16x16x32_bf16 v[160:163], v[64:67], v[44:47], v[160:163]
    v_mfma_f32_16x16x32_bf16 v[180:183], v[64:67], v[48:51], v[180:183]
    buffer_load_dwordx4 v[64:67], v224, s[12:15], s21 offen offset:3072
    v_mfma_f32_16x16x32_bf16 v[124:127], v[68:71], v[36:39], v[124:127]
    v_mfma_f32_16x16x32_bf16 v[144:147], v[68:71], v[40:43], v[144:147]
    v_mfma_f32_16x16x32_bf16 v[164:167], v[68:71], v[44:47], v[164:167]
    v_mfma_f32_16x16x32_bf16 v[184:187], v[68:71], v[48:51], v[184:187]
    buffer_load_dwordx4 v[68:71], v225, s[12:15], s21 offen
    buffer_load_dwordx4 v[36:39], v226, s[12:15], s20 offen
    buffer_load_dwordx4 v[40:43], v227, s[12:15], s20 offen
    buffer_load_dwordx4 v[44:47], v228, s[12:15], s20 offen
    buffer_load_dwordx4 v[48:51], v229, s[12:15], s20 offen
    s_add_u32 s20, s20, 1024
    s_add_u32 s21, s21, 5120
    s_waitcnt vmcnt(18)
    v_mfma_f32_16x16x32_bf16 v[108:111], v[88:91], v[72:75], v[108:111]
    v_mfma_f32_16x16x32_bf16 v[128:131], v[88:91], v[76:79], v[128:131]
    v_mfma_f32_16x16x32_bf16 v[148:151], v[88:91], v[80:83], v[148:151]
    v_mfma_f32_16x16x32_bf16 v[168:171], v[88:91], v[84:87], v[168:171]
    buffer_load_dwordx4 v[88:91], v224, s[12:15], s21 offen offset:0
    v_mfma_f32_16x16x32_bf16 v[112:115], v[92:95], v[72:75], v[112:115]
    v_mfma_f32_16x16x32_bf16 v[132:135], v[92:95], v[76:79], v[132:135]
    v_mfma_f32_16x16x32_bf16 v[152:155], v[92:95], v[80:83], v[152:155]
    v_mfma_f32_16x16x32_bf16 v[172:175], v[92:95], v[84:87], v[172:175]
    buffer_load_dwordx4 v[92:95], v224, s[12:15], s21 offen offset:1024
    v_mfma_f32_16x16x32_bf16 v[116:119], v[96:99], v[72:75], v[116:119]
    v_mfma_f32_16x16x32_bf16 v[136:139], v[96:99], v[76:79], v[136:139]
    v_mfma_f32_16x16x32_bf16 v[156:159], v[96:99], v[80:83], v[156:159]
    v_mfma_f32_16x16x32_bf16 v[176:179], v[96:99], v[84:87], v[176:179]
    buffer_load_dwordx4 v[96:99], v224, s[12:15], s21 offen offset:2048
    v_mfma_f32_16x16x32_bf16 v[120:123], v[100:103], v[72:75], v[120:123]
    v_mfma_f32_16x16x32_bf16 v[140:143], v[100:103], v[76:79], v[140:143]
    v_mfma_f32_16x16x32_bf16 v[160:163], v[100:103], v[80:83], v[160:163]
    v_mfma_f32_16x16x32_bf16 v[180:183], v[100:103], v[84:87], v[180:183]
    buffer_load_dwordx4 v[100:103], v224, s[12:15], s21 offen offset:3072
    v_mfma_f32_16x16x32_bf16 v[124:127], v[104:107], v[72:75], v[124:127]
    v_mfma_f32_16x16x32_bf16 v[144:147], v[104:107], v[76:79], v[144:147]
    v_mfma_f32_16x16x32_bf16 v[164:167], v[104:107], v[80:83], v[164:167]
    v_mfma_f32_16x16x32_bf16 v[184:187], v[104:107], v[84:87], v[184:187]
    buffer_load_dwordx4 v[104:107], v225, s[12:15], s21 offen
    buffer_load_dwordx4 v[72:75], v226, s[12:15], s20 offen
    buffer_load_dwordx4 v[76:79], v227, s[12:15], s20 offen
    buffer_load_dwordx4 v[80:83], v228, s[12:15], s20 offen
    buffer_load_dwordx4 v[84:87], v229, s[12:15], s20 offen
    s_add_u32 s20, s20, 1024
    s_add_u32 s21, s21, 5120
    s_waitcnt vmcnt(18)
    v_mfma_f32_16x16x32_bf16 v[108:111], v[16:19], v[0:3], v[108:111]
    v_mfma_f32_16x16x32_bf16 v[128:131], v[16:19], v[4:7], v[128:131]
    v_mfma_f32_16x16x32_bf16 v[148:151], v[16:19], v[8:11], v[148:151]
    v_mfma_f32_16x16x32_bf16 v[168:171], v[16:19], v[12:15], v[168:171]
    buffer_load_dwordx4 v[16:19], v224, s[12:15], s21 offen offset:0
    v_mfma_f32_16x16x32_bf16 v[112:115], v[20:23], v[0:3], v[112:115]
    v_mfma_f32_16x16x32_bf16 v[132:135], v[20:23], v[4:7], v[132:135]
    v_mfma_f32_16x16x32_bf16 v[152:155], v[20:23], v[8:11], v[152:155]
    v_mfma_f32_16x16x32_bf16 v[172:175], v[20:23], v[12:15], v[172:175]
    buffer_load_dwordx4 v[20:23], v224, s[12:15], s21 offen offset:1024
    v_mfma_f32_16x16x32_bf16 v[116:119], v[24:27], v[0:3], v[116:119]
    v_mfma_f32_16x16x32_bf16 v[136:139], v[24:27], v[4:7], v[136:139]
    v_mfma_f32_16x16x32_bf16 v[156:159], v[24:27], v[8:11], v[156:159]
    v_mfma_f32_16x16x32_bf16 v[176:179], v[24:27], v[12:15], v[176:179]
    buffer_load_dwordx4 v[24:27], v224, s[12:15], s21 offen offset:2048
    v_mfma_f32_16x16x32_bf16 v[120:123], v[28:31], v[0:3], v[120:123]
    v_mfma_f32_16x16x32_bf16 v[140:143], v[28:31], v[4:7], v[140:143]
    v_mfma_f32_16x16x32_bf16 v[160:163], v[28:31], v[8:11], v[160:163]
    v_mfma_f32_16x16x32_bf16 v[180:183], v[28:31], v[12:15], v[180:183]
    buffer_load_dwordx4 v[28:31], v224, s[12:15], s21 offen offset:3072
    v_mfma_f32_16x16x32_bf16 v[124:127], v[32:35], v[0:3], v[124:127]
    v_mfma_f32_16x16x32_bf16 v[144:147], v[32:35], v[4:7], v[144:147]
    v_mfma_f32_16x16x32_bf16 v[164:167], v[32:35], v[8:11], v[164:167]
    v_mfma_f32_16x16x32_bf16 v[184:187], v[32:35], v[12:15], v[184:187]
    buffer_load_dwordx4 v[32:35], v225, s[12:15], s21 offen
    buffer_load_dwordx4 v[0:3], v226, s[12:15], s20 offen
    buffer_load_dwordx4 v[4:7], v227, s[12:15], s20 offen
    buffer_load_dwordx4 v[8:11], v228, s[12:15], s20 offen
    buffer_load_dwordx4 v[12:15], v229, s[12:15], s20 offen
    s_add_u32 s20, s20, 1024
    s_add_u32 s21, s21, 5120
    s_waitcnt vmcnt(18)
    v_mfma_f32_16x16x32_bf16 v[108:111], v[52:55], v[36:39], v[108:111]
    v_mfma_f32_16x16x32_bf16 v[128:131], v[52:55], v[40:43], v[128:131]
    v_mfma_f32_16x16x32_bf16 v[148:151], v[52:55], v[44:47], v[148:151]
    v_mfma_f32_16x16x32_bf16 v[168:171], v[52:55], v[48:51], v[168:171]
    buffer_load_dwordx4 v[52:55], v224, s[12:15], s21 offen offset:0
    v_mfma_f32_16x16x32_bf16 v[112:115], v[56:59], v[36:39], v[112:115]
    v_mfma_f32_16x16x32_bf16 v[132:135], v[56:59], v[40:43], v[132:135]
    v_mfma_f32_16x16x32_bf16 v[152:155], v[56:59], v[44:47], v[152:155]
    v_mfma_f32_16x16x32_bf16 v[172:175], v[56:59], v[48:51], v[172:175]
    buffer_load_dwordx4 v[56:59], v224, s[12:15], s21 offen offset:1024
    v_mfma_f32_16x16x32_bf16 v[116:119], v[60:63], v[36:39], v[116:119]
    v_mfma_f32_16x16x32_bf16 v[136:139], v[60:63], v[40:43], v[136:139]
    v_mfma_f32_16x16x32_bf16 v[156:159], v[60:63], v[44:47], v[156:159]
    v_mfma_f32_16x16x32_bf16 v[176:179], v[60:63], v[48:51], v[176:179]
    buffer_load_dwordx4 v[60:63], v224, s[12:15], s21 offen offset:2048
    v_mfma_f32_16x16x32_bf16 v[120:123], v[64:67], v[36:39], v[120:123]
    v_mfma_f32_16x16x32_bf16 v[140:143], v[64:67], v[40:43], v[140:143]
    v_mfma_f32_16x16x32_bf16 v[160:163], v[64:67], v[44:47], v[160:163]
    v_mfma_f32_16x16x32_bf16 v[180:183], v[64:67], v[48:51], v[180:183]
    buffer_load_dwordx4 v[64:67], v224, s[12:15], s21 offen offset:3072
    v_mfma_f32_16x16x32_bf16 v[124:127], v[68:71], v[36:39], v[124:127]
    v_mfma_f32_16x16x32_bf16 v[144:147], v[68:71], v[40:43], v[144:147]
    v_mfma_f32_16x16x32_bf16 v[164:167], v[68:71], v[44:47], v[164:167]
    v_mfma_f32_16x16x32_bf16 v[184:187], v[68:71], v[48:51], v[184:187]
    buffer_load_dwordx4 v[68:71], v225, s[12:15], s21 offen
    buffer_load_dwordx4 v[36:39], v226, s[12:15], s20 offen
    buffer_load_dwordx4 v[40:43], v227, s[12:15], s20 offen
    buffer_load_dwordx4 v[44:47], v228, s[12:15], s20 offen
    buffer_load_dwordx4 v[48:51], v229, s[12:15], s20 offen
    s_add_u32 s20, s20, 1024
    s_add_u32 s21, s21, 5120
    s_waitcnt vmcnt(18)
    v_mfma_f32_16x16x32_bf16 v[108:111], v[88:91], v[72:75], v[108:111]
    v_mfma_f32_16x16x32_bf16 v[128:131], v[88:91], v[76:79], v[128:131]
    v_mfma_f32_16x16x32_bf16 v[148:151], v[88:91], v[80:83], v[148:151]
    v_mfma_f32_16x16x32_bf16 v[168:171], v[88:91], v[84:87], v[168:171]
    buffer_load_dwordx4 v[88:91], v224, s[12:15], s21 offen offset:0
    v_mfma_f32_16x16x32_bf16 v[112:115], v[92:95], v[72:75], v[112:115]
    v_mfma_f32_16x16x32_bf16 v[132:135], v[92:95], v[76:79], v[132:135]
    v_mfma_f32_16x16x32_bf16 v[152:155], v[92:95], v[80:83], v[152:155]
    v_mfma_f32_16x16x32_bf16 v[172:175], v[92:95], v[84:87], v[172:175]
    buffer_load_dwordx4 v[92:95], v224, s[12:15], s21 offen offset:1024
    v_mfma_f32_16x16x32_bf16 v[116:119], v[96:99], v[72:75], v[116:119]
    v_mfma_f32_16x16x32_bf16 v[136:139], v[96:99], v[76:79], v[136:139]
    v_mfma_f32_16x16x32_bf16 v[156:159], v[96:99], v[80:83], v[156:159]
    v_mfma_f32_16x16x32_bf16 v[176:179], v[96:99], v[84:87], v[176:179]
    buffer_load_dwordx4 v[96:99], v224, s[12:15], s21 offen offset:2048
    v_mfma_f32_16x16x32_bf16 v[120:123], v[100:103], v[72:75], v[120:123]
    v_mfma_f32_16x16x32_bf16 v[140:143], v[100:103], v[76:79], v[140:143]
    v_mfma_f32_16x16x32_bf16 v[160:163], v[100:103], v[80:83], v[160:163]
    v_mfma_f32_16x16x32_bf16 v[180:183], v[100:103], v[84:87], v[180:183]
    buffer_load_dwordx4 v[100:103], v224, s[12:15], s21 offen offset:3072
    v_mfma_f32_16x16x32_bf16 v[124:127], v[104:107], v[72:75], v[124:127]
    v_mfma_f32_16x16x32_bf16 v[144:147], v[104:107], v[76:79], v[144:147]
    v_mfma_f32_16x16x32_bf16 v[164:167], v[104:107], v[80:83], v[164:167]
    v_mfma_f32_16x16x32_bf16 v[184:187], v[104:107], v[84:87], v[184:187]
    buffer_load_dwordx4 v[104:107], v225, s[12:15], s21 offen
    buffer_load_dwordx4 v[72:75], v226, s[12:15], s20 offen
    buffer_load_dwordx4 v[76:79], v227, s[12:15], s20 offen
    buffer_load_dwordx4 v[80:83], v228, s[12:15], s20 offen
    buffer_load_dwordx4 v[84:87], v229, s[12:15], s20 offen
    s_add_u32 s20, s20, 1024
    s_add_u32 s21, s21, 5120
    s_waitcnt vmcnt(18)
    v_mfma_f32_16x16x32_bf16 v[108:111], v[16:19], v[0:3], v[108:111]
    v_mfma_f32_16x16x32_bf16 v[128:131], v[16:19], v[4:7], v[128:131]
    v_mfma_f32_16x16x32_bf16 v[148:151], v[16:19], v[8:11], v[148:151]
    v_mfma_f32_16x16x32_bf16 v[168:171], v[16:19], v[12:15], v[168:171]
    buffer_load_dwordx4 v[16:19], v224, s[12:15], s21 offen offset:0
    v_mfma_f32_16x16x32_bf16 v[112:115], v[20:23], v[0:3], v[112:115]
    v_mfma_f32_16x16x32_bf16 v[132:135], v[20:23], v[4:7], v[132:135]
    v_mfma_f32_16x16x32_bf16 v[152:155], v[20:23], v[8:11], v[152:155]
    v_mfma_f32_16x16x32_bf16 v[172:175], v[20:23], v[12:15], v[172:175]
    buffer_load_dwordx4 v[20:23], v224, s[12:15], s21 offen offset:1024
    v_mfma_f32_16x16x32_bf16 v[116:119], v[24:27], v[0:3], v[116:119]
    v_mfma_f32_16x16x32_bf16 v[136:139], v[24:27], v[4:7], v[136:139]
    v_mfma_f32_16x16x32_bf16 v[156:159], v[24:27], v[8:11], v[156:159]
    v_mfma_f32_16x16x32_bf16 v[176:179], v[24:27], v[12:15], v[176:179]
    buffer_load_dwordx4 v[24:27], v224, s[12:15], s21 offen offset:2048
    v_mfma_f32_16x16x32_bf16 v[120:123], v[28:31], v[0:3], v[120:123]
    v_mfma_f32_16x16x32_bf16 v[140:143], v[28:31], v[4:7], v[140:143]
    v_mfma_f32_16x16x32_bf16 v[160:163], v[28:31], v[8:11], v[160:163]
    v_mfma_f32_16x16x32_bf16 v[180:183], v[28:31], v[12:15], v[180:183]
    buffer_load_dwordx4 v[28:31], v224, s[12:15], s21 offen offset:3072
    v_mfma_f32_16x16x32_bf16 v[124:127], v[32:35], v[0:3], v[124:127]
    v_mfma_f32_16x16x32_bf16 v[144:147], v[32:35], v[4:7], v[144:147]
    v_mfma_f32_16x16x32_bf16 v[164:167], v[32:35], v[8:11], v[164:167]
    v_mfma_f32_16x16x32_bf16 v[184:187], v[32:35], v[12:15], v[184:187]
    buffer_load_dwordx4 v[32:35], v225, s[12:15], s21 offen
    buffer_load_dwordx4 v[0:3], v226, s[12:15], s20 offen
    buffer_load_dwordx4 v[4:7], v227, s[12:15], s20 offen
    buffer_load_dwordx4 v[8:11], v228, s[12:15], s20 offen
    buffer_load_dwordx4 v[12:15], v229, s[12:15], s20 offen
    s_add_u32 s20, s20, 1024
    s_add_u32 s21, s21, 5120
    s_waitcnt vmcnt(18)
    v_mfma_f32_16x16x32_bf16 v[108:111], v[52:55], v[36:39], v[108:111]
    v_mfma_f32_16x16x32_bf16 v[128:131], v[52:55], v[40:43], v[128:131]
    v_mfma_f32_16x16x32_bf16 v[148:151], v[52:55], v[44:47], v[148:151]
    v_mfma_f32_16x16x32_bf16 v[168:171], v[52:55], v[48:51], v[168:171]
    buffer_load_dwordx4 v[52:55], v224, s[12:15], s21 offen offset:0
    v_mfma_f32_16x16x32_bf16 v[112:115], v[56:59], v[36:39], v[112:115]
    v_mfma_f32_16x16x32_bf16 v[132:135], v[56:59], v[40:43], v[132:135]
    v_mfma_f32_16x16x32_bf16 v[152:155], v[56:59], v[44:47], v[152:155]
    v_mfma_f32_16x16x32_bf16 v[172:175], v[56:59], v[48:51], v[172:175]
    buffer_load_dwordx4 v[56:59], v224, s[12:15], s21 offen offset:1024
    v_mfma_f32_16x16x32_bf16 v[116:119], v[60:63], v[36:39], v[116:119]
    v_mfma_f32_16x16x32_bf16 v[136:139], v[60:63], v[40:43], v[136:139]
    v_mfma_f32_16x16x32_bf16 v[156:159], v[60:63], v[44:47], v[156:159]
    v_mfma_f32_16x16x32_bf16 v[176:179], v[60:63], v[48:51], v[176:179]
    buffer_load_dwordx4 v[60:63], v224, s[12:15], s21 offen offset:2048
    v_mfma_f32_16x16x32_bf16 v[120:123], v[64:67], v[36:39], v[120:123]
    v_mfma_f32_16x16x32_bf16 v[140:143], v[64:67], v[40:43], v[140:143]
    v_mfma_f32_16x16x32_bf16 v[160:163], v[64:67], v[44:47], v[160:163]
    v_mfma_f32_16x16x32_bf16 v[180:183], v[64:67], v[48:51], v[180:183]
    buffer_load_dwordx4 v[64:67], v224, s[12:15], s21 offen offset:3072
    v_mfma_f32_16x16x32_bf16 v[124:127], v[68:71], v[36:39], v[124:127]
    v_mfma_f32_16x16x32_bf16 v[144:147], v[68:71], v[40:43], v[144:147]
    v_mfma_f32_16x16x32_bf16 v[164:167], v[68:71], v[44:47], v[164:167]
    v_mfma_f32_16x16x32_bf16 v[184:187], v[68:71], v[48:51], v[184:187]
    buffer_load_dwordx4 v[68:71], v225, s[12:15], s21 offen
    buffer_load_dwordx4 v[36:39], v226, s[12:15], s20 offen
    buffer_load_dwordx4 v[40:43], v227, s[12:15], s20 offen
    buffer_load_dwordx4 v[44:47], v228, s[12:15], s20 offen
    buffer_load_dwordx4 v[48:51], v229, s[12:15], s20 offen
    s_add_u32 s20, s20, 1024
    s_add_u32 s21, s21, 5120
    s_waitcnt vmcnt(18)
    v_mfma_f32_16x16x32_bf16 v[108:111], v[88:91], v[72:75], v[108:111]
    v_mfma_f32_16x16x32_bf16 v[128:131], v[88:91], v[76:79], v[128:131]
    v_mfma_f32_16x16x32_bf16 v[148:151], v[88:91], v[80:83], v[148:151]
    v_mfma_f32_16x16x32_bf16 v[168:171], v[88:91], v[84:87], v[168:171]
    buffer_load_dwordx4 v[88:91], v224, s[12:15], s21 offen offset:0
    v_mfma_f32_16x16x32_bf16 v[112:115], v[92:95], v[72:75], v[112:115]
    v_mfma_f32_16x16x32_bf16 v[132:135], v[92:95], v[76:79], v[132:135]
    v_mfma_f32_16x16x32_bf16 v[152:155], v[92:95], v[80:83], v[152:155]
    v_mfma_f32_16x16x32_bf16 v[172:175], v[92:95], v[84:87], v[172:175]
    buffer_load_dwordx4 v[92:95], v224, s[12:15], s21 offen offset:1024
    v_mfma_f32_16x16x32_bf16 v[116:119], v[96:99], v[72:75], v[116:119]
    v_mfma_f32_16x16x32_bf16 v[136:139], v[96:99], v[76:79], v[136:139]
    v_mfma_f32_16x16x32_bf16 v[156:159], v[96:99], v[80:83], v[156:159]
    v_mfma_f32_16x16x32_bf16 v[176:179], v[96:99], v[84:87], v[176:179]
    buffer_load_dwordx4 v[96:99], v224, s[12:15], s21 offen offset:2048
    v_mfma_f32_16x16x32_bf16 v[120:123], v[100:103], v[72:75], v[120:123]
    v_mfma_f32_16x16x32_bf16 v[140:143], v[100:103], v[76:79], v[140:143]
    v_mfma_f32_16x16x32_bf16 v[160:163], v[100:103], v[80:83], v[160:163]
    v_mfma_f32_16x16x32_bf16 v[180:183], v[100:103], v[84:87], v[180:183]
    buffer_load_dwordx4 v[100:103], v224, s[12:15], s21 offen offset:3072
    v_mfma_f32_16x16x32_bf16 v[124:127], v[104:107], v[72:75], v[124:127]
    v_mfma_f32_16x16x32_bf16 v[144:147], v[104:107], v[76:79], v[144:147]
    v_mfma_f32_16x16x32_bf16 v[164:167], v[104:107], v[80:83], v[164:167]
    v_mfma_f32_16x16x32_bf16 v[184:187], v[104:107], v[84:87], v[184:187]
    buffer_load_dwordx4 v[104:107], v225, s[12:15], s21 offen
    buffer_load_dwordx4 v[72:75], v226, s[12:15], s20 offen
    buffer_load_dwordx4 v[76:79], v227, s[12:15], s20 offen
    buffer_load_dwordx4 v[80:83], v228, s[12:15], s20 offen
    buffer_load_dwordx4 v[84:87], v229, s[12:15], s20 offen
    s_add_u32 s20, s20, 1024
    s_add_u32 s21, s21, 5120
    s_waitcnt vmcnt(18)
    v_mfma_f32_16x16x32_bf16 v[108:111], v[16:19], v[0:3], v[108:111]
    v_mfma_f32_16x16x32_bf16 v[128:131], v[16:19], v[4:7], v[128:131]
    v_mfma_f32_16x16x32_bf16 v[148:151], v[16:19], v[8:11], v[148:151]
    v_mfma_f32_16x16x32_bf16 v[168:171], v[16:19], v[12:15], v[168:171]
    buffer_load_dwordx4 v[16:19], v224, s[12:15], s21 offen offset:0
    v_mfma_f32_16x16x32_bf16 v[112:115], v[20:23], v[0:3], v[112:115]
    v_mfma_f32_16x16x32_bf16 v[132:135], v[20:23], v[4:7], v[132:135]
    v_mfma_f32_16x16x32_bf16 v[152:155], v[20:23], v[8:11], v[152:155]
    v_mfma_f32_16x16x32_bf16 v[172:175], v[20:23], v[12:15], v[172:175]
    buffer_load_dwordx4 v[20:23], v224, s[12:15], s21 offen offset:1024
    v_mfma_f32_16x16x32_bf16 v[116:119], v[24:27], v[0:3], v[116:119]
    v_mfma_f32_16x16x32_bf16 v[136:139], v[24:27], v[4:7], v[136:139]
    v_mfma_f32_16x16x32_bf16 v[156:159], v[24:27], v[8:11], v[156:159]
    v_mfma_f32_16x16x32_bf16 v[176:179], v[24:27], v[12:15], v[176:179]
    buffer_load_dwordx4 v[24:27], v224, s[12:15], s21 offen offset:2048
    v_mfma_f32_16x16x32_bf16 v[120:123], v[28:31], v[0:3], v[120:123]
    v_mfma_f32_16x16x32_bf16 v[140:143], v[28:31], v[4:7], v[140:143]
    v_mfma_f32_16x16x32_bf16 v[160:163], v[28:31], v[8:11], v[160:163]
    v_mfma_f32_16x16x32_bf16 v[180:183], v[28:31], v[12:15], v[180:183]
    buffer_load_dwordx4 v[28:31], v224, s[12:15], s21 offen offset:3072
    v_mfma_f32_16x16x32_bf16 v[124:127], v[32:35], v[0:3], v[124:127]
    v_mfma_f32_16x16x32_bf16 v[144:147], v[32:35], v[4:7], v[144:147]
    v_mfma_f32_16x16x32_bf16 v[164:167], v[32:35], v[8:11], v[164:167]
    v_mfma_f32_16x16x32_bf16 v[184:187], v[32:35], v[12:15], v[184:187]
    buffer_load_dwordx4 v[32:35], v225, s[12:15], s21 offen
    buffer_load_dwordx4 v[0:3], v226, s[12:15], s20 offen
    buffer_load_dwordx4 v[4:7], v227, s[12:15], s20 offen
    buffer_load_dwordx4 v[8:11], v228, s[12:15], s20 offen
    buffer_load_dwordx4 v[12:15], v229, s[12:15], s20 offen
    s_add_u32 s20, s20, 1024
    s_add_u32 s21, s21, 5120
    s_waitcnt vmcnt(18)
    v_mfma_f32_16x16x32_bf16 v[108:111], v[52:55], v[36:39], v[108:111]
    v_mfma_f32_16x16x32_bf16 v[128:131], v[52:55], v[40:43], v[128:131]
    v_mfma_f32_16x16x32_bf16 v[148:151], v[52:55], v[44:47], v[148:151]
    v_mfma_f32_16x16x32_bf16 v[168:171], v[52:55], v[48:51], v[168:171]
    buffer_load_dwordx4 v[52:55], v224, s[12:15], s21 offen offset:0
    v_mfma_f32_16x16x32_bf16 v[112:115], v[56:59], v[36:39], v[112:115]
    v_mfma_f32_16x16x32_bf16 v[132:135], v[56:59], v[40:43], v[132:135]
    v_mfma_f32_16x16x32_bf16 v[152:155], v[56:59], v[44:47], v[152:155]
    v_mfma_f32_16x16x32_bf16 v[172:175], v[56:59], v[48:51], v[172:175]
    buffer_load_dwordx4 v[56:59], v224, s[12:15], s21 offen offset:1024
    v_mfma_f32_16x16x32_bf16 v[116:119], v[60:63], v[36:39], v[116:119]
    v_mfma_f32_16x16x32_bf16 v[136:139], v[60:63], v[40:43], v[136:139]
    v_mfma_f32_16x16x32_bf16 v[156:159], v[60:63], v[44:47], v[156:159]
    v_mfma_f32_16x16x32_bf16 v[176:179], v[60:63], v[48:51], v[176:179]
    buffer_load_dwordx4 v[60:63], v224, s[12:15], s21 offen offset:2048
    v_mfma_f32_16x16x32_bf16 v[120:123], v[64:67], v[36:39], v[120:123]
    v_mfma_f32_16x16x32_bf16 v[140:143], v[64:67], v[40:43], v[140:143]
    v_mfma_f32_16x16x32_bf16 v[160:163], v[64:67], v[44:47], v[160:163]
    v_mfma_f32_16x16x32_bf16 v[180:183], v[64:67], v[48:51], v[180:183]
    buffer_load_dwordx4 v[64:67], v224, s[12:15], s21 offen offset:3072
    v_mfma_f32_16x16x32_bf16 v[124:127], v[68:71], v[36:39], v[124:127]
    v_mfma_f32_16x16x32_bf16 v[144:147], v[68:71], v[40:43], v[144:147]
    v_mfma_f32_16x16x32_bf16 v[164:167], v[68:71], v[44:47], v[164:167]
    v_mfma_f32_16x16x32_bf16 v[184:187], v[68:71], v[48:51], v[184:187]
    buffer_load_dwordx4 v[68:71], v225, s[12:15], s21 offen
    buffer_load_dwordx4 v[36:39], v226, s[12:15], s20 offen
    buffer_load_dwordx4 v[40:43], v227, s[12:15], s20 offen
    buffer_load_dwordx4 v[44:47], v228, s[12:15], s20 offen
    buffer_load_dwordx4 v[48:51], v229, s[12:15], s20 offen
    s_add_u32 s20, s20, 1024
    s_add_u32 s21, s21, 5120
    s_waitcnt vmcnt(18)
    v_mfma_f32_16x16x32_bf16 v[108:111], v[88:91], v[72:75], v[108:111]
    v_mfma_f32_16x16x32_bf16 v[128:131], v[88:91], v[76:79], v[128:131]
    v_mfma_f32_16x16x32_bf16 v[148:151], v[88:91], v[80:83], v[148:151]
    v_mfma_f32_16x16x32_bf16 v[168:171], v[88:91], v[84:87], v[168:171]
    buffer_load_dwordx4 v[88:91], v224, s[12:15], s21 offen offset:0
    v_mfma_f32_16x16x32_bf16 v[112:115], v[92:95], v[72:75], v[112:115]
    v_mfma_f32_16x16x32_bf16 v[132:135], v[92:95], v[76:79], v[132:135]
    v_mfma_f32_16x16x32_bf16 v[152:155], v[92:95], v[80:83], v[152:155]
    v_mfma_f32_16x16x32_bf16 v[172:175], v[92:95], v[84:87], v[172:175]
    buffer_load_dwordx4 v[92:95], v224, s[12:15], s21 offen offset:1024
    v_mfma_f32_16x16x32_bf16 v[116:119], v[96:99], v[72:75], v[116:119]
    v_mfma_f32_16x16x32_bf16 v[136:139], v[96:99], v[76:79], v[136:139]
    v_mfma_f32_16x16x32_bf16 v[156:159], v[96:99], v[80:83], v[156:159]
    v_mfma_f32_16x16x32_bf16 v[176:179], v[96:99], v[84:87], v[176:179]
    buffer_load_dwordx4 v[96:99], v224, s[12:15], s21 offen offset:2048
    v_mfma_f32_16x16x32_bf16 v[120:123], v[100:103], v[72:75], v[120:123]
    v_mfma_f32_16x16x32_bf16 v[140:143], v[100:103], v[76:79], v[140:143]
    v_mfma_f32_16x16x32_bf16 v[160:163], v[100:103], v[80:83], v[160:163]
    v_mfma_f32_16x16x32_bf16 v[180:183], v[100:103], v[84:87], v[180:183]
    buffer_load_dwordx4 v[100:103], v224, s[12:15], s21 offen offset:3072
    v_mfma_f32_16x16x32_bf16 v[124:127], v[104:107], v[72:75], v[124:127]
    v_mfma_f32_16x16x32_bf16 v[144:147], v[104:107], v[76:79], v[144:147]
    v_mfma_f32_16x16x32_bf16 v[164:167], v[104:107], v[80:83], v[164:167]
    v_mfma_f32_16x16x32_bf16 v[184:187], v[104:107], v[84:87], v[184:187]
    buffer_load_dwordx4 v[104:107], v225, s[12:15], s21 offen
    buffer_load_dwordx4 v[72:75], v226, s[12:15], s20 offen
    buffer_load_dwordx4 v[76:79], v227, s[12:15], s20 offen
    buffer_load_dwordx4 v[80:83], v228, s[12:15], s20 offen
    buffer_load_dwordx4 v[84:87], v229, s[12:15], s20 offen
    s_add_u32 s20, s20, 1024
    s_add_u32 s21, s21, 5120
    s_waitcnt vmcnt(18)
    v_mfma_f32_16x16x32_bf16 v[108:111], v[16:19], v[0:3], v[108:111]
    v_mfma_f32_16x16x32_bf16 v[128:131], v[16:19], v[4:7], v[128:131]
    v_mfma_f32_16x16x32_bf16 v[148:151], v[16:19], v[8:11], v[148:151]
    v_mfma_f32_16x16x32_bf16 v[168:171], v[16:19], v[12:15], v[168:171]
    buffer_load_dwordx4 v[16:19], v224, s[12:15], s21 offen offset:0
    v_mfma_f32_16x16x32_bf16 v[112:115], v[20:23], v[0:3], v[112:115]
    v_mfma_f32_16x16x32_bf16 v[132:135], v[20:23], v[4:7], v[132:135]
    v_mfma_f32_16x16x32_bf16 v[152:155], v[20:23], v[8:11], v[152:155]
    v_mfma_f32_16x16x32_bf16 v[172:175], v[20:23], v[12:15], v[172:175]
    buffer_load_dwordx4 v[20:23], v224, s[12:15], s21 offen offset:1024
    v_mfma_f32_16x16x32_bf16 v[116:119], v[24:27], v[0:3], v[116:119]
    v_mfma_f32_16x16x32_bf16 v[136:139], v[24:27], v[4:7], v[136:139]
    v_mfma_f32_16x16x32_bf16 v[156:159], v[24:27], v[8:11], v[156:159]
    v_mfma_f32_16x16x32_bf16 v[176:179], v[24:27], v[12:15], v[176:179]
    buffer_load_dwordx4 v[24:27], v224, s[12:15], s21 offen offset:2048
    v_mfma_f32_16x16x32_bf16 v[120:123], v[28:31], v[0:3], v[120:123]
    v_mfma_f32_16x16x32_bf16 v[140:143], v[28:31], v[4:7], v[140:143]
    v_mfma_f32_16x16x32_bf16 v[160:163], v[28:31], v[8:11], v[160:163]
    v_mfma_f32_16x16x32_bf16 v[180:183], v[28:31], v[12:15], v[180:183]
    buffer_load_dwordx4 v[28:31], v224, s[12:15], s21 offen offset:3072
    v_mfma_f32_16x16x32_bf16 v[124:127], v[32:35], v[0:3], v[124:127]
    v_mfma_f32_16x16x32_bf16 v[144:147], v[32:35], v[4:7], v[144:147]
    v_mfma_f32_16x16x32_bf16 v[164:167], v[32:35], v[8:11], v[164:167]
    v_mfma_f32_16x16x32_bf16 v[184:187], v[32:35], v[12:15], v[184:187]
    buffer_load_dwordx4 v[32:35], v225, s[12:15], s21 offen
    buffer_load_dwordx4 v[0:3], v226, s[12:15], s20 offen
    buffer_load_dwordx4 v[4:7], v227, s[12:15], s20 offen
    buffer_load_dwordx4 v[8:11], v228, s[12:15], s20 offen
    buffer_load_dwordx4 v[12:15], v229, s[12:15], s20 offen
    s_add_u32 s20, s20, 1024
    s_add_u32 s21, s21, 5120
    s_waitcnt vmcnt(18)
    v_mfma_f32_16x16x32_bf16 v[108:111], v[52:55], v[36:39], v[108:111]
    v_mfma_f32_16x16x32_bf16 v[128:131], v[52:55], v[40:43], v[128:131]
    v_mfma_f32_16x16x32_bf16 v[148:151], v[52:55], v[44:47], v[148:151]
    v_mfma_f32_16x16x32_bf16 v[168:171], v[52:55], v[48:51], v[168:171]
    buffer_load_dwordx4 v[52:55], v224, s[12:15], s21 offen offset:0
    v_mfma_f32_16x16x32_bf16 v[112:115], v[56:59], v[36:39], v[112:115]
    v_mfma_f32_16x16x32_bf16 v[132:135], v[56:59], v[40:43], v[132:135]
    v_mfma_f32_16x16x32_bf16 v[152:155], v[56:59], v[44:47], v[152:155]
    v_mfma_f32_16x16x32_bf16 v[172:175], v[56:59], v[48:51], v[172:175]
    buffer_load_dwordx4 v[56:59], v224, s[12:15], s21 offen offset:1024
    v_mfma_f32_16x16x32_bf16 v[116:119], v[60:63], v[36:39], v[116:119]
    v_mfma_f32_16x16x32_bf16 v[136:139], v[60:63], v[40:43], v[136:139]
    v_mfma_f32_16x16x32_bf16 v[156:159], v[60:63], v[44:47], v[156:159]
    v_mfma_f32_16x16x32_bf16 v[176:179], v[60:63], v[48:51], v[176:179]
    buffer_load_dwordx4 v[60:63], v224, s[12:15], s21 offen offset:2048
    v_mfma_f32_16x16x32_bf16 v[120:123], v[64:67], v[36:39], v[120:123]
    v_mfma_f32_16x16x32_bf16 v[140:143], v[64:67], v[40:43], v[140:143]
    v_mfma_f32_16x16x32_bf16 v[160:163], v[64:67], v[44:47], v[160:163]
    v_mfma_f32_16x16x32_bf16 v[180:183], v[64:67], v[48:51], v[180:183]
    buffer_load_dwordx4 v[64:67], v224, s[12:15], s21 offen offset:3072
    v_mfma_f32_16x16x32_bf16 v[124:127], v[68:71], v[36:39], v[124:127]
    v_mfma_f32_16x16x32_bf16 v[144:147], v[68:71], v[40:43], v[144:147]
    v_mfma_f32_16x16x32_bf16 v[164:167], v[68:71], v[44:47], v[164:167]
    v_mfma_f32_16x16x32_bf16 v[184:187], v[68:71], v[48:51], v[184:187]
    buffer_load_dwordx4 v[68:71], v225, s[12:15], s21 offen
    buffer_load_dwordx4 v[36:39], v226, s[12:15], s20 offen
    buffer_load_dwordx4 v[40:43], v227, s[12:15], s20 offen
    buffer_load_dwordx4 v[44:47], v228, s[12:15], s20 offen
    buffer_load_dwordx4 v[48:51], v229, s[12:15], s20 offen
    s_add_u32 s20, s20, 1024
    s_add_u32 s21, s21, 5120
    s_waitcnt vmcnt(18)
    v_mfma_f32_16x16x32_bf16 v[108:111], v[88:91], v[72:75], v[108:111]
    v_mfma_f32_16x16x32_bf16 v[128:131], v[88:91], v[76:79], v[128:131]
    v_mfma_f32_16x16x32_bf16 v[148:151], v[88:91], v[80:83], v[148:151]
    v_mfma_f32_16x16x32_bf16 v[168:171], v[88:91], v[84:87], v[168:171]
    buffer_load_dwordx4 v[88:91], v224, s[12:15], s21 offen offset:0
    v_mfma_f32_16x16x32_bf16 v[112:115], v[92:95], v[72:75], v[112:115]
    v_mfma_f32_16x16x32_bf16 v[132:135], v[92:95], v[76:79], v[132:135]
    v_mfma_f32_16x16x32_bf16 v[152:155], v[92:95], v[80:83], v[152:155]
    v_mfma_f32_16x16x32_bf16 v[172:175], v[92:95], v[84:87], v[172:175]
    buffer_load_dwordx4 v[92:95], v224, s[12:15], s21 offen offset:1024
    v_mfma_f32_16x16x32_bf16 v[116:119], v[96:99], v[72:75], v[116:119]
    v_mfma_f32_16x16x32_bf16 v[136:139], v[96:99], v[76:79], v[136:139]
    v_mfma_f32_16x16x32_bf16 v[156:159], v[96:99], v[80:83], v[156:159]
    v_mfma_f32_16x16x32_bf16 v[176:179], v[96:99], v[84:87], v[176:179]
    buffer_load_dwordx4 v[96:99], v224, s[12:15], s21 offen offset:2048
    v_mfma_f32_16x16x32_bf16 v[120:123], v[100:103], v[72:75], v[120:123]
    v_mfma_f32_16x16x32_bf16 v[140:143], v[100:103], v[76:79], v[140:143]
    v_mfma_f32_16x16x32_bf16 v[160:163], v[100:103], v[80:83], v[160:163]
    v_mfma_f32_16x16x32_bf16 v[180:183], v[100:103], v[84:87], v[180:183]
    buffer_load_dwordx4 v[100:103], v224, s[12:15], s21 offen offset:3072
    v_mfma_f32_16x16x32_bf16 v[124:127], v[104:107], v[72:75], v[124:127]
    v_mfma_f32_16x16x32_bf16 v[144:147], v[104:107], v[76:79], v[144:147]
    v_mfma_f32_16x16x32_bf16 v[164:167], v[104:107], v[80:83], v[164:167]
    v_mfma_f32_16x16x32_bf16 v[184:187], v[104:107], v[84:87], v[184:187]
    buffer_load_dwordx4 v[104:107], v225, s[12:15], s21 offen
    buffer_load_dwordx4 v[72:75], v226, s[12:15], s20 offen
    buffer_load_dwordx4 v[76:79], v227, s[12:15], s20 offen
    buffer_load_dwordx4 v[80:83], v228, s[12:15], s20 offen
    buffer_load_dwordx4 v[84:87], v229, s[12:15], s20 offen
    s_add_u32 s20, s20, 1024
    s_add_u32 s21, s21, 5120
    s_waitcnt vmcnt(18)
    v_mfma_f32_16x16x32_bf16 v[108:111], v[16:19], v[0:3], v[108:111]
    v_mfma_f32_16x16x32_bf16 v[128:131], v[16:19], v[4:7], v[128:131]
    v_mfma_f32_16x16x32_bf16 v[148:151], v[16:19], v[8:11], v[148:151]
    v_mfma_f32_16x16x32_bf16 v[168:171], v[16:19], v[12:15], v[168:171]
    buffer_load_dwordx4 v[16:19], v224, s[12:15], s21 offen offset:0
    v_mfma_f32_16x16x32_bf16 v[112:115], v[20:23], v[0:3], v[112:115]
    v_mfma_f32_16x16x32_bf16 v[132:135], v[20:23], v[4:7], v[132:135]
    v_mfma_f32_16x16x32_bf16 v[152:155], v[20:23], v[8:11], v[152:155]
    v_mfma_f32_16x16x32_bf16 v[172:175], v[20:23], v[12:15], v[172:175]
    buffer_load_dwordx4 v[20:23], v224, s[12:15], s21 offen offset:1024
    v_mfma_f32_16x16x32_bf16 v[116:119], v[24:27], v[0:3], v[116:119]
    v_mfma_f32_16x16x32_bf16 v[136:139], v[24:27], v[4:7], v[136:139]
    v_mfma_f32_16x16x32_bf16 v[156:159], v[24:27], v[8:11], v[156:159]
    v_mfma_f32_16x16x32_bf16 v[176:179], v[24:27], v[12:15], v[176:179]
    buffer_load_dwordx4 v[24:27], v224, s[12:15], s21 offen offset:2048
    v_mfma_f32_16x16x32_bf16 v[120:123], v[28:31], v[0:3], v[120:123]
    v_mfma_f32_16x16x32_bf16 v[140:143], v[28:31], v[4:7], v[140:143]
    v_mfma_f32_16x16x32_bf16 v[160:163], v[28:31], v[8:11], v[160:163]
    v_mfma_f32_16x16x32_bf16 v[180:183], v[28:31], v[12:15], v[180:183]
    buffer_load_dwordx4 v[28:31], v224, s[12:15], s21 offen offset:3072
    v_mfma_f32_16x16x32_bf16 v[124:127], v[32:35], v[0:3], v[124:127]
    v_mfma_f32_16x16x32_bf16 v[144:147], v[32:35], v[4:7], v[144:147]
    v_mfma_f32_16x16x32_bf16 v[164:167], v[32:35], v[8:11], v[164:167]
    v_mfma_f32_16x16x32_bf16 v[184:187], v[32:35], v[12:15], v[184:187]
    buffer_load_dwordx4 v[32:35], v225, s[12:15], s21 offen
    buffer_load_dwordx4 v[0:3], v226, s[12:15], s20 offen
    buffer_load_dwordx4 v[4:7], v227, s[12:15], s20 offen
    buffer_load_dwordx4 v[8:11], v228, s[12:15], s20 offen
    buffer_load_dwordx4 v[12:15], v229, s[12:15], s20 offen
    s_add_u32 s20, s20, 1024
    s_add_u32 s21, s21, 5120
    s_waitcnt vmcnt(18)
    v_swap_b32 v38, v44
    v_swap_b32 v39, v45
    v_swap_b32 v42, v48
    v_swap_b32 v43, v49
    v_mfma_f32_16x16x32_bf16 v[108:111], v[52:55], v[36:39], v[108:111]
    v_mfma_f32_16x16x32_bf16 v[128:131], v[52:55], v[44:47], v[128:131]
    v_mfma_f32_16x16x32_bf16 v[148:151], v[52:55], v[40:43], v[148:151]
    v_mfma_f32_16x16x32_bf16 v[168:171], v[52:55], v[48:51], v[168:171]
    buffer_load_dwordx4 v[52:55], v224, s[12:15], s21 offen offset:0
    v_mfma_f32_16x16x32_bf16 v[112:115], v[56:59], v[36:39], v[112:115]
    v_mfma_f32_16x16x32_bf16 v[132:135], v[56:59], v[44:47], v[132:135]
    v_mfma_f32_16x16x32_bf16 v[152:155], v[56:59], v[40:43], v[152:155]
    v_mfma_f32_16x16x32_bf16 v[172:175], v[56:59], v[48:51], v[172:175]
    buffer_load_dwordx4 v[56:59], v224, s[12:15], s21 offen offset:1024
    v_mfma_f32_16x16x32_bf16 v[116:119], v[60:63], v[36:39], v[116:119]
    v_mfma_f32_16x16x32_bf16 v[136:139], v[60:63], v[44:47], v[136:139]
    v_mfma_f32_16x16x32_bf16 v[156:159], v[60:63], v[40:43], v[156:159]
    v_mfma_f32_16x16x32_bf16 v[176:179], v[60:63], v[48:51], v[176:179]
    buffer_load_dwordx4 v[60:63], v224, s[12:15], s21 offen offset:2048
    v_mfma_f32_16x16x32_bf16 v[120:123], v[64:67], v[36:39], v[120:123]
    v_mfma_f32_16x16x32_bf16 v[140:143], v[64:67], v[44:47], v[140:143]
    v_mfma_f32_16x16x32_bf16 v[160:163], v[64:67], v[40:43], v[160:163]
    v_mfma_f32_16x16x32_bf16 v[180:183], v[64:67], v[48:51], v[180:183]
    buffer_load_dwordx4 v[64:67], v224, s[12:15], s21 offen offset:3072
    v_mfma_f32_16x16x32_bf16 v[124:127], v[68:71], v[36:39], v[124:127]
    v_mfma_f32_16x16x32_bf16 v[144:147], v[68:71], v[44:47], v[144:147]
    v_mfma_f32_16x16x32_bf16 v[164:167], v[68:71], v[40:43], v[164:167]
    v_mfma_f32_16x16x32_bf16 v[184:187], v[68:71], v[48:51], v[184:187]
    buffer_load_dwordx4 v[68:71], v225, s[12:15], s21 offen
    buffer_load_dwordx4 v[36:39], v226, s[12:15], s20 offen
    buffer_load_dwordx4 v[40:43], v227, s[12:15], s20 offen
    buffer_load_dwordx4 v[44:47], v228, s[12:15], s20 offen
    buffer_load_dwordx4 v[48:51], v229, s[12:15], s20 offen
    s_add_u32 s20, s20, 1024
    s_add_u32 s21, s21, 5120
    s_waitcnt vmcnt(18)
    v_swap_b32 v74, v80
    v_swap_b32 v75, v81
    v_swap_b32 v78, v84
    v_swap_b32 v79, v85
    v_mfma_f32_16x16x32_bf16 v[108:111], v[88:91], v[72:75], v[108:111]
    v_mfma_f32_16x16x32_bf16 v[128:131], v[88:91], v[80:83], v[128:131]
    v_mfma_f32_16x16x32_bf16 v[148:151], v[88:91], v[76:79], v[148:151]
    v_mfma_f32_16x16x32_bf16 v[168:171], v[88:91], v[84:87], v[168:171]
    v_mfma_f32_16x16x32_bf16 v[112:115], v[92:95], v[72:75], v[112:115]
    v_mfma_f32_16x16x32_bf16 v[132:135], v[92:95], v[80:83], v[132:135]
    v_mfma_f32_16x16x32_bf16 v[152:155], v[92:95], v[76:79], v[152:155]
    v_mfma_f32_16x16x32_bf16 v[172:175], v[92:95], v[84:87], v[172:175]
    v_mfma_f32_16x16x32_bf16 v[116:119], v[96:99], v[72:75], v[116:119]
    v_mfma_f32_16x16x32_bf16 v[136:139], v[96:99], v[80:83], v[136:139]
    v_mfma_f32_16x16x32_bf16 v[156:159], v[96:99], v[76:79], v[156:159]
    v_mfma_f32_16x16x32_bf16 v[176:179], v[96:99], v[84:87], v[176:179]
    v_mfma_f32_16x16x32_bf16 v[120:123], v[100:103], v[72:75], v[120:123]
    v_mfma_f32_16x16x32_bf16 v[140:143], v[100:103], v[80:83], v[140:143]
    v_mfma_f32_16x16x32_bf16 v[160:163], v[100:103], v[76:79], v[160:163]
    v_mfma_f32_16x16x32_bf16 v[180:183], v[100:103], v[84:87], v[180:183]
    v_mfma_f32_16x16x32_bf16 v[124:127], v[104:107], v[72:75], v[124:127]
    v_mfma_f32_16x16x32_bf16 v[144:147], v[104:107], v[80:83], v[144:147]
    v_mfma_f32_16x16x32_bf16 v[164:167], v[104:107], v[76:79], v[164:167]
    v_mfma_f32_16x16x32_bf16 v[184:187], v[104:107], v[84:87], v[184:187]
    s_waitcnt vmcnt(9)
    v_swap_b32 v2, v8
    v_swap_b32 v3, v9
    v_swap_b32 v6, v12
    v_swap_b32 v7, v13
    v_mfma_f32_16x16x32_bf16 v[108:111], v[16:19], v[0:3], v[108:111]
    v_mfma_f32_16x16x32_bf16 v[128:131], v[16:19], v[8:11], v[128:131]
    v_mfma_f32_16x16x32_bf16 v[148:151], v[16:19], v[4:7], v[148:151]
    v_mfma_f32_16x16x32_bf16 v[168:171], v[16:19], v[12:15], v[168:171]
    v_mfma_f32_16x16x32_bf16 v[112:115], v[20:23], v[0:3], v[112:115]
    v_mfma_f32_16x16x32_bf16 v[132:135], v[20:23], v[8:11], v[132:135]
    v_mfma_f32_16x16x32_bf16 v[152:155], v[20:23], v[4:7], v[152:155]
    v_mfma_f32_16x16x32_bf16 v[172:175], v[20:23], v[12:15], v[172:175]
    v_mfma_f32_16x16x32_bf16 v[116:119], v[24:27], v[0:3], v[116:119]
    v_mfma_f32_16x16x32_bf16 v[136:139], v[24:27], v[8:11], v[136:139]
    v_mfma_f32_16x16x32_bf16 v[156:159], v[24:27], v[4:7], v[156:159]
    v_mfma_f32_16x16x32_bf16 v[176:179], v[24:27], v[12:15], v[176:179]
    v_mfma_f32_16x16x32_bf16 v[120:123], v[28:31], v[0:3], v[120:123]
    v_mfma_f32_16x16x32_bf16 v[140:143], v[28:31], v[8:11], v[140:143]
    v_mfma_f32_16x16x32_bf16 v[160:163], v[28:31], v[4:7], v[160:163]
    v_mfma_f32_16x16x32_bf16 v[180:183], v[28:31], v[12:15], v[180:183]
    v_mfma_f32_16x16x32_bf16 v[124:127], v[32:35], v[0:3], v[124:127]
    v_mfma_f32_16x16x32_bf16 v[144:147], v[32:35], v[8:11], v[144:147]
    v_mfma_f32_16x16x32_bf16 v[164:167], v[32:35], v[4:7], v[164:167]
    v_mfma_f32_16x16x32_bf16 v[184:187], v[32:35], v[12:15], v[184:187]
    s_waitcnt vmcnt(0)
    v_swap_b32 v38, v44
    v_swap_b32 v39, v45
    v_swap_b32 v42, v48
    v_swap_b32 v43, v49
    v_add_u32 v220, 0, v224
    v_add_u32 v221, 40960, v224
    v_mfma_f32_16x16x32_bf16 v[128:131], v[52:55], v[44:47], v[128:131]
    v_mfma_f32_16x16x32_bf16 v[132:135], v[56:59], v[44:47], v[132:135]
    v_mfma_f32_16x16x32_bf16 v[136:139], v[60:63], v[44:47], v[136:139]
    v_mfma_f32_16x16x32_bf16 v[140:143], v[64:67], v[44:47], v[140:143]
    v_mfma_f32_16x16x32_bf16 v[144:147], v[68:71], v[44:47], v[144:147]
    v_mfma_f32_16x16x32_bf16 v[148:151], v[52:55], v[40:43], v[148:151]
    v_mfma_f32_16x16x32_bf16 v[152:155], v[56:59], v[40:43], v[152:155]
    v_mfma_f32_16x16x32_bf16 v[156:159], v[60:63], v[40:43], v[156:159]
    v_mfma_f32_16x16x32_bf16 v[160:163], v[64:67], v[40:43], v[160:163]
    v_mfma_f32_16x16x32_bf16 v[164:167], v[68:71], v[40:43], v[164:167]
    v_mfma_f32_16x16x32_bf16 v[168:171], v[52:55], v[48:51], v[168:171]
    ds_write_b128 v220, v[128:131] offset:20480
    v_mfma_f32_16x16x32_bf16 v[172:175], v[56:59], v[48:51], v[172:175]
    ds_write_b128 v220, v[132:135] offset:21504
    v_mfma_f32_16x16x32_bf16 v[176:179], v[60:63], v[48:51], v[176:179]
    ds_write_b128 v220, v[136:139] offset:22528
    v_mfma_f32_16x16x32_bf16 v[180:183], v[64:67], v[48:51], v[180:183]
    ds_write_b128 v220, v[140:143] offset:23552
    v_mfma_f32_16x16x32_bf16 v[184:187], v[68:71], v[48:51], v[184:187]
    ds_write_b128 v220, v[144:147] offset:24576
    v_mfma_f32_16x16x32_bf16 v[108:111], v[52:55], v[36:39], v[108:111]
    ds_write_b128 v221, v[148:151] offset:0
    v_mfma_f32_16x16x32_bf16 v[112:115], v[56:59], v[36:39], v[112:115]
    ds_write_b128 v221, v[152:155] offset:1024
    v_mfma_f32_16x16x32_bf16 v[116:119], v[60:63], v[36:39], v[116:119]
    ds_write_b128 v221, v[156:159] offset:2048
    v_mfma_f32_16x16x32_bf16 v[120:123], v[64:67], v[36:39], v[120:123]
    ds_write_b128 v221, v[160:163] offset:3072
    v_mfma_f32_16x16x32_bf16 v[124:127], v[68:71], v[36:39], v[124:127]
    ds_write_b128 v221, v[164:167] offset:4096
    ds_write_b128 v221, v[168:171] offset:20480
    ds_write_b128 v221, v[172:175] offset:21504
    ds_write_b128 v221, v[176:179] offset:22528
    ds_write_b128 v221, v[180:183] offset:23552
    ds_write_b128 v221, v[184:187] offset:24576
    s_branch L_k2_red_a
L_k2_b:
    buffer_load_dwordx4 v[16:19], v224, s[12:15], s21 offen offset:0
    buffer_load_dwordx4 v[20:23], v224, s[12:15], s21 offen offset:1024
    buffer_load_dwordx4 v[24:27], v224, s[12:15], s21 offen offset:2048
    buffer_load_dwordx4 v[28:31], v224, s[12:15], s21 offen offset:3072
    buffer_load_dwordx4 v[32:35], v225, s[12:15], s21 offen
    buffer_load_dwordx4 v[0:3], v226, s[12:15], s20 offen
    buffer_load_dwordx4 v[4:7], v227, s[12:15], s20 offen
    buffer_load_dwordx4 v[8:11], v228, s[12:15], s20 offen
    buffer_load_dwordx4 v[12:15], v229, s[12:15], s20 offen
    s_add_u32 s20, s20, 1024
    s_add_u32 s21, s21, 5120
    buffer_load_dwordx4 v[52:55], v224, s[12:15], s21 offen offset:0
    buffer_load_dwordx4 v[56:59], v224, s[12:15], s21 offen offset:1024
    buffer_load_dwordx4 v[60:63], v224, s[12:15], s21 offen offset:2048
    buffer_load_dwordx4 v[64:67], v224, s[12:15], s21 offen offset:3072
    buffer_load_dwordx4 v[68:71], v225, s[12:15], s21 offen
    buffer_load_dwordx4 v[36:39], v226, s[12:15], s20 offen
    buffer_load_dwordx4 v[40:43], v227, s[12:15], s20 offen
    buffer_load_dwordx4 v[44:47], v228, s[12:15], s20 offen
    buffer_load_dwordx4 v[48:51], v229, s[12:15], s20 offen
    s_add_u32 s20, s20, 1024
    s_add_u32 s21, s21, 5120
    buffer_load_dwordx4 v[88:91], v224, s[12:15], s21 offen offset:0
    buffer_load_dwordx4 v[92:95], v224, s[12:15], s21 offen offset:1024
    buffer_load_dwordx4 v[96:99], v224, s[12:15], s21 offen offset:2048
    buffer_load_dwordx4 v[100:103], v224, s[12:15], s21 offen offset:3072
    buffer_load_dwordx4 v[104:107], v225, s[12:15], s21 offen
    buffer_load_dwordx4 v[72:75], v226, s[12:15], s20 offen
    buffer_load_dwordx4 v[76:79], v227, s[12:15], s20 offen
    buffer_load_dwordx4 v[80:83], v228, s[12:15], s20 offen
    buffer_load_dwordx4 v[84:87], v229, s[12:15], s20 offen
    s_add_u32 s20, s20, 1024
    s_add_u32 s21, s21, 5120
    v_mov_b32 v108, 0
    v_mov_b32 v109, 0
    v_mov_b32 v110, 0
    v_mov_b32 v111, 0
    v_mov_b32 v112, 0
    v_mov_b32 v113, 0
    v_mov_b32 v114, 0
    v_mov_b32 v115, 0
    v_mov_b32 v116, 0
    v_mov_b32 v117, 0
    v_mov_b32 v118, 0
    v_mov_b32 v119, 0
    v_mov_b32 v120, 0
    v_mov_b32 v121, 0
    v_mov_b32 v122, 0
    v_mov_b32 v123, 0
    v_mov_b32 v124, 0
    v_mov_b32 v125, 0
    v_mov_b32 v126, 0
    v_mov_b32 v127, 0
    v_mov_b32 v128, 0
    v_mov_b32 v129, 0
    v_mov_b32 v130, 0
    v_mov_b32 v131, 0
    v_mov_b32 v132, 0
    v_mov_b32 v133, 0
    v_mov_b32 v134, 0
    v_mov_b32 v135, 0
    v_mov_b32 v136, 0
    v_mov_b32 v137, 0
    v_mov_b32 v138, 0
    v_mov_b32 v139, 0
    v_mov_b32 v140, 0
    v_mov_b32 v141, 0
    v_mov_b32 v142, 0
    v_mov_b32 v143, 0
    v_mov_b32 v144, 0
    v_mov_b32 v145, 0
    v_mov_b32 v146, 0
    v_mov_b32 v147, 0
    v_mov_b32 v148, 0
    v_mov_b32 v149, 0
    v_mov_b32 v150, 0
    v_mov_b32 v151, 0
    v_mov_b32 v152, 0
    v_mov_b32 v153, 0
    v_mov_b32 v154, 0
    v_mov_b32 v155, 0
    v_mov_b32 v156, 0
    v_mov_b32 v157, 0
    v_mov_b32 v158, 0
    v_mov_b32 v159, 0
    v_mov_b32 v160, 0
    v_mov_b32 v161, 0
    v_mov_b32 v162, 0
    v_mov_b32 v163, 0
    v_mov_b32 v164, 0
    v_mov_b32 v165, 0
    v_mov_b32 v166, 0
    v_mov_b32 v167, 0
    v_mov_b32 v168, 0
    v_mov_b32 v169, 0
    v_mov_b32 v170, 0
    v_mov_b32 v171, 0
    v_mov_b32 v172, 0
    v_mov_b32 v173, 0
    v_mov_b32 v174, 0
    v_mov_b32 v175, 0
    v_mov_b32 v176, 0
    v_mov_b32 v177, 0
    v_mov_b32 v178, 0
    v_mov_b32 v179, 0
    v_mov_b32 v180, 0
    v_mov_b32 v181, 0
    v_mov_b32 v182, 0
    v_mov_b32 v183, 0
    v_mov_b32 v184, 0
    v_mov_b32 v185, 0
    v_mov_b32 v186, 0
    v_mov_b32 v187, 0
    s_waitcnt vmcnt(18)
    v_mfma_f32_16x16x32_bf16 v[108:111], v[16:19], v[0:3], v[108:111]
    v_mfma_f32_16x16x32_bf16 v[128:131], v[16:19], v[4:7], v[128:131]
    v_mfma_f32_16x16x32_bf16 v[148:151], v[16:19], v[8:11], v[148:151]
    v_mfma_f32_16x16x32_bf16 v[168:171], v[16:19], v[12:15], v[168:171]
    buffer_load_dwordx4 v[16:19], v224, s[12:15], s21 offen offset:0
    v_mfma_f32_16x16x32_bf16 v[112:115], v[20:23], v[0:3], v[112:115]
    v_mfma_f32_16x16x32_bf16 v[132:135], v[20:23], v[4:7], v[132:135]
    v_mfma_f32_16x16x32_bf16 v[152:155], v[20:23], v[8:11], v[152:155]
    v_mfma_f32_16x16x32_bf16 v[172:175], v[20:23], v[12:15], v[172:175]
    buffer_load_dwordx4 v[20:23], v224, s[12:15], s21 offen offset:1024
    v_mfma_f32_16x16x32_bf16 v[116:119], v[24:27], v[0:3], v[116:119]
    v_mfma_f32_16x16x32_bf16 v[136:139], v[24:27], v[4:7], v[136:139]
    v_mfma_f32_16x16x32_bf16 v[156:159], v[24:27], v[8:11], v[156:159]
    v_mfma_f32_16x16x32_bf16 v[176:179], v[24:27], v[12:15], v[176:179]
    buffer_load_dwordx4 v[24:27], v224, s[12:15], s21 offen offset:2048
    v_mfma_f32_16x16x32_bf16 v[120:123], v[28:31], v[0:3], v[120:123]
    v_mfma_f32_16x16x32_bf16 v[140:143], v[28:31], v[4:7], v[140:143]
    v_mfma_f32_16x16x32_bf16 v[160:163], v[28:31], v[8:11], v[160:163]
    v_mfma_f32_16x16x32_bf16 v[180:183], v[28:31], v[12:15], v[180:183]
    buffer_load_dwordx4 v[28:31], v224, s[12:15], s21 offen offset:3072
    v_mfma_f32_16x16x32_bf16 v[124:127], v[32:35], v[0:3], v[124:127]
    v_mfma_f32_16x16x32_bf16 v[144:147], v[32:35], v[4:7], v[144:147]
    v_mfma_f32_16x16x32_bf16 v[164:167], v[32:35], v[8:11], v[164:167]
    v_mfma_f32_16x16x32_bf16 v[184:187], v[32:35], v[12:15], v[184:187]
    buffer_load_dwordx4 v[32:35], v225, s[12:15], s21 offen
    buffer_load_dwordx4 v[0:3], v226, s[12:15], s20 offen
    buffer_load_dwordx4 v[4:7], v227, s[12:15], s20 offen
    buffer_load_dwordx4 v[8:11], v228, s[12:15], s20 offen
    buffer_load_dwordx4 v[12:15], v229, s[12:15], s20 offen
    s_add_u32 s20, s20, 1024
    s_add_u32 s21, s21, 5120
    s_waitcnt vmcnt(18)
    v_mfma_f32_16x16x32_bf16 v[108:111], v[52:55], v[36:39], v[108:111]
    v_mfma_f32_16x16x32_bf16 v[128:131], v[52:55], v[40:43], v[128:131]
    v_mfma_f32_16x16x32_bf16 v[148:151], v[52:55], v[44:47], v[148:151]
    v_mfma_f32_16x16x32_bf16 v[168:171], v[52:55], v[48:51], v[168:171]
    buffer_load_dwordx4 v[52:55], v224, s[12:15], s21 offen offset:0
    v_mfma_f32_16x16x32_bf16 v[112:115], v[56:59], v[36:39], v[112:115]
    v_mfma_f32_16x16x32_bf16 v[132:135], v[56:59], v[40:43], v[132:135]
    v_mfma_f32_16x16x32_bf16 v[152:155], v[56:59], v[44:47], v[152:155]
    v_mfma_f32_16x16x32_bf16 v[172:175], v[56:59], v[48:51], v[172:175]
    buffer_load_dwordx4 v[56:59], v224, s[12:15], s21 offen offset:1024
    v_mfma_f32_16x16x32_bf16 v[116:119], v[60:63], v[36:39], v[116:119]
    v_mfma_f32_16x16x32_bf16 v[136:139], v[60:63], v[40:43], v[136:139]
    v_mfma_f32_16x16x32_bf16 v[156:159], v[60:63], v[44:47], v[156:159]
    v_mfma_f32_16x16x32_bf16 v[176:179], v[60:63], v[48:51], v[176:179]
    buffer_load_dwordx4 v[60:63], v224, s[12:15], s21 offen offset:2048
    v_mfma_f32_16x16x32_bf16 v[120:123], v[64:67], v[36:39], v[120:123]
    v_mfma_f32_16x16x32_bf16 v[140:143], v[64:67], v[40:43], v[140:143]
    v_mfma_f32_16x16x32_bf16 v[160:163], v[64:67], v[44:47], v[160:163]
    v_mfma_f32_16x16x32_bf16 v[180:183], v[64:67], v[48:51], v[180:183]
    buffer_load_dwordx4 v[64:67], v224, s[12:15], s21 offen offset:3072
    v_mfma_f32_16x16x32_bf16 v[124:127], v[68:71], v[36:39], v[124:127]
    v_mfma_f32_16x16x32_bf16 v[144:147], v[68:71], v[40:43], v[144:147]
    v_mfma_f32_16x16x32_bf16 v[164:167], v[68:71], v[44:47], v[164:167]
    v_mfma_f32_16x16x32_bf16 v[184:187], v[68:71], v[48:51], v[184:187]
    buffer_load_dwordx4 v[68:71], v225, s[12:15], s21 offen
    buffer_load_dwordx4 v[36:39], v226, s[12:15], s20 offen
    buffer_load_dwordx4 v[40:43], v227, s[12:15], s20 offen
    buffer_load_dwordx4 v[44:47], v228, s[12:15], s20 offen
    buffer_load_dwordx4 v[48:51], v229, s[12:15], s20 offen
    s_add_u32 s20, s20, 1024
    s_add_u32 s21, s21, 5120
    s_waitcnt vmcnt(18)
    v_mfma_f32_16x16x32_bf16 v[108:111], v[88:91], v[72:75], v[108:111]
    v_mfma_f32_16x16x32_bf16 v[128:131], v[88:91], v[76:79], v[128:131]
    v_mfma_f32_16x16x32_bf16 v[148:151], v[88:91], v[80:83], v[148:151]
    v_mfma_f32_16x16x32_bf16 v[168:171], v[88:91], v[84:87], v[168:171]
    buffer_load_dwordx4 v[88:91], v224, s[12:15], s21 offen offset:0
    v_mfma_f32_16x16x32_bf16 v[112:115], v[92:95], v[72:75], v[112:115]
    v_mfma_f32_16x16x32_bf16 v[132:135], v[92:95], v[76:79], v[132:135]
    v_mfma_f32_16x16x32_bf16 v[152:155], v[92:95], v[80:83], v[152:155]
    v_mfma_f32_16x16x32_bf16 v[172:175], v[92:95], v[84:87], v[172:175]
    buffer_load_dwordx4 v[92:95], v224, s[12:15], s21 offen offset:1024
    v_mfma_f32_16x16x32_bf16 v[116:119], v[96:99], v[72:75], v[116:119]
    v_mfma_f32_16x16x32_bf16 v[136:139], v[96:99], v[76:79], v[136:139]
    v_mfma_f32_16x16x32_bf16 v[156:159], v[96:99], v[80:83], v[156:159]
    v_mfma_f32_16x16x32_bf16 v[176:179], v[96:99], v[84:87], v[176:179]
    buffer_load_dwordx4 v[96:99], v224, s[12:15], s21 offen offset:2048
    v_mfma_f32_16x16x32_bf16 v[120:123], v[100:103], v[72:75], v[120:123]
    v_mfma_f32_16x16x32_bf16 v[140:143], v[100:103], v[76:79], v[140:143]
    v_mfma_f32_16x16x32_bf16 v[160:163], v[100:103], v[80:83], v[160:163]
    v_mfma_f32_16x16x32_bf16 v[180:183], v[100:103], v[84:87], v[180:183]
    buffer_load_dwordx4 v[100:103], v224, s[12:15], s21 offen offset:3072
    v_mfma_f32_16x16x32_bf16 v[124:127], v[104:107], v[72:75], v[124:127]
    v_mfma_f32_16x16x32_bf16 v[144:147], v[104:107], v[76:79], v[144:147]
    v_mfma_f32_16x16x32_bf16 v[164:167], v[104:107], v[80:83], v[164:167]
    v_mfma_f32_16x16x32_bf16 v[184:187], v[104:107], v[84:87], v[184:187]
    buffer_load_dwordx4 v[104:107], v225, s[12:15], s21 offen
    buffer_load_dwordx4 v[72:75], v226, s[12:15], s20 offen
    buffer_load_dwordx4 v[76:79], v227, s[12:15], s20 offen
    buffer_load_dwordx4 v[80:83], v228, s[12:15], s20 offen
    buffer_load_dwordx4 v[84:87], v229, s[12:15], s20 offen
    s_add_u32 s20, s20, 1024
    s_add_u32 s21, s21, 5120
    s_waitcnt vmcnt(18)
    v_mfma_f32_16x16x32_bf16 v[108:111], v[16:19], v[0:3], v[108:111]
    v_mfma_f32_16x16x32_bf16 v[128:131], v[16:19], v[4:7], v[128:131]
    v_mfma_f32_16x16x32_bf16 v[148:151], v[16:19], v[8:11], v[148:151]
    v_mfma_f32_16x16x32_bf16 v[168:171], v[16:19], v[12:15], v[168:171]
    buffer_load_dwordx4 v[16:19], v224, s[12:15], s21 offen offset:0
    v_mfma_f32_16x16x32_bf16 v[112:115], v[20:23], v[0:3], v[112:115]
    v_mfma_f32_16x16x32_bf16 v[132:135], v[20:23], v[4:7], v[132:135]
    v_mfma_f32_16x16x32_bf16 v[152:155], v[20:23], v[8:11], v[152:155]
    v_mfma_f32_16x16x32_bf16 v[172:175], v[20:23], v[12:15], v[172:175]
    buffer_load_dwordx4 v[20:23], v224, s[12:15], s21 offen offset:1024
    v_mfma_f32_16x16x32_bf16 v[116:119], v[24:27], v[0:3], v[116:119]
    v_mfma_f32_16x16x32_bf16 v[136:139], v[24:27], v[4:7], v[136:139]
    v_mfma_f32_16x16x32_bf16 v[156:159], v[24:27], v[8:11], v[156:159]
    v_mfma_f32_16x16x32_bf16 v[176:179], v[24:27], v[12:15], v[176:179]
    buffer_load_dwordx4 v[24:27], v224, s[12:15], s21 offen offset:2048
    v_mfma_f32_16x16x32_bf16 v[120:123], v[28:31], v[0:3], v[120:123]
    v_mfma_f32_16x16x32_bf16 v[140:143], v[28:31], v[4:7], v[140:143]
    v_mfma_f32_16x16x32_bf16 v[160:163], v[28:31], v[8:11], v[160:163]
    v_mfma_f32_16x16x32_bf16 v[180:183], v[28:31], v[12:15], v[180:183]
    buffer_load_dwordx4 v[28:31], v224, s[12:15], s21 offen offset:3072
    v_mfma_f32_16x16x32_bf16 v[124:127], v[32:35], v[0:3], v[124:127]
    v_mfma_f32_16x16x32_bf16 v[144:147], v[32:35], v[4:7], v[144:147]
    v_mfma_f32_16x16x32_bf16 v[164:167], v[32:35], v[8:11], v[164:167]
    v_mfma_f32_16x16x32_bf16 v[184:187], v[32:35], v[12:15], v[184:187]
    buffer_load_dwordx4 v[32:35], v225, s[12:15], s21 offen
    buffer_load_dwordx4 v[0:3], v226, s[12:15], s20 offen
    buffer_load_dwordx4 v[4:7], v227, s[12:15], s20 offen
    buffer_load_dwordx4 v[8:11], v228, s[12:15], s20 offen
    buffer_load_dwordx4 v[12:15], v229, s[12:15], s20 offen
    s_add_u32 s20, s20, 1024
    s_add_u32 s21, s21, 5120
    s_waitcnt vmcnt(18)
    v_mfma_f32_16x16x32_bf16 v[108:111], v[52:55], v[36:39], v[108:111]
    v_mfma_f32_16x16x32_bf16 v[128:131], v[52:55], v[40:43], v[128:131]
    v_mfma_f32_16x16x32_bf16 v[148:151], v[52:55], v[44:47], v[148:151]
    v_mfma_f32_16x16x32_bf16 v[168:171], v[52:55], v[48:51], v[168:171]
    buffer_load_dwordx4 v[52:55], v224, s[12:15], s21 offen offset:0
    v_mfma_f32_16x16x32_bf16 v[112:115], v[56:59], v[36:39], v[112:115]
    v_mfma_f32_16x16x32_bf16 v[132:135], v[56:59], v[40:43], v[132:135]
    v_mfma_f32_16x16x32_bf16 v[152:155], v[56:59], v[44:47], v[152:155]
    v_mfma_f32_16x16x32_bf16 v[172:175], v[56:59], v[48:51], v[172:175]
    buffer_load_dwordx4 v[56:59], v224, s[12:15], s21 offen offset:1024
    v_mfma_f32_16x16x32_bf16 v[116:119], v[60:63], v[36:39], v[116:119]
    v_mfma_f32_16x16x32_bf16 v[136:139], v[60:63], v[40:43], v[136:139]
    v_mfma_f32_16x16x32_bf16 v[156:159], v[60:63], v[44:47], v[156:159]
    v_mfma_f32_16x16x32_bf16 v[176:179], v[60:63], v[48:51], v[176:179]
    buffer_load_dwordx4 v[60:63], v224, s[12:15], s21 offen offset:2048
    v_mfma_f32_16x16x32_bf16 v[120:123], v[64:67], v[36:39], v[120:123]
    v_mfma_f32_16x16x32_bf16 v[140:143], v[64:67], v[40:43], v[140:143]
    v_mfma_f32_16x16x32_bf16 v[160:163], v[64:67], v[44:47], v[160:163]
    v_mfma_f32_16x16x32_bf16 v[180:183], v[64:67], v[48:51], v[180:183]
    buffer_load_dwordx4 v[64:67], v224, s[12:15], s21 offen offset:3072
    v_mfma_f32_16x16x32_bf16 v[124:127], v[68:71], v[36:39], v[124:127]
    v_mfma_f32_16x16x32_bf16 v[144:147], v[68:71], v[40:43], v[144:147]
    v_mfma_f32_16x16x32_bf16 v[164:167], v[68:71], v[44:47], v[164:167]
    v_mfma_f32_16x16x32_bf16 v[184:187], v[68:71], v[48:51], v[184:187]
    buffer_load_dwordx4 v[68:71], v225, s[12:15], s21 offen
    buffer_load_dwordx4 v[36:39], v226, s[12:15], s20 offen
    buffer_load_dwordx4 v[40:43], v227, s[12:15], s20 offen
    buffer_load_dwordx4 v[44:47], v228, s[12:15], s20 offen
    buffer_load_dwordx4 v[48:51], v229, s[12:15], s20 offen
    s_add_u32 s20, s20, 1024
    s_add_u32 s21, s21, 5120
    s_waitcnt vmcnt(18)
    v_mfma_f32_16x16x32_bf16 v[108:111], v[88:91], v[72:75], v[108:111]
    v_mfma_f32_16x16x32_bf16 v[128:131], v[88:91], v[76:79], v[128:131]
    v_mfma_f32_16x16x32_bf16 v[148:151], v[88:91], v[80:83], v[148:151]
    v_mfma_f32_16x16x32_bf16 v[168:171], v[88:91], v[84:87], v[168:171]
    buffer_load_dwordx4 v[88:91], v224, s[12:15], s21 offen offset:0
    v_mfma_f32_16x16x32_bf16 v[112:115], v[92:95], v[72:75], v[112:115]
    v_mfma_f32_16x16x32_bf16 v[132:135], v[92:95], v[76:79], v[132:135]
    v_mfma_f32_16x16x32_bf16 v[152:155], v[92:95], v[80:83], v[152:155]
    v_mfma_f32_16x16x32_bf16 v[172:175], v[92:95], v[84:87], v[172:175]
    buffer_load_dwordx4 v[92:95], v224, s[12:15], s21 offen offset:1024
    v_mfma_f32_16x16x32_bf16 v[116:119], v[96:99], v[72:75], v[116:119]
    v_mfma_f32_16x16x32_bf16 v[136:139], v[96:99], v[76:79], v[136:139]
    v_mfma_f32_16x16x32_bf16 v[156:159], v[96:99], v[80:83], v[156:159]
    v_mfma_f32_16x16x32_bf16 v[176:179], v[96:99], v[84:87], v[176:179]
    buffer_load_dwordx4 v[96:99], v224, s[12:15], s21 offen offset:2048
    v_mfma_f32_16x16x32_bf16 v[120:123], v[100:103], v[72:75], v[120:123]
    v_mfma_f32_16x16x32_bf16 v[140:143], v[100:103], v[76:79], v[140:143]
    v_mfma_f32_16x16x32_bf16 v[160:163], v[100:103], v[80:83], v[160:163]
    v_mfma_f32_16x16x32_bf16 v[180:183], v[100:103], v[84:87], v[180:183]
    buffer_load_dwordx4 v[100:103], v224, s[12:15], s21 offen offset:3072
    v_mfma_f32_16x16x32_bf16 v[124:127], v[104:107], v[72:75], v[124:127]
    v_mfma_f32_16x16x32_bf16 v[144:147], v[104:107], v[76:79], v[144:147]
    v_mfma_f32_16x16x32_bf16 v[164:167], v[104:107], v[80:83], v[164:167]
    v_mfma_f32_16x16x32_bf16 v[184:187], v[104:107], v[84:87], v[184:187]
    buffer_load_dwordx4 v[104:107], v225, s[12:15], s21 offen
    buffer_load_dwordx4 v[72:75], v226, s[12:15], s20 offen
    buffer_load_dwordx4 v[76:79], v227, s[12:15], s20 offen
    buffer_load_dwordx4 v[80:83], v228, s[12:15], s20 offen
    buffer_load_dwordx4 v[84:87], v229, s[12:15], s20 offen
    s_add_u32 s20, s20, 1024
    s_add_u32 s21, s21, 5120
    s_waitcnt vmcnt(18)
    v_mfma_f32_16x16x32_bf16 v[108:111], v[16:19], v[0:3], v[108:111]
    v_mfma_f32_16x16x32_bf16 v[128:131], v[16:19], v[4:7], v[128:131]
    v_mfma_f32_16x16x32_bf16 v[148:151], v[16:19], v[8:11], v[148:151]
    v_mfma_f32_16x16x32_bf16 v[168:171], v[16:19], v[12:15], v[168:171]
    buffer_load_dwordx4 v[16:19], v224, s[12:15], s21 offen offset:0
    v_mfma_f32_16x16x32_bf16 v[112:115], v[20:23], v[0:3], v[112:115]
    v_mfma_f32_16x16x32_bf16 v[132:135], v[20:23], v[4:7], v[132:135]
    v_mfma_f32_16x16x32_bf16 v[152:155], v[20:23], v[8:11], v[152:155]
    v_mfma_f32_16x16x32_bf16 v[172:175], v[20:23], v[12:15], v[172:175]
    buffer_load_dwordx4 v[20:23], v224, s[12:15], s21 offen offset:1024
    v_mfma_f32_16x16x32_bf16 v[116:119], v[24:27], v[0:3], v[116:119]
    v_mfma_f32_16x16x32_bf16 v[136:139], v[24:27], v[4:7], v[136:139]
    v_mfma_f32_16x16x32_bf16 v[156:159], v[24:27], v[8:11], v[156:159]
    v_mfma_f32_16x16x32_bf16 v[176:179], v[24:27], v[12:15], v[176:179]
    buffer_load_dwordx4 v[24:27], v224, s[12:15], s21 offen offset:2048
    v_mfma_f32_16x16x32_bf16 v[120:123], v[28:31], v[0:3], v[120:123]
    v_mfma_f32_16x16x32_bf16 v[140:143], v[28:31], v[4:7], v[140:143]
    v_mfma_f32_16x16x32_bf16 v[160:163], v[28:31], v[8:11], v[160:163]
    v_mfma_f32_16x16x32_bf16 v[180:183], v[28:31], v[12:15], v[180:183]
    buffer_load_dwordx4 v[28:31], v224, s[12:15], s21 offen offset:3072
    v_mfma_f32_16x16x32_bf16 v[124:127], v[32:35], v[0:3], v[124:127]
    v_mfma_f32_16x16x32_bf16 v[144:147], v[32:35], v[4:7], v[144:147]
    v_mfma_f32_16x16x32_bf16 v[164:167], v[32:35], v[8:11], v[164:167]
    v_mfma_f32_16x16x32_bf16 v[184:187], v[32:35], v[12:15], v[184:187]
    buffer_load_dwordx4 v[32:35], v225, s[12:15], s21 offen
    buffer_load_dwordx4 v[0:3], v226, s[12:15], s20 offen
    buffer_load_dwordx4 v[4:7], v227, s[12:15], s20 offen
    buffer_load_dwordx4 v[8:11], v228, s[12:15], s20 offen
    buffer_load_dwordx4 v[12:15], v229, s[12:15], s20 offen
    s_add_u32 s20, s20, 1024
    s_add_u32 s21, s21, 5120
    s_waitcnt vmcnt(18)
    v_mfma_f32_16x16x32_bf16 v[108:111], v[52:55], v[36:39], v[108:111]
    v_mfma_f32_16x16x32_bf16 v[128:131], v[52:55], v[40:43], v[128:131]
    v_mfma_f32_16x16x32_bf16 v[148:151], v[52:55], v[44:47], v[148:151]
    v_mfma_f32_16x16x32_bf16 v[168:171], v[52:55], v[48:51], v[168:171]
    buffer_load_dwordx4 v[52:55], v224, s[12:15], s21 offen offset:0
    v_mfma_f32_16x16x32_bf16 v[112:115], v[56:59], v[36:39], v[112:115]
    v_mfma_f32_16x16x32_bf16 v[132:135], v[56:59], v[40:43], v[132:135]
    v_mfma_f32_16x16x32_bf16 v[152:155], v[56:59], v[44:47], v[152:155]
    v_mfma_f32_16x16x32_bf16 v[172:175], v[56:59], v[48:51], v[172:175]
    buffer_load_dwordx4 v[56:59], v224, s[12:15], s21 offen offset:1024
    v_mfma_f32_16x16x32_bf16 v[116:119], v[60:63], v[36:39], v[116:119]
    v_mfma_f32_16x16x32_bf16 v[136:139], v[60:63], v[40:43], v[136:139]
    v_mfma_f32_16x16x32_bf16 v[156:159], v[60:63], v[44:47], v[156:159]
    v_mfma_f32_16x16x32_bf16 v[176:179], v[60:63], v[48:51], v[176:179]
    buffer_load_dwordx4 v[60:63], v224, s[12:15], s21 offen offset:2048
    v_mfma_f32_16x16x32_bf16 v[120:123], v[64:67], v[36:39], v[120:123]
    v_mfma_f32_16x16x32_bf16 v[140:143], v[64:67], v[40:43], v[140:143]
    v_mfma_f32_16x16x32_bf16 v[160:163], v[64:67], v[44:47], v[160:163]
    v_mfma_f32_16x16x32_bf16 v[180:183], v[64:67], v[48:51], v[180:183]
    buffer_load_dwordx4 v[64:67], v224, s[12:15], s21 offen offset:3072
    v_mfma_f32_16x16x32_bf16 v[124:127], v[68:71], v[36:39], v[124:127]
    v_mfma_f32_16x16x32_bf16 v[144:147], v[68:71], v[40:43], v[144:147]
    v_mfma_f32_16x16x32_bf16 v[164:167], v[68:71], v[44:47], v[164:167]
    v_mfma_f32_16x16x32_bf16 v[184:187], v[68:71], v[48:51], v[184:187]
    buffer_load_dwordx4 v[68:71], v225, s[12:15], s21 offen
    buffer_load_dwordx4 v[36:39], v226, s[12:15], s20 offen
    buffer_load_dwordx4 v[40:43], v227, s[12:15], s20 offen
    buffer_load_dwordx4 v[44:47], v228, s[12:15], s20 offen
    buffer_load_dwordx4 v[48:51], v229, s[12:15], s20 offen
    s_add_u32 s20, s20, 1024
    s_add_u32 s21, s21, 5120
    s_waitcnt vmcnt(18)
    v_mfma_f32_16x16x32_bf16 v[108:111], v[88:91], v[72:75], v[108:111]
    v_mfma_f32_16x16x32_bf16 v[128:131], v[88:91], v[76:79], v[128:131]
    v_mfma_f32_16x16x32_bf16 v[148:151], v[88:91], v[80:83], v[148:151]
    v_mfma_f32_16x16x32_bf16 v[168:171], v[88:91], v[84:87], v[168:171]
    buffer_load_dwordx4 v[88:91], v224, s[12:15], s21 offen offset:0
    v_mfma_f32_16x16x32_bf16 v[112:115], v[92:95], v[72:75], v[112:115]
    v_mfma_f32_16x16x32_bf16 v[132:135], v[92:95], v[76:79], v[132:135]
    v_mfma_f32_16x16x32_bf16 v[152:155], v[92:95], v[80:83], v[152:155]
    v_mfma_f32_16x16x32_bf16 v[172:175], v[92:95], v[84:87], v[172:175]
    buffer_load_dwordx4 v[92:95], v224, s[12:15], s21 offen offset:1024
    v_mfma_f32_16x16x32_bf16 v[116:119], v[96:99], v[72:75], v[116:119]
    v_mfma_f32_16x16x32_bf16 v[136:139], v[96:99], v[76:79], v[136:139]
    v_mfma_f32_16x16x32_bf16 v[156:159], v[96:99], v[80:83], v[156:159]
    v_mfma_f32_16x16x32_bf16 v[176:179], v[96:99], v[84:87], v[176:179]
    buffer_load_dwordx4 v[96:99], v224, s[12:15], s21 offen offset:2048
    v_mfma_f32_16x16x32_bf16 v[120:123], v[100:103], v[72:75], v[120:123]
    v_mfma_f32_16x16x32_bf16 v[140:143], v[100:103], v[76:79], v[140:143]
    v_mfma_f32_16x16x32_bf16 v[160:163], v[100:103], v[80:83], v[160:163]
    v_mfma_f32_16x16x32_bf16 v[180:183], v[100:103], v[84:87], v[180:183]
    buffer_load_dwordx4 v[100:103], v224, s[12:15], s21 offen offset:3072
    v_mfma_f32_16x16x32_bf16 v[124:127], v[104:107], v[72:75], v[124:127]
    v_mfma_f32_16x16x32_bf16 v[144:147], v[104:107], v[76:79], v[144:147]
    v_mfma_f32_16x16x32_bf16 v[164:167], v[104:107], v[80:83], v[164:167]
    v_mfma_f32_16x16x32_bf16 v[184:187], v[104:107], v[84:87], v[184:187]
    buffer_load_dwordx4 v[104:107], v225, s[12:15], s21 offen
    buffer_load_dwordx4 v[72:75], v226, s[12:15], s20 offen
    buffer_load_dwordx4 v[76:79], v227, s[12:15], s20 offen
    buffer_load_dwordx4 v[80:83], v228, s[12:15], s20 offen
    buffer_load_dwordx4 v[84:87], v229, s[12:15], s20 offen
    s_add_u32 s20, s20, 1024
    s_add_u32 s21, s21, 5120
    s_waitcnt vmcnt(18)
    v_mfma_f32_16x16x32_bf16 v[108:111], v[16:19], v[0:3], v[108:111]
    v_mfma_f32_16x16x32_bf16 v[128:131], v[16:19], v[4:7], v[128:131]
    v_mfma_f32_16x16x32_bf16 v[148:151], v[16:19], v[8:11], v[148:151]
    v_mfma_f32_16x16x32_bf16 v[168:171], v[16:19], v[12:15], v[168:171]
    buffer_load_dwordx4 v[16:19], v224, s[12:15], s21 offen offset:0
    v_mfma_f32_16x16x32_bf16 v[112:115], v[20:23], v[0:3], v[112:115]
    v_mfma_f32_16x16x32_bf16 v[132:135], v[20:23], v[4:7], v[132:135]
    v_mfma_f32_16x16x32_bf16 v[152:155], v[20:23], v[8:11], v[152:155]
    v_mfma_f32_16x16x32_bf16 v[172:175], v[20:23], v[12:15], v[172:175]
    buffer_load_dwordx4 v[20:23], v224, s[12:15], s21 offen offset:1024
    v_mfma_f32_16x16x32_bf16 v[116:119], v[24:27], v[0:3], v[116:119]
    v_mfma_f32_16x16x32_bf16 v[136:139], v[24:27], v[4:7], v[136:139]
    v_mfma_f32_16x16x32_bf16 v[156:159], v[24:27], v[8:11], v[156:159]
    v_mfma_f32_16x16x32_bf16 v[176:179], v[24:27], v[12:15], v[176:179]
    buffer_load_dwordx4 v[24:27], v224, s[12:15], s21 offen offset:2048
    v_mfma_f32_16x16x32_bf16 v[120:123], v[28:31], v[0:3], v[120:123]
    v_mfma_f32_16x16x32_bf16 v[140:143], v[28:31], v[4:7], v[140:143]
    v_mfma_f32_16x16x32_bf16 v[160:163], v[28:31], v[8:11], v[160:163]
    v_mfma_f32_16x16x32_bf16 v[180:183], v[28:31], v[12:15], v[180:183]
    buffer_load_dwordx4 v[28:31], v224, s[12:15], s21 offen offset:3072
    v_mfma_f32_16x16x32_bf16 v[124:127], v[32:35], v[0:3], v[124:127]
    v_mfma_f32_16x16x32_bf16 v[144:147], v[32:35], v[4:7], v[144:147]
    v_mfma_f32_16x16x32_bf16 v[164:167], v[32:35], v[8:11], v[164:167]
    v_mfma_f32_16x16x32_bf16 v[184:187], v[32:35], v[12:15], v[184:187]
    buffer_load_dwordx4 v[32:35], v225, s[12:15], s21 offen
    buffer_load_dwordx4 v[0:3], v226, s[12:15], s20 offen
    buffer_load_dwordx4 v[4:7], v227, s[12:15], s20 offen
    buffer_load_dwordx4 v[8:11], v228, s[12:15], s20 offen
    buffer_load_dwordx4 v[12:15], v229, s[12:15], s20 offen
    s_add_u32 s20, s20, 1024
    s_add_u32 s21, s21, 5120
    s_waitcnt vmcnt(18)
    v_mfma_f32_16x16x32_bf16 v[108:111], v[52:55], v[36:39], v[108:111]
    v_mfma_f32_16x16x32_bf16 v[128:131], v[52:55], v[40:43], v[128:131]
    v_mfma_f32_16x16x32_bf16 v[148:151], v[52:55], v[44:47], v[148:151]
    v_mfma_f32_16x16x32_bf16 v[168:171], v[52:55], v[48:51], v[168:171]
    buffer_load_dwordx4 v[52:55], v224, s[12:15], s21 offen offset:0
    v_mfma_f32_16x16x32_bf16 v[112:115], v[56:59], v[36:39], v[112:115]
    v_mfma_f32_16x16x32_bf16 v[132:135], v[56:59], v[40:43], v[132:135]
    v_mfma_f32_16x16x32_bf16 v[152:155], v[56:59], v[44:47], v[152:155]
    v_mfma_f32_16x16x32_bf16 v[172:175], v[56:59], v[48:51], v[172:175]
    buffer_load_dwordx4 v[56:59], v224, s[12:15], s21 offen offset:1024
    v_mfma_f32_16x16x32_bf16 v[116:119], v[60:63], v[36:39], v[116:119]
    v_mfma_f32_16x16x32_bf16 v[136:139], v[60:63], v[40:43], v[136:139]
    v_mfma_f32_16x16x32_bf16 v[156:159], v[60:63], v[44:47], v[156:159]
    v_mfma_f32_16x16x32_bf16 v[176:179], v[60:63], v[48:51], v[176:179]
    buffer_load_dwordx4 v[60:63], v224, s[12:15], s21 offen offset:2048
    v_mfma_f32_16x16x32_bf16 v[120:123], v[64:67], v[36:39], v[120:123]
    v_mfma_f32_16x16x32_bf16 v[140:143], v[64:67], v[40:43], v[140:143]
    v_mfma_f32_16x16x32_bf16 v[160:163], v[64:67], v[44:47], v[160:163]
    v_mfma_f32_16x16x32_bf16 v[180:183], v[64:67], v[48:51], v[180:183]
    buffer_load_dwordx4 v[64:67], v224, s[12:15], s21 offen offset:3072
    v_mfma_f32_16x16x32_bf16 v[124:127], v[68:71], v[36:39], v[124:127]
    v_mfma_f32_16x16x32_bf16 v[144:147], v[68:71], v[40:43], v[144:147]
    v_mfma_f32_16x16x32_bf16 v[164:167], v[68:71], v[44:47], v[164:167]
    v_mfma_f32_16x16x32_bf16 v[184:187], v[68:71], v[48:51], v[184:187]
    buffer_load_dwordx4 v[68:71], v225, s[12:15], s21 offen
    buffer_load_dwordx4 v[36:39], v226, s[12:15], s20 offen
    buffer_load_dwordx4 v[40:43], v227, s[12:15], s20 offen
    buffer_load_dwordx4 v[44:47], v228, s[12:15], s20 offen
    buffer_load_dwordx4 v[48:51], v229, s[12:15], s20 offen
    s_add_u32 s20, s20, 1024
    s_add_u32 s21, s21, 5120
    s_waitcnt vmcnt(18)
    v_mfma_f32_16x16x32_bf16 v[108:111], v[88:91], v[72:75], v[108:111]
    v_mfma_f32_16x16x32_bf16 v[128:131], v[88:91], v[76:79], v[128:131]
    v_mfma_f32_16x16x32_bf16 v[148:151], v[88:91], v[80:83], v[148:151]
    v_mfma_f32_16x16x32_bf16 v[168:171], v[88:91], v[84:87], v[168:171]
    buffer_load_dwordx4 v[88:91], v224, s[12:15], s21 offen offset:0
    v_mfma_f32_16x16x32_bf16 v[112:115], v[92:95], v[72:75], v[112:115]
    v_mfma_f32_16x16x32_bf16 v[132:135], v[92:95], v[76:79], v[132:135]
    v_mfma_f32_16x16x32_bf16 v[152:155], v[92:95], v[80:83], v[152:155]
    v_mfma_f32_16x16x32_bf16 v[172:175], v[92:95], v[84:87], v[172:175]
    buffer_load_dwordx4 v[92:95], v224, s[12:15], s21 offen offset:1024
    v_mfma_f32_16x16x32_bf16 v[116:119], v[96:99], v[72:75], v[116:119]
    v_mfma_f32_16x16x32_bf16 v[136:139], v[96:99], v[76:79], v[136:139]
    v_mfma_f32_16x16x32_bf16 v[156:159], v[96:99], v[80:83], v[156:159]
    v_mfma_f32_16x16x32_bf16 v[176:179], v[96:99], v[84:87], v[176:179]
    buffer_load_dwordx4 v[96:99], v224, s[12:15], s21 offen offset:2048
    v_mfma_f32_16x16x32_bf16 v[120:123], v[100:103], v[72:75], v[120:123]
    v_mfma_f32_16x16x32_bf16 v[140:143], v[100:103], v[76:79], v[140:143]
    v_mfma_f32_16x16x32_bf16 v[160:163], v[100:103], v[80:83], v[160:163]
    v_mfma_f32_16x16x32_bf16 v[180:183], v[100:103], v[84:87], v[180:183]
    buffer_load_dwordx4 v[100:103], v224, s[12:15], s21 offen offset:3072
    v_mfma_f32_16x16x32_bf16 v[124:127], v[104:107], v[72:75], v[124:127]
    v_mfma_f32_16x16x32_bf16 v[144:147], v[104:107], v[76:79], v[144:147]
    v_mfma_f32_16x16x32_bf16 v[164:167], v[104:107], v[80:83], v[164:167]
    v_mfma_f32_16x16x32_bf16 v[184:187], v[104:107], v[84:87], v[184:187]
    buffer_load_dwordx4 v[104:107], v225, s[12:15], s21 offen
    buffer_load_dwordx4 v[72:75], v226, s[12:15], s20 offen
    buffer_load_dwordx4 v[76:79], v227, s[12:15], s20 offen
    buffer_load_dwordx4 v[80:83], v228, s[12:15], s20 offen
    buffer_load_dwordx4 v[84:87], v229, s[12:15], s20 offen
    s_add_u32 s20, s20, 1024
    s_add_u32 s21, s21, 5120
    s_waitcnt vmcnt(18)
    v_mfma_f32_16x16x32_bf16 v[108:111], v[16:19], v[0:3], v[108:111]
    v_mfma_f32_16x16x32_bf16 v[128:131], v[16:19], v[4:7], v[128:131]
    v_mfma_f32_16x16x32_bf16 v[148:151], v[16:19], v[8:11], v[148:151]
    v_mfma_f32_16x16x32_bf16 v[168:171], v[16:19], v[12:15], v[168:171]
    buffer_load_dwordx4 v[16:19], v224, s[12:15], s21 offen offset:0
    v_mfma_f32_16x16x32_bf16 v[112:115], v[20:23], v[0:3], v[112:115]
    v_mfma_f32_16x16x32_bf16 v[132:135], v[20:23], v[4:7], v[132:135]
    v_mfma_f32_16x16x32_bf16 v[152:155], v[20:23], v[8:11], v[152:155]
    v_mfma_f32_16x16x32_bf16 v[172:175], v[20:23], v[12:15], v[172:175]
    buffer_load_dwordx4 v[20:23], v224, s[12:15], s21 offen offset:1024
    v_mfma_f32_16x16x32_bf16 v[116:119], v[24:27], v[0:3], v[116:119]
    v_mfma_f32_16x16x32_bf16 v[136:139], v[24:27], v[4:7], v[136:139]
    v_mfma_f32_16x16x32_bf16 v[156:159], v[24:27], v[8:11], v[156:159]
    v_mfma_f32_16x16x32_bf16 v[176:179], v[24:27], v[12:15], v[176:179]
    buffer_load_dwordx4 v[24:27], v224, s[12:15], s21 offen offset:2048
    v_mfma_f32_16x16x32_bf16 v[120:123], v[28:31], v[0:3], v[120:123]
    v_mfma_f32_16x16x32_bf16 v[140:143], v[28:31], v[4:7], v[140:143]
    v_mfma_f32_16x16x32_bf16 v[160:163], v[28:31], v[8:11], v[160:163]
    v_mfma_f32_16x16x32_bf16 v[180:183], v[28:31], v[12:15], v[180:183]
    buffer_load_dwordx4 v[28:31], v224, s[12:15], s21 offen offset:3072
    v_mfma_f32_16x16x32_bf16 v[124:127], v[32:35], v[0:3], v[124:127]
    v_mfma_f32_16x16x32_bf16 v[144:147], v[32:35], v[4:7], v[144:147]
    v_mfma_f32_16x16x32_bf16 v[164:167], v[32:35], v[8:11], v[164:167]
    v_mfma_f32_16x16x32_bf16 v[184:187], v[32:35], v[12:15], v[184:187]
    buffer_load_dwordx4 v[32:35], v225, s[12:15], s21 offen
    buffer_load_dwordx4 v[0:3], v226, s[12:15], s20 offen
    buffer_load_dwordx4 v[4:7], v227, s[12:15], s20 offen
    buffer_load_dwordx4 v[8:11], v228, s[12:15], s20 offen
    buffer_load_dwordx4 v[12:15], v229, s[12:15], s20 offen
    s_add_u32 s20, s20, 1024
    s_add_u32 s21, s21, 5120
    s_waitcnt vmcnt(18)
    v_mfma_f32_16x16x32_bf16 v[108:111], v[52:55], v[36:39], v[108:111]
    v_mfma_f32_16x16x32_bf16 v[128:131], v[52:55], v[40:43], v[128:131]
    v_mfma_f32_16x16x32_bf16 v[148:151], v[52:55], v[44:47], v[148:151]
    v_mfma_f32_16x16x32_bf16 v[168:171], v[52:55], v[48:51], v[168:171]
    buffer_load_dwordx4 v[52:55], v224, s[12:15], s21 offen offset:0
    v_mfma_f32_16x16x32_bf16 v[112:115], v[56:59], v[36:39], v[112:115]
    v_mfma_f32_16x16x32_bf16 v[132:135], v[56:59], v[40:43], v[132:135]
    v_mfma_f32_16x16x32_bf16 v[152:155], v[56:59], v[44:47], v[152:155]
    v_mfma_f32_16x16x32_bf16 v[172:175], v[56:59], v[48:51], v[172:175]
    buffer_load_dwordx4 v[56:59], v224, s[12:15], s21 offen offset:1024
    v_mfma_f32_16x16x32_bf16 v[116:119], v[60:63], v[36:39], v[116:119]
    v_mfma_f32_16x16x32_bf16 v[136:139], v[60:63], v[40:43], v[136:139]
    v_mfma_f32_16x16x32_bf16 v[156:159], v[60:63], v[44:47], v[156:159]
    v_mfma_f32_16x16x32_bf16 v[176:179], v[60:63], v[48:51], v[176:179]
    buffer_load_dwordx4 v[60:63], v224, s[12:15], s21 offen offset:2048
    v_mfma_f32_16x16x32_bf16 v[120:123], v[64:67], v[36:39], v[120:123]
    v_mfma_f32_16x16x32_bf16 v[140:143], v[64:67], v[40:43], v[140:143]
    v_mfma_f32_16x16x32_bf16 v[160:163], v[64:67], v[44:47], v[160:163]
    v_mfma_f32_16x16x32_bf16 v[180:183], v[64:67], v[48:51], v[180:183]
    buffer_load_dwordx4 v[64:67], v224, s[12:15], s21 offen offset:3072
    v_mfma_f32_16x16x32_bf16 v[124:127], v[68:71], v[36:39], v[124:127]
    v_mfma_f32_16x16x32_bf16 v[144:147], v[68:71], v[40:43], v[144:147]
    v_mfma_f32_16x16x32_bf16 v[164:167], v[68:71], v[44:47], v[164:167]
    v_mfma_f32_16x16x32_bf16 v[184:187], v[68:71], v[48:51], v[184:187]
    buffer_load_dwordx4 v[68:71], v225, s[12:15], s21 offen
    buffer_load_dwordx4 v[36:39], v226, s[12:15], s20 offen
    buffer_load_dwordx4 v[40:43], v227, s[12:15], s20 offen
    buffer_load_dwordx4 v[44:47], v228, s[12:15], s20 offen
    buffer_load_dwordx4 v[48:51], v229, s[12:15], s20 offen
    s_add_u32 s20, s20, 1024
    s_add_u32 s21, s21, 5120
    s_waitcnt vmcnt(18)
    v_mfma_f32_16x16x32_bf16 v[108:111], v[88:91], v[72:75], v[108:111]
    v_mfma_f32_16x16x32_bf16 v[128:131], v[88:91], v[76:79], v[128:131]
    v_mfma_f32_16x16x32_bf16 v[148:151], v[88:91], v[80:83], v[148:151]
    v_mfma_f32_16x16x32_bf16 v[168:171], v[88:91], v[84:87], v[168:171]
    buffer_load_dwordx4 v[88:91], v224, s[12:15], s21 offen offset:0
    v_mfma_f32_16x16x32_bf16 v[112:115], v[92:95], v[72:75], v[112:115]
    v_mfma_f32_16x16x32_bf16 v[132:135], v[92:95], v[76:79], v[132:135]
    v_mfma_f32_16x16x32_bf16 v[152:155], v[92:95], v[80:83], v[152:155]
    v_mfma_f32_16x16x32_bf16 v[172:175], v[92:95], v[84:87], v[172:175]
    buffer_load_dwordx4 v[92:95], v224, s[12:15], s21 offen offset:1024
    v_mfma_f32_16x16x32_bf16 v[116:119], v[96:99], v[72:75], v[116:119]
    v_mfma_f32_16x16x32_bf16 v[136:139], v[96:99], v[76:79], v[136:139]
    v_mfma_f32_16x16x32_bf16 v[156:159], v[96:99], v[80:83], v[156:159]
    v_mfma_f32_16x16x32_bf16 v[176:179], v[96:99], v[84:87], v[176:179]
    buffer_load_dwordx4 v[96:99], v224, s[12:15], s21 offen offset:2048
    v_mfma_f32_16x16x32_bf16 v[120:123], v[100:103], v[72:75], v[120:123]
    v_mfma_f32_16x16x32_bf16 v[140:143], v[100:103], v[76:79], v[140:143]
    v_mfma_f32_16x16x32_bf16 v[160:163], v[100:103], v[80:83], v[160:163]
    v_mfma_f32_16x16x32_bf16 v[180:183], v[100:103], v[84:87], v[180:183]
    buffer_load_dwordx4 v[100:103], v224, s[12:15], s21 offen offset:3072
    v_mfma_f32_16x16x32_bf16 v[124:127], v[104:107], v[72:75], v[124:127]
    v_mfma_f32_16x16x32_bf16 v[144:147], v[104:107], v[76:79], v[144:147]
    v_mfma_f32_16x16x32_bf16 v[164:167], v[104:107], v[80:83], v[164:167]
    v_mfma_f32_16x16x32_bf16 v[184:187], v[104:107], v[84:87], v[184:187]
    buffer_load_dwordx4 v[104:107], v225, s[12:15], s21 offen
    buffer_load_dwordx4 v[72:75], v226, s[12:15], s20 offen
    buffer_load_dwordx4 v[76:79], v227, s[12:15], s20 offen
    buffer_load_dwordx4 v[80:83], v228, s[12:15], s20 offen
    buffer_load_dwordx4 v[84:87], v229, s[12:15], s20 offen
    s_add_u32 s20, s20, 1024
    s_add_u32 s21, s21, 5120
    s_waitcnt vmcnt(18)
    v_mfma_f32_16x16x32_bf16 v[108:111], v[16:19], v[0:3], v[108:111]
    v_mfma_f32_16x16x32_bf16 v[128:131], v[16:19], v[4:7], v[128:131]
    v_mfma_f32_16x16x32_bf16 v[148:151], v[16:19], v[8:11], v[148:151]
    v_mfma_f32_16x16x32_bf16 v[168:171], v[16:19], v[12:15], v[168:171]
    v_mfma_f32_16x16x32_bf16 v[112:115], v[20:23], v[0:3], v[112:115]
    v_mfma_f32_16x16x32_bf16 v[132:135], v[20:23], v[4:7], v[132:135]
    v_mfma_f32_16x16x32_bf16 v[152:155], v[20:23], v[8:11], v[152:155]
    v_mfma_f32_16x16x32_bf16 v[172:175], v[20:23], v[12:15], v[172:175]
    v_mfma_f32_16x16x32_bf16 v[116:119], v[24:27], v[0:3], v[116:119]
    v_mfma_f32_16x16x32_bf16 v[136:139], v[24:27], v[4:7], v[136:139]
    v_mfma_f32_16x16x32_bf16 v[156:159], v[24:27], v[8:11], v[156:159]
    v_mfma_f32_16x16x32_bf16 v[176:179], v[24:27], v[12:15], v[176:179]
    v_mfma_f32_16x16x32_bf16 v[120:123], v[28:31], v[0:3], v[120:123]
    v_mfma_f32_16x16x32_bf16 v[140:143], v[28:31], v[4:7], v[140:143]
    v_mfma_f32_16x16x32_bf16 v[160:163], v[28:31], v[8:11], v[160:163]
    v_mfma_f32_16x16x32_bf16 v[180:183], v[28:31], v[12:15], v[180:183]
    v_mfma_f32_16x16x32_bf16 v[124:127], v[32:35], v[0:3], v[124:127]
    v_mfma_f32_16x16x32_bf16 v[144:147], v[32:35], v[4:7], v[144:147]
    v_mfma_f32_16x16x32_bf16 v[164:167], v[32:35], v[8:11], v[164:167]
    v_mfma_f32_16x16x32_bf16 v[184:187], v[32:35], v[12:15], v[184:187]
    s_waitcnt vmcnt(9)
    v_mfma_f32_16x16x32_bf16 v[108:111], v[52:55], v[36:39], v[108:111]
    v_mfma_f32_16x16x32_bf16 v[128:131], v[52:55], v[40:43], v[128:131]
    v_mfma_f32_16x16x32_bf16 v[148:151], v[52:55], v[44:47], v[148:151]
    v_mfma_f32_16x16x32_bf16 v[168:171], v[52:55], v[48:51], v[168:171]
    v_mfma_f32_16x16x32_bf16 v[112:115], v[56:59], v[36:39], v[112:115]
    v_mfma_f32_16x16x32_bf16 v[132:135], v[56:59], v[40:43], v[132:135]
    v_mfma_f32_16x16x32_bf16 v[152:155], v[56:59], v[44:47], v[152:155]
    v_mfma_f32_16x16x32_bf16 v[172:175], v[56:59], v[48:51], v[172:175]
    v_mfma_f32_16x16x32_bf16 v[116:119], v[60:63], v[36:39], v[116:119]
    v_mfma_f32_16x16x32_bf16 v[136:139], v[60:63], v[40:43], v[136:139]
    v_mfma_f32_16x16x32_bf16 v[156:159], v[60:63], v[44:47], v[156:159]
    v_mfma_f32_16x16x32_bf16 v[176:179], v[60:63], v[48:51], v[176:179]
    v_mfma_f32_16x16x32_bf16 v[120:123], v[64:67], v[36:39], v[120:123]
    v_mfma_f32_16x16x32_bf16 v[140:143], v[64:67], v[40:43], v[140:143]
    v_mfma_f32_16x16x32_bf16 v[160:163], v[64:67], v[44:47], v[160:163]
    v_mfma_f32_16x16x32_bf16 v[180:183], v[64:67], v[48:51], v[180:183]
    v_mfma_f32_16x16x32_bf16 v[124:127], v[68:71], v[36:39], v[124:127]
    v_mfma_f32_16x16x32_bf16 v[144:147], v[68:71], v[40:43], v[144:147]
    v_mfma_f32_16x16x32_bf16 v[164:167], v[68:71], v[44:47], v[164:167]
    v_mfma_f32_16x16x32_bf16 v[184:187], v[68:71], v[48:51], v[184:187]
    s_waitcnt vmcnt(0)
    s_branch L_k2_red_b
L_k2_red_a:
    v_add_u32 v220, 0, v224
    v_add_u32 v221, 40960, v224
    v_add_u32 v222, 0, v224
    v_mov_b32 v219, 81920
    v_mov_b32 v218, 1
    s_nop 7
    s_waitcnt lgkmcnt(0)
    ds_write_b32 v219, v218 offset:0
    v_mov_b32 v208, v230
    v_mov_b32 v209, v230
L_k2_spin_a:
    ds_read_b128 v[214:217], v219 offset:16
    s_waitcnt lgkmcnt(0)
    v_and_b32 v215, v215, v216
    v_and_b32 v215, v215, v217
    s_nop 0
    v_readfirstlane_b32 s62, v215
    s_nop 3
    s_cmp_eq_u32 s62, 0
    s_cbranch_scc1 L_k2_spin_a
    ds_read_b128 v[0:3], v224 offset:0
    ds_read_b128 v[4:7], v224 offset:1024
    ds_read_b128 v[8:11], v224 offset:2048
    ds_read_b128 v[12:15], v224 offset:3072
    ds_read_b128 v[16:19], v224 offset:4096
    s_waitcnt lgkmcnt(4)
    v_pk_fma_f32 v[108:109], v[108:109], v[208:209], v[0:1]
    v_pk_fma_f32 v[110:111], v[110:111], v[208:209], v[2:3]
    s_waitcnt lgkmcnt(3)
    v_pk_fma_f32 v[112:113], v[112:113], v[208:209], v[4:5]
    v_pk_fma_f32 v[114:115], v[114:115], v[208:209], v[6:7]
    s_waitcnt lgkmcnt(2)
    v_pk_fma_f32 v[116:117], v[116:117], v[208:209], v[8:9]
    v_pk_fma_f32 v[118:119], v[118:119], v[208:209], v[10:11]
    s_waitcnt lgkmcnt(1)
    v_pk_fma_f32 v[120:121], v[120:121], v[208:209], v[12:13]
    v_pk_fma_f32 v[122:123], v[122:123], v[208:209], v[14:15]
    s_waitcnt lgkmcnt(0)
    v_pk_fma_f32 v[124:125], v[124:125], v[208:209], v[16:17]
    v_pk_fma_f32 v[126:127], v[126:127], v[208:209], v[18:19]
    v_cvt_pk_bf16_f32 v80, v108, v109
    v_cvt_pk_bf16_f32 v81, v110, v111
    v_cvt_pk_bf16_f32 v82, v112, v113
    v_cvt_pk_bf16_f32 v83, v114, v115
    buffer_store_dwordx4 v[80:83], v242, s[28:31], 0 offen offset:0
    v_cvt_pk_bf16_f32 v84, v116, v117
    v_cvt_pk_bf16_f32 v85, v118, v119
    v_cvt_pk_bf16_f32 v86, v120, v121
    v_cvt_pk_bf16_f32 v87, v122, v123
    buffer_store_dwordx4 v[84:87], v242, s[28:31], 0 offen offset:64
    v_cvt_pk_bf16_f32 v88, v124, v125
    v_cvt_pk_bf16_f32 v89, v126, v127
    buffer_store_dwordx2 v[88:89], v243, s[28:31], 0 offen offset:128
    s_endpgm
L_k2_red_b:
    s_cmp_eq_u32 s24, 1
    s_cbranch_scc0 L_k2_red_b2
    v_add_u32 v220, 5120, v224
    v_add_u32 v221, 46080, v224
    v_mfma_f32_16x16x32_bf16 v[108:111], v[88:91], v[72:75], v[108:111]
    v_mfma_f32_16x16x32_bf16 v[112:115], v[92:95], v[72:75], v[112:115]
    v_mfma_f32_16x16x32_bf16 v[116:119], v[96:99], v[72:75], v[116:119]
    v_mfma_f32_16x16x32_bf16 v[120:123], v[100:103], v[72:75], v[120:123]
    v_mfma_f32_16x16x32_bf16 v[124:127], v[104:107], v[72:75], v[124:127]
    v_mfma_f32_16x16x32_bf16 v[148:151], v[88:91], v[80:83], v[148:151]
    v_mfma_f32_16x16x32_bf16 v[152:155], v[92:95], v[80:83], v[152:155]
    v_mfma_f32_16x16x32_bf16 v[156:159], v[96:99], v[80:83], v[156:159]
    v_mfma_f32_16x16x32_bf16 v[160:163], v[100:103], v[80:83], v[160:163]
    v_mfma_f32_16x16x32_bf16 v[164:167], v[104:107], v[80:83], v[164:167]
    v_mfma_f32_16x16x32_bf16 v[168:171], v[88:91], v[84:87], v[168:171]
    ds_write_b128 v220, v[108:111] offset:0
    v_mfma_f32_16x16x32_bf16 v[172:175], v[92:95], v[84:87], v[172:175]
    ds_write_b128 v220, v[112:115] offset:1024
    v_mfma_f32_16x16x32_bf16 v[176:179], v[96:99], v[84:87], v[176:179]
    ds_write_b128 v220, v[116:119] offset:2048
    v_mfma_f32_16x16x32_bf16 v[180:183], v[100:103], v[84:87], v[180:183]
    ds_write_b128 v220, v[120:123] offset:3072
    v_mfma_f32_16x16x32_bf16 v[184:187], v[104:107], v[84:87], v[184:187]
    ds_write_b128 v220, v[124:127] offset:4096
    v_mfma_f32_16x16x32_bf16 v[128:131], v[88:91], v[76:79], v[128:131]
    ds_write_b128 v221, v[148:151] offset:0
    v_mfma_f32_16x16x32_bf16 v[132:135], v[92:95], v[76:79], v[132:135]
    ds_write_b128 v221, v[152:155] offset:1024
    v_mfma_f32_16x16x32_bf16 v[136:139], v[96:99], v[76:79], v[136:139]
    ds_write_b128 v221, v[156:159] offset:2048
    v_mfma_f32_16x16x32_bf16 v[140:143], v[100:103], v[76:79], v[140:143]
    ds_write_b128 v221, v[160:163] offset:3072
    v_mfma_f32_16x16x32_bf16 v[144:147], v[104:107], v[76:79], v[144:147]
    ds_write_b128 v221, v[164:167] offset:4096
    ds_write_b128 v221, v[168:171] offset:20480
    ds_write_b128 v221, v[172:175] offset:21504
    ds_write_b128 v221, v[176:179] offset:22528
    ds_write_b128 v221, v[180:183] offset:23552
    ds_write_b128 v221, v[184:187] offset:24576
    v_add_u32 v220, 5120, v224
    v_add_u32 v221, 46080, v224
    v_add_u32 v222, 20480, v224
    v_mov_b32 v219, 81920
    v_mov_b32 v218, 1
    s_nop 7
    s_waitcnt lgkmcnt(0)
    ds_write_b32 v219, v218 offset:4
    s_mov_b32 s63, 0xffff0000
    v_lshlrev_b32 v188, 16, v232
    v_and_b32 v189, s63, v232
    v_lshlrev_b32 v190, 16, v233
    v_and_b32 v191, s63, v233
    v_lshlrev_b32 v192, 16, v234
    v_and_b32 v193, s63, v234
    v_lshlrev_b32 v194, 16, v235
    v_and_b32 v195, s63, v235
    v_lshlrev_b32 v196, 16, v236
    v_and_b32 v197, s63, v236
    v_lshlrev_b32 v198, 16, v237
    v_and_b32 v199, s63, v237
    v_lshlrev_b32 v200, 16, v238
    v_and_b32 v201, s63, v238
    v_lshlrev_b32 v202, 16, v239
    v_and_b32 v203, s63, v239
    v_lshlrev_b32 v204, 16, v240
    v_and_b32 v205, s63, v240
    v_lshlrev_b32 v206, 16, v241
    v_and_b32 v207, s63, v241
    v_mov_b32 v208, v230
    v_mov_b32 v209, v230
    v_mov_b32 v210, v231
    v_mov_b32 v211, v231
    v_mov_b32 v212, v245
    v_mov_b32 v213, v245
L_k2_spin_b1:
    ds_read_b128 v[214:217], v219 offset:0
    s_waitcnt lgkmcnt(0)
    v_and_b32 v216, v216, v217
    s_nop 0
    v_readfirstlane_b32 s62, v216
    s_nop 3
    s_cmp_eq_u32 s62, 0
    s_cbranch_scc1 L_k2_spin_b1
    ds_read_b128 v[40:43], v224 offset:10240
    ds_read_b128 v[48:51], v224 offset:15360
    ds_read_b128 v[44:47], v224 offset:11264
    ds_read_b128 v[52:55], v224 offset:16384
    ds_read_b128 v[0:3], v222 offset:10240
    ds_read_b128 v[20:23], v222 offset:15360
    ds_read_b128 v[4:7], v222 offset:11264
    ds_read_b128 v[24:27], v222 offset:16384
    ds_read_b128 v[8:11], v222 offset:12288
    ds_read_b128 v[28:31], v222 offset:17408
    ds_read_b128 v[12:15], v222 offset:13312
    ds_read_b128 v[32:35], v222 offset:18432
    ds_read_b128 v[16:19], v222 offset:14336
    ds_read_b128 v[36:39], v222 offset:19456
    s_waitcnt lgkmcnt(10)
    v_pk_add_f32 v[40:41], v[40:41], v[48:49]
    v_pk_add_f32 v[108:109], v[108:109], v[188:189]
    v_pk_add_f32 v[42:43], v[42:43], v[50:51]
    v_pk_add_f32 v[110:111], v[110:111], v[190:191]
    v_pk_add_f32 v[108:109], v[108:109], v[40:41]
    v_pk_mul_f32 v[108:109], v[108:109], v[212:213]
    v_pk_add_f32 v[110:111], v[110:111], v[42:43]
    v_pk_mul_f32 v[110:111], v[110:111], v[212:213]
    v_pk_add_f32 v[44:45], v[44:45], v[52:53]
    v_pk_add_f32 v[112:113], v[112:113], v[192:193]
    v_pk_add_f32 v[46:47], v[46:47], v[54:55]
    v_pk_add_f32 v[114:115], v[114:115], v[194:195]
    v_pk_add_f32 v[112:113], v[112:113], v[44:45]
    v_pk_mul_f32 v[112:113], v[112:113], v[212:213]
    v_pk_add_f32 v[114:115], v[114:115], v[46:47]
    v_pk_mul_f32 v[114:115], v[114:115], v[212:213]
    ds_write_b128 v224, v[108:111] offset:0
    ds_write_b128 v224, v[112:115] offset:1024
    s_waitcnt lgkmcnt(0)
    ds_write_b32 v219, v218 offset:20
    v_pk_add_f32 v[0:1], v[0:1], v[20:21]
    v_pk_add_f32 v[128:129], v[128:129], v[188:189]
    v_pk_add_f32 v[2:3], v[2:3], v[22:23]
    v_pk_add_f32 v[130:131], v[130:131], v[190:191]
    v_pk_add_f32 v[128:129], v[128:129], v[0:1]
    v_pk_mul_f32 v[128:129], v[128:129], v[210:211]
    v_pk_add_f32 v[130:131], v[130:131], v[2:3]
    v_pk_mul_f32 v[130:131], v[130:131], v[210:211]
    v_pk_add_f32 v[4:5], v[4:5], v[24:25]
    v_pk_add_f32 v[132:133], v[132:133], v[192:193]
    v_pk_add_f32 v[6:7], v[6:7], v[26:27]
    v_pk_add_f32 v[134:135], v[134:135], v[194:195]
    v_pk_add_f32 v[132:133], v[132:133], v[4:5]
    v_pk_mul_f32 v[132:133], v[132:133], v[210:211]
    v_pk_add_f32 v[134:135], v[134:135], v[6:7]
    v_pk_mul_f32 v[134:135], v[134:135], v[210:211]
    v_pk_add_f32 v[8:9], v[8:9], v[28:29]
    v_pk_add_f32 v[136:137], v[136:137], v[196:197]
    v_pk_add_f32 v[10:11], v[10:11], v[30:31]
    v_pk_add_f32 v[138:139], v[138:139], v[198:199]
    v_pk_add_f32 v[136:137], v[136:137], v[8:9]
    v_pk_mul_f32 v[136:137], v[136:137], v[210:211]
    v_pk_add_f32 v[138:139], v[138:139], v[10:11]
    v_pk_mul_f32 v[138:139], v[138:139], v[210:211]
    v_pk_add_f32 v[12:13], v[12:13], v[32:33]
    v_pk_add_f32 v[140:141], v[140:141], v[200:201]
    v_pk_add_f32 v[14:15], v[14:15], v[34:35]
    v_pk_add_f32 v[142:143], v[142:143], v[202:203]
    v_pk_add_f32 v[140:141], v[140:141], v[12:13]
    v_pk_mul_f32 v[140:141], v[140:141], v[210:211]
    v_pk_add_f32 v[142:143], v[142:143], v[14:15]
    v_pk_mul_f32 v[142:143], v[142:143], v[210:211]
    v_pk_add_f32 v[16:17], v[16:17], v[36:37]
    v_pk_add_f32 v[144:145], v[144:145], v[204:205]
    v_pk_add_f32 v[18:19], v[18:19], v[38:39]
    v_pk_add_f32 v[146:147], v[146:147], v[206:207]
    v_pk_add_f32 v[144:145], v[144:145], v[16:17]
    v_pk_mul_f32 v[144:145], v[144:145], v[210:211]
    v_pk_add_f32 v[146:147], v[146:147], v[18:19]
    v_pk_mul_f32 v[146:147], v[146:147], v[210:211]
L_k2_spin_c1:
    ds_read_b128 v[214:217], v219 offset:0
    s_waitcnt lgkmcnt(0)
    v_readfirstlane_b32 s62, v214
    s_nop 3
    s_cmp_eq_u32 s62, 0
    s_cbranch_scc1 L_k2_spin_c1
    ds_read_b128 v[56:59], v222 offset:0
    ds_read_b128 v[60:63], v222 offset:1024
    ds_read_b128 v[64:67], v222 offset:2048
    ds_read_b128 v[68:71], v222 offset:3072
    ds_read_b128 v[72:75], v222 offset:4096
    s_waitcnt lgkmcnt(4)
    v_pk_fma_f32 v[128:129], v[56:57], v[208:209], v[128:129]
    v_pk_fma_f32 v[130:131], v[58:59], v[208:209], v[130:131]
    s_waitcnt lgkmcnt(3)
    v_pk_fma_f32 v[132:133], v[60:61], v[208:209], v[132:133]
    v_pk_fma_f32 v[134:135], v[62:63], v[208:209], v[134:135]
    s_waitcnt lgkmcnt(2)
    v_pk_fma_f32 v[136:137], v[64:65], v[208:209], v[136:137]
    v_pk_fma_f32 v[138:139], v[66:67], v[208:209], v[138:139]
    s_waitcnt lgkmcnt(1)
    v_pk_fma_f32 v[140:141], v[68:69], v[208:209], v[140:141]
    v_pk_fma_f32 v[142:143], v[70:71], v[208:209], v[142:143]
    s_waitcnt lgkmcnt(0)
    v_pk_fma_f32 v[144:145], v[72:73], v[208:209], v[144:145]
    v_pk_fma_f32 v[146:147], v[74:75], v[208:209], v[146:147]
    v_cvt_pk_bf16_f32 v80, v128, v129
    v_cvt_pk_bf16_f32 v81, v130, v131
    v_cvt_pk_bf16_f32 v82, v132, v133
    v_cvt_pk_bf16_f32 v83, v134, v135
    buffer_store_dwordx4 v[80:83], v242, s[28:31], 0 offen offset:0
    v_cvt_pk_bf16_f32 v84, v136, v137
    v_cvt_pk_bf16_f32 v85, v138, v139
    v_cvt_pk_bf16_f32 v86, v140, v141
    v_cvt_pk_bf16_f32 v87, v142, v143
    buffer_store_dwordx4 v[84:87], v242, s[28:31], 0 offen offset:64
    v_cvt_pk_bf16_f32 v88, v144, v145
    v_cvt_pk_bf16_f32 v89, v146, v147
    buffer_store_dwordx2 v[88:89], v243, s[28:31], 0 offen offset:128
    s_endpgm
L_k2_red_b2:
    s_cmp_eq_u32 s24, 2
    s_cbranch_scc0 L_k2_red_b3
    v_add_u32 v220, 10240, v224
    v_add_u32 v221, 51200, v224
    v_mfma_f32_16x16x32_bf16 v[108:111], v[88:91], v[72:75], v[108:111]
    v_mfma_f32_16x16x32_bf16 v[112:115], v[92:95], v[72:75], v[112:115]
    v_mfma_f32_16x16x32_bf16 v[116:119], v[96:99], v[72:75], v[116:119]
    v_mfma_f32_16x16x32_bf16 v[120:123], v[100:103], v[72:75], v[120:123]
    v_mfma_f32_16x16x32_bf16 v[124:127], v[104:107], v[72:75], v[124:127]
    v_mfma_f32_16x16x32_bf16 v[128:131], v[88:91], v[76:79], v[128:131]
    v_mfma_f32_16x16x32_bf16 v[132:135], v[92:95], v[76:79], v[132:135]
    v_mfma_f32_16x16x32_bf16 v[136:139], v[96:99], v[76:79], v[136:139]
    v_mfma_f32_16x16x32_bf16 v[140:143], v[100:103], v[76:79], v[140:143]
    v_mfma_f32_16x16x32_bf16 v[144:147], v[104:107], v[76:79], v[144:147]
    v_mfma_f32_16x16x32_bf16 v[168:171], v[88:91], v[84:87], v[168:171]
    ds_write_b128 v220, v[108:111] offset:0
    v_mfma_f32_16x16x32_bf16 v[172:175], v[92:95], v[84:87], v[172:175]
    ds_write_b128 v220, v[112:115] offset:1024
    v_mfma_f32_16x16x32_bf16 v[176:179], v[96:99], v[84:87], v[176:179]
    ds_write_b128 v220, v[116:119] offset:2048
    v_mfma_f32_16x16x32_bf16 v[180:183], v[100:103], v[84:87], v[180:183]
    ds_write_b128 v220, v[120:123] offset:3072
    v_mfma_f32_16x16x32_bf16 v[184:187], v[104:107], v[84:87], v[184:187]
    ds_write_b128 v220, v[124:127] offset:4096
    v_mfma_f32_16x16x32_bf16 v[148:151], v[88:91], v[80:83], v[148:151]
    ds_write_b128 v220, v[128:131] offset:20480
    v_mfma_f32_16x16x32_bf16 v[152:155], v[92:95], v[80:83], v[152:155]
    ds_write_b128 v220, v[132:135] offset:21504
    v_mfma_f32_16x16x32_bf16 v[156:159], v[96:99], v[80:83], v[156:159]
    ds_write_b128 v220, v[136:139] offset:22528
    v_mfma_f32_16x16x32_bf16 v[160:163], v[100:103], v[80:83], v[160:163]
    ds_write_b128 v220, v[140:143] offset:23552
    v_mfma_f32_16x16x32_bf16 v[164:167], v[104:107], v[80:83], v[164:167]
    ds_write_b128 v220, v[144:147] offset:24576
    ds_write_b128 v221, v[168:171] offset:20480
    ds_write_b128 v221, v[172:175] offset:21504
    ds_write_b128 v221, v[176:179] offset:22528
    ds_write_b128 v221, v[180:183] offset:23552
    ds_write_b128 v221, v[184:187] offset:24576
    v_add_u32 v220, 10240, v224
    v_add_u32 v221, 51200, v224
    v_add_u32 v222, 40960, v224
    v_mov_b32 v219, 81920
    v_mov_b32 v218, 1
    s_nop 7
    s_waitcnt lgkmcnt(0)
    ds_write_b32 v219, v218 offset:8
    s_mov_b32 s63, 0xffff0000
    v_lshlrev_b32 v188, 16, v232
    v_and_b32 v189, s63, v232
    v_lshlrev_b32 v190, 16, v233
    v_and_b32 v191, s63, v233
    v_lshlrev_b32 v192, 16, v234
    v_and_b32 v193, s63, v234
    v_lshlrev_b32 v194, 16, v235
    v_and_b32 v195, s63, v235
    v_lshlrev_b32 v196, 16, v236
    v_and_b32 v197, s63, v236
    v_lshlrev_b32 v198, 16, v237
    v_and_b32 v199, s63, v237
    v_lshlrev_b32 v200, 16, v238
    v_and_b32 v201, s63, v238
    v_lshlrev_b32 v202, 16, v239
    v_and_b32 v203, s63, v239
    v_lshlrev_b32 v204, 16, v240
    v_and_b32 v205, s63, v240
    v_lshlrev_b32 v206, 16, v241
    v_and_b32 v207, s63, v241
    v_mov_b32 v208, v230
    v_mov_b32 v209, v230
    v_mov_b32 v210, v231
    v_mov_b32 v211, v231
    v_mov_b32 v212, v245
    v_mov_b32 v213, v245
L_k2_spin_b2:
    ds_read_b128 v[214:217], v219 offset:0
    s_waitcnt lgkmcnt(0)
    v_and_b32 v215, v215, v217
    s_nop 0
    v_readfirstlane_b32 s62, v215
    s_nop 3
    s_cmp_eq_u32 s62, 0
    s_cbranch_scc1 L_k2_spin_b2
    ds_read_b128 v[40:43], v224 offset:7168
    ds_read_b128 v[48:51], v224 offset:17408
    ds_read_b128 v[44:47], v224 offset:8192
    ds_read_b128 v[52:55], v224 offset:18432
    ds_read_b128 v[0:3], v222 offset:5120
    ds_read_b128 v[20:23], v222 offset:15360
    ds_read_b128 v[4:7], v222 offset:6144
    ds_read_b128 v[24:27], v222 offset:16384
    ds_read_b128 v[8:11], v222 offset:7168
    ds_read_b128 v[28:31], v222 offset:17408
    ds_read_b128 v[12:15], v222 offset:8192
    ds_read_b128 v[32:35], v222 offset:18432
    ds_read_b128 v[16:19], v222 offset:9216
    ds_read_b128 v[36:39], v222 offset:19456
    s_waitcnt lgkmcnt(10)
    v_pk_add_f32 v[40:41], v[40:41], v[48:49]
    v_pk_add_f32 v[116:117], v[116:117], v[196:197]
    v_pk_add_f32 v[42:43], v[42:43], v[50:51]
    v_pk_add_f32 v[118:119], v[118:119], v[198:199]
    v_pk_add_f32 v[116:117], v[116:117], v[40:41]
    v_pk_mul_f32 v[116:117], v[116:117], v[212:213]
    v_pk_add_f32 v[118:119], v[118:119], v[42:43]
    v_pk_mul_f32 v[118:119], v[118:119], v[212:213]
    v_pk_add_f32 v[44:45], v[44:45], v[52:53]
    v_pk_add_f32 v[120:121], v[120:121], v[200:201]
    v_pk_add_f32 v[46:47], v[46:47], v[54:55]
    v_pk_add_f32 v[122:123], v[122:123], v[202:203]
    v_pk_add_f32 v[120:121], v[120:121], v[44:45]
    v_pk_mul_f32 v[120:121], v[120:121], v[212:213]
    v_pk_add_f32 v[122:123], v[122:123], v[46:47]
    v_pk_mul_f32 v[122:123], v[122:123], v[212:213]
    ds_write_b128 v224, v[116:119] offset:2048
    ds_write_b128 v224, v[120:123] offset:3072
    s_waitcnt lgkmcnt(0)
    ds_write_b32 v219, v218 offset:24
    v_pk_add_f32 v[0:1], v[0:1], v[20:21]
    v_pk_add_f32 v[148:149], v[148:149], v[188:189]
    v_pk_add_f32 v[2:3], v[2:3], v[22:23]
    v_pk_add_f32 v[150:151], v[150:151], v[190:191]
    v_pk_add_f32 v[148:149], v[148:149], v[0:1]
    v_pk_mul_f32 v[148:149], v[148:149], v[210:211]
    v_pk_add_f32 v[150:151], v[150:151], v[2:3]
    v_pk_mul_f32 v[150:151], v[150:151], v[210:211]
    v_pk_add_f32 v[4:5], v[4:5], v[24:25]
    v_pk_add_f32 v[152:153], v[152:153], v[192:193]
    v_pk_add_f32 v[6:7], v[6:7], v[26:27]
    v_pk_add_f32 v[154:155], v[154:155], v[194:195]
    v_pk_add_f32 v[152:153], v[152:153], v[4:5]
    v_pk_mul_f32 v[152:153], v[152:153], v[210:211]
    v_pk_add_f32 v[154:155], v[154:155], v[6:7]
    v_pk_mul_f32 v[154:155], v[154:155], v[210:211]
    v_pk_add_f32 v[8:9], v[8:9], v[28:29]
    v_pk_add_f32 v[156:157], v[156:157], v[196:197]
    v_pk_add_f32 v[10:11], v[10:11], v[30:31]
    v_pk_add_f32 v[158:159], v[158:159], v[198:199]
    v_pk_add_f32 v[156:157], v[156:157], v[8:9]
    v_pk_mul_f32 v[156:157], v[156:157], v[210:211]
    v_pk_add_f32 v[158:159], v[158:159], v[10:11]
    v_pk_mul_f32 v[158:159], v[158:159], v[210:211]
    v_pk_add_f32 v[12:13], v[12:13], v[32:33]
    v_pk_add_f32 v[160:161], v[160:161], v[200:201]
    v_pk_add_f32 v[14:15], v[14:15], v[34:35]
    v_pk_add_f32 v[162:163], v[162:163], v[202:203]
    v_pk_add_f32 v[160:161], v[160:161], v[12:13]
    v_pk_mul_f32 v[160:161], v[160:161], v[210:211]
    v_pk_add_f32 v[162:163], v[162:163], v[14:15]
    v_pk_mul_f32 v[162:163], v[162:163], v[210:211]
    v_pk_add_f32 v[16:17], v[16:17], v[36:37]
    v_pk_add_f32 v[164:165], v[164:165], v[204:205]
    v_pk_add_f32 v[18:19], v[18:19], v[38:39]
    v_pk_add_f32 v[166:167], v[166:167], v[206:207]
    v_pk_add_f32 v[164:165], v[164:165], v[16:17]
    v_pk_mul_f32 v[164:165], v[164:165], v[210:211]
    v_pk_add_f32 v[166:167], v[166:167], v[18:19]
    v_pk_mul_f32 v[166:167], v[166:167], v[210:211]
L_k2_spin_c2:
    ds_read_b128 v[214:217], v219 offset:0
    s_waitcnt lgkmcnt(0)
    v_readfirstlane_b32 s62, v214
    s_nop 3
    s_cmp_eq_u32 s62, 0
    s_cbranch_scc1 L_k2_spin_c2
    ds_read_b128 v[56:59], v222 offset:0
    ds_read_b128 v[60:63], v222 offset:1024
    ds_read_b128 v[64:67], v222 offset:2048
    ds_read_b128 v[68:71], v222 offset:3072
    ds_read_b128 v[72:75], v222 offset:4096
    s_waitcnt lgkmcnt(4)
    v_pk_fma_f32 v[148:149], v[56:57], v[208:209], v[148:149]
    v_pk_fma_f32 v[150:151], v[58:59], v[208:209], v[150:151]
    s_waitcnt lgkmcnt(3)
    v_pk_fma_f32 v[152:153], v[60:61], v[208:209], v[152:153]
    v_pk_fma_f32 v[154:155], v[62:63], v[208:209], v[154:155]
    s_waitcnt lgkmcnt(2)
    v_pk_fma_f32 v[156:157], v[64:65], v[208:209], v[156:157]
    v_pk_fma_f32 v[158:159], v[66:67], v[208:209], v[158:159]
    s_waitcnt lgkmcnt(1)
    v_pk_fma_f32 v[160:161], v[68:69], v[208:209], v[160:161]
    v_pk_fma_f32 v[162:163], v[70:71], v[208:209], v[162:163]
    s_waitcnt lgkmcnt(0)
    v_pk_fma_f32 v[164:165], v[72:73], v[208:209], v[164:165]
    v_pk_fma_f32 v[166:167], v[74:75], v[208:209], v[166:167]
    v_cvt_pk_bf16_f32 v80, v148, v149
    v_cvt_pk_bf16_f32 v81, v150, v151
    v_cvt_pk_bf16_f32 v82, v152, v153
    v_cvt_pk_bf16_f32 v83, v154, v155
    buffer_store_dwordx4 v[80:83], v242, s[28:31], 0 offen offset:0
    v_cvt_pk_bf16_f32 v84, v156, v157
    v_cvt_pk_bf16_f32 v85, v158, v159
    v_cvt_pk_bf16_f32 v86, v160, v161
    v_cvt_pk_bf16_f32 v87, v162, v163
    buffer_store_dwordx4 v[84:87], v242, s[28:31], 0 offen offset:64
    v_cvt_pk_bf16_f32 v88, v164, v165
    v_cvt_pk_bf16_f32 v89, v166, v167
    buffer_store_dwordx2 v[88:89], v243, s[28:31], 0 offen offset:128
    s_endpgm
L_k2_red_b3:
    v_add_u32 v220, 15360, v224
    v_add_u32 v221, 56320, v224
    v_mfma_f32_16x16x32_bf16 v[108:111], v[88:91], v[72:75], v[108:111]
    v_mfma_f32_16x16x32_bf16 v[112:115], v[92:95], v[72:75], v[112:115]
    v_mfma_f32_16x16x32_bf16 v[116:119], v[96:99], v[72:75], v[116:119]
    v_mfma_f32_16x16x32_bf16 v[120:123], v[100:103], v[72:75], v[120:123]
    v_mfma_f32_16x16x32_bf16 v[124:127], v[104:107], v[72:75], v[124:127]
    v_mfma_f32_16x16x32_bf16 v[128:131], v[88:91], v[76:79], v[128:131]
    v_mfma_f32_16x16x32_bf16 v[132:135], v[92:95], v[76:79], v[132:135]
    v_mfma_f32_16x16x32_bf16 v[136:139], v[96:99], v[76:79], v[136:139]
    v_mfma_f32_16x16x32_bf16 v[140:143], v[100:103], v[76:79], v[140:143]
    v_mfma_f32_16x16x32_bf16 v[144:147], v[104:107], v[76:79], v[144:147]
    v_mfma_f32_16x16x32_bf16 v[148:151], v[88:91], v[80:83], v[148:151]
    ds_write_b128 v220, v[108:111] offset:0
    v_mfma_f32_16x16x32_bf16 v[152:155], v[92:95], v[80:83], v[152:155]
    ds_write_b128 v220, v[112:115] offset:1024
    v_mfma_f32_16x16x32_bf16 v[156:159], v[96:99], v[80:83], v[156:159]
    ds_write_b128 v220, v[116:119] offset:2048
    v_mfma_f32_16x16x32_bf16 v[160:163], v[100:103], v[80:83], v[160:163]
    ds_write_b128 v220, v[120:123] offset:3072
    v_mfma_f32_16x16x32_bf16 v[164:167], v[104:107], v[80:83], v[164:167]
    ds_write_b128 v220, v[124:127] offset:4096
    v_mfma_f32_16x16x32_bf16 v[168:171], v[88:91], v[84:87], v[168:171]
    ds_write_b128 v220, v[128:131] offset:20480
    v_mfma_f32_16x16x32_bf16 v[172:175], v[92:95], v[84:87], v[172:175]
    ds_write_b128 v220, v[132:135] offset:21504
    v_mfma_f32_16x16x32_bf16 v[176:179], v[96:99], v[84:87], v[176:179]
    ds_write_b128 v220, v[136:139] offset:22528
    v_mfma_f32_16x16x32_bf16 v[180:183], v[100:103], v[84:87], v[180:183]
    ds_write_b128 v220, v[140:143] offset:23552
    v_mfma_f32_16x16x32_bf16 v[184:187], v[104:107], v[84:87], v[184:187]
    ds_write_b128 v220, v[144:147] offset:24576
    ds_write_b128 v221, v[148:151] offset:0
    ds_write_b128 v221, v[152:155] offset:1024
    ds_write_b128 v221, v[156:159] offset:2048
    ds_write_b128 v221, v[160:163] offset:3072
    ds_write_b128 v221, v[164:167] offset:4096
    v_add_u32 v220, 15360, v224
    v_add_u32 v221, 56320, v224
    v_add_u32 v222, 61440, v224
    v_mov_b32 v219, 81920
    v_mov_b32 v218, 1
    s_nop 7
    s_waitcnt lgkmcnt(0)
    ds_write_b32 v219, v218 offset:12
    s_mov_b32 s63, 0xffff0000
    v_lshlrev_b32 v188, 16, v232
    v_and_b32 v189, s63, v232
    v_lshlrev_b32 v190, 16, v233
    v_and_b32 v191, s63, v233
    v_lshlrev_b32 v192, 16, v234
    v_and_b32 v193, s63, v234
    v_lshlrev_b32 v194, 16, v235
    v_and_b32 v195, s63, v235
    v_lshlrev_b32 v196, 16, v236
    v_and_b32 v197, s63, v236
    v_lshlrev_b32 v198, 16, v237
    v_and_b32 v199, s63, v237
    v_lshlrev_b32 v200, 16, v238
    v_and_b32 v201, s63, v238
    v_lshlrev_b32 v202, 16, v239
    v_and_b32 v203, s63, v239
    v_lshlrev_b32 v204, 16, v240
    v_and_b32 v205, s63, v240
    v_lshlrev_b32 v206, 16, v241
    v_and_b32 v207, s63, v241
    v_mov_b32 v208, v230
    v_mov_b32 v209, v230
    v_mov_b32 v210, v231
    v_mov_b32 v211, v231
    v_mov_b32 v212, v245
    v_mov_b32 v213, v245
L_k2_spin_b3:
    ds_read_b128 v[214:217], v219 offset:0
    s_waitcnt lgkmcnt(0)
    v_and_b32 v215, v215, v216
    s_nop 0
    v_readfirstlane_b32 s62, v215
    s_nop 3
    s_cmp_eq_u32 s62, 0
    s_cbranch_scc1 L_k2_spin_b3
    ds_read_b128 v[40:43], v224 offset:9216
    ds_read_b128 v[48:51], v224 offset:14336
    ds_read_b128 v[0:3], v222 offset:5120
    ds_read_b128 v[20:23], v222 offset:10240
    ds_read_b128 v[4:7], v222 offset:6144
    ds_read_b128 v[24:27], v222 offset:11264
    ds_read_b128 v[8:11], v222 offset:7168
    ds_read_b128 v[28:31], v222 offset:12288
    ds_read_b128 v[12:15], v222 offset:8192
    ds_read_b128 v[32:35], v222 offset:13312
    ds_read_b128 v[16:19], v222 offset:9216
    ds_read_b128 v[36:39], v222 offset:14336
    s_waitcnt lgkmcnt(10)
    v_pk_add_f32 v[40:41], v[40:41], v[48:49]
    v_pk_add_f32 v[124:125], v[124:125], v[204:205]
    v_pk_add_f32 v[42:43], v[42:43], v[50:51]
    v_pk_add_f32 v[126:127], v[126:127], v[206:207]
    v_pk_add_f32 v[124:125], v[124:125], v[40:41]
    v_pk_mul_f32 v[124:125], v[124:125], v[212:213]
    v_pk_add_f32 v[126:127], v[126:127], v[42:43]
    v_pk_mul_f32 v[126:127], v[126:127], v[212:213]
    ds_write_b128 v224, v[124:127] offset:4096
    s_waitcnt lgkmcnt(0)
    ds_write_b32 v219, v218 offset:28
    v_pk_add_f32 v[0:1], v[0:1], v[20:21]
    v_pk_add_f32 v[168:169], v[168:169], v[188:189]
    v_pk_add_f32 v[2:3], v[2:3], v[22:23]
    v_pk_add_f32 v[170:171], v[170:171], v[190:191]
    v_pk_add_f32 v[168:169], v[168:169], v[0:1]
    v_pk_mul_f32 v[168:169], v[168:169], v[210:211]
    v_pk_add_f32 v[170:171], v[170:171], v[2:3]
    v_pk_mul_f32 v[170:171], v[170:171], v[210:211]
    v_pk_add_f32 v[4:5], v[4:5], v[24:25]
    v_pk_add_f32 v[172:173], v[172:173], v[192:193]
    v_pk_add_f32 v[6:7], v[6:7], v[26:27]
    v_pk_add_f32 v[174:175], v[174:175], v[194:195]
    v_pk_add_f32 v[172:173], v[172:173], v[4:5]
    v_pk_mul_f32 v[172:173], v[172:173], v[210:211]
    v_pk_add_f32 v[174:175], v[174:175], v[6:7]
    v_pk_mul_f32 v[174:175], v[174:175], v[210:211]
    v_pk_add_f32 v[8:9], v[8:9], v[28:29]
    v_pk_add_f32 v[176:177], v[176:177], v[196:197]
    v_pk_add_f32 v[10:11], v[10:11], v[30:31]
    v_pk_add_f32 v[178:179], v[178:179], v[198:199]
    v_pk_add_f32 v[176:177], v[176:177], v[8:9]
    v_pk_mul_f32 v[176:177], v[176:177], v[210:211]
    v_pk_add_f32 v[178:179], v[178:179], v[10:11]
    v_pk_mul_f32 v[178:179], v[178:179], v[210:211]
    v_pk_add_f32 v[12:13], v[12:13], v[32:33]
    v_pk_add_f32 v[180:181], v[180:181], v[200:201]
    v_pk_add_f32 v[14:15], v[14:15], v[34:35]
    v_pk_add_f32 v[182:183], v[182:183], v[202:203]
    v_pk_add_f32 v[180:181], v[180:181], v[12:13]
    v_pk_mul_f32 v[180:181], v[180:181], v[210:211]
    v_pk_add_f32 v[182:183], v[182:183], v[14:15]
    v_pk_mul_f32 v[182:183], v[182:183], v[210:211]
    v_pk_add_f32 v[16:17], v[16:17], v[36:37]
    v_pk_add_f32 v[184:185], v[184:185], v[204:205]
    v_pk_add_f32 v[18:19], v[18:19], v[38:39]
    v_pk_add_f32 v[186:187], v[186:187], v[206:207]
    v_pk_add_f32 v[184:185], v[184:185], v[16:17]
    v_pk_mul_f32 v[184:185], v[184:185], v[210:211]
    v_pk_add_f32 v[186:187], v[186:187], v[18:19]
    v_pk_mul_f32 v[186:187], v[186:187], v[210:211]
L_k2_spin_c3:
    ds_read_b128 v[214:217], v219 offset:0
    s_waitcnt lgkmcnt(0)
    v_readfirstlane_b32 s62, v214
    s_nop 3
    s_cmp_eq_u32 s62, 0
    s_cbranch_scc1 L_k2_spin_c3
    ds_read_b128 v[56:59], v222 offset:0
    ds_read_b128 v[60:63], v222 offset:1024
    ds_read_b128 v[64:67], v222 offset:2048
    ds_read_b128 v[68:71], v222 offset:3072
    ds_read_b128 v[72:75], v222 offset:4096
    s_waitcnt lgkmcnt(4)
    v_pk_fma_f32 v[168:169], v[56:57], v[208:209], v[168:169]
    v_pk_fma_f32 v[170:171], v[58:59], v[208:209], v[170:171]
    s_waitcnt lgkmcnt(3)
    v_pk_fma_f32 v[172:173], v[60:61], v[208:209], v[172:173]
    v_pk_fma_f32 v[174:175], v[62:63], v[208:209], v[174:175]
    s_waitcnt lgkmcnt(2)
    v_pk_fma_f32 v[176:177], v[64:65], v[208:209], v[176:177]
    v_pk_fma_f32 v[178:179], v[66:67], v[208:209], v[178:179]
    s_waitcnt lgkmcnt(1)
    v_pk_fma_f32 v[180:181], v[68:69], v[208:209], v[180:181]
    v_pk_fma_f32 v[182:183], v[70:71], v[208:209], v[182:183]
    s_waitcnt lgkmcnt(0)
    v_pk_fma_f32 v[184:185], v[72:73], v[208:209], v[184:185]
    v_pk_fma_f32 v[186:187], v[74:75], v[208:209], v[186:187]
    v_cvt_pk_bf16_f32 v80, v168, v169
    v_cvt_pk_bf16_f32 v81, v170, v171
    v_cvt_pk_bf16_f32 v82, v172, v173
    v_cvt_pk_bf16_f32 v83, v174, v175
    buffer_store_dwordx4 v[80:83], v242, s[28:31], 0 offen offset:0
    v_cvt_pk_bf16_f32 v84, v176, v177
    v_cvt_pk_bf16_f32 v85, v178, v179
    v_cvt_pk_bf16_f32 v86, v180, v181
    v_cvt_pk_bf16_f32 v87, v182, v183
    buffer_store_dwordx4 v[84:87], v242, s[28:31], 0 offen offset:64
    v_cvt_pk_bf16_f32 v88, v184, v185
    v_cvt_pk_bf16_f32 v89, v186, v187
    buffer_store_dwordx2 v[88:89], v243, s[28:31], 0 offen offset:128
    s_endpgm
L_k2_end:
    s_endpgm
.section .rodata,"a"
.p2align 6
.amdhsa_kernel gm_k1_kernel
  .amdhsa_next_free_vgpr 256
  .amdhsa_next_free_sgpr 102
  .amdhsa_accum_offset 256
  .amdhsa_group_segment_fixed_size 0
  .amdhsa_kernarg_size 96
  .amdhsa_user_sgpr_count 2
  .amdhsa_user_sgpr_kernarg_segment_ptr 1
  .amdhsa_system_sgpr_workgroup_id_x 1
  .amdhsa_float_denorm_mode_32 3
.end_amdhsa_kernel
.p2align 6
.amdhsa_kernel gm_k2_kernel
  .amdhsa_next_free_vgpr 256
  .amdhsa_next_free_sgpr 102
  .amdhsa_accum_offset 256
  .amdhsa_group_segment_fixed_size 0
  .amdhsa_kernarg_size 96
  .amdhsa_user_sgpr_count 2
  .amdhsa_user_sgpr_kernarg_segment_ptr 1
  .amdhsa_system_sgpr_workgroup_id_x 1
  .amdhsa_float_denorm_mode_32 3
.end_amdhsa_kernel
```
